```python
import torch

def _softmax(x, axis=-1):
    return torch.softmax(x, dim=axis)
def _gelu(x):
    return torch.nn.functional.gelu(x, approximate="tanh")
def _silu(x):
    return torch.nn.functional.silu(x)
def _sigmoid(x):
    return torch.sigmoid(x)
def _layernorm(x, axis=-1, eps=1e-5):
    m = x.mean(dim=axis, keepdim=True)
    v = x.var(dim=axis, keepdim=True, unbiased=False)
    return (x - m) / torch.sqrt(v + eps)
def _scatter_add(tgt, idx, src, axis=0):
    return tgt.clone().index_add_(axis, idx, src)
def _segment_sum(src, seg, n):
    out = torch.zeros((n,) + src.shape[1:], dtype=src.dtype)
    return out.index_add_(0, seg, src)
def _pad(x, pw):
    flat = tuple(v for pair in reversed(pw) for v in pair)
    return torch.nn.functional.pad(x, flat)

kernel_name = 'sequential_preLN__linear_kernel_hedgehog__moe_arch_mod__prompt'

def setup_inputs():

    _w = (lambda a: (lambda t: t.to(torch.bfloat16) if t.is_floating_point() else t)(torch.as_tensor(a)))
    def _A_setup():
        B, S, D, H = 1, 2048, 640, 32
        Dh = D // H
        return {
            "x": _w((lambda *s: torch.randn(*s, dtype=torch.bfloat16) * 0.05)(B, S, D)),
            "wqkv": _w((lambda *s: torch.randn(*s, dtype=torch.bfloat16) * 0.2)(D, 3 * D)),
            "w_phi": _w((lambda *s: torch.randn(*s, dtype=torch.bfloat16) * 0.2)(H, Dh, Dh) * (Dh ** -0.5)),
            "wo": _w((lambda *s: torch.randn(*s, dtype=torch.bfloat16) * 0.05)(D, D)),
        }
    _A_in = _A_setup()

    def _B_setup():
        B, S, D, F, C = 1, 2048, 640, 1536, 8
        return {
            "x": _w((lambda *s: torch.randn(*s, dtype=torch.bfloat16) * 0.05)(B, S, D)),
            "w_r": _w((lambda *s: torch.randn(*s, dtype=torch.bfloat16) * 0.05)(D)),
            "w_gate": _w((lambda *s: torch.randn(*s, dtype=torch.bfloat16) * 0.05)(D, F)),
            "w_up": _w((lambda *s: torch.randn(*s, dtype=torch.bfloat16) * 0.05)(D, F)),
            "w_down": _w((lambda *s: torch.randn(*s, dtype=torch.bfloat16) * 0.05)(F, D)),
        }
    _B_in = _B_setup()

    return {
        "A_x": _A_in["x"],
        "A_wqkv": _A_in["wqkv"],
        "A_w_phi": _A_in["w_phi"],
        "A_wo": _A_in["wo"],
        "B_x": _B_in["x"],
        "B_w_r": _B_in["w_r"],
        "B_w_gate": _B_in["w_gate"],
        "B_w_up": _B_in["w_up"],
        "B_w_down": _B_in["w_down"],
    }

def reference(A_x, A_wqkv, A_w_phi, A_wo, B_x, B_w_r, B_w_gate, B_w_up, B_w_down):
    def _A_ref(x, wqkv, w_phi, wo):
        B, S, D = x.shape
        H = 32; Dh = D // H
        qkv = (lambda x, *d: x.permute(*d))((x @ wqkv).reshape(B, S, 3, H, Dh), 2, 0, 3, 1, 4)
        q, k, v = qkv[0], qkv[1], qkv[2]
        pq = torch.einsum("bhsd,hdf->bhsf", q, w_phi)
        pk = torch.einsum("bhsd,hdf->bhsf", k, w_phi)
        phi_q = torch.concatenate([_softmax(pq, axis=-1), _softmax(-pq, axis=-1)], axis=-1)
        phi_k = torch.concatenate([_softmax(pk, axis=-1), _softmax(-pk, axis=-1)], axis=-1)
        kv = torch.einsum("bhsf,bhsd->bhfd", phi_k, v)
        z  = torch.einsum("bhsf->bhf", phi_k)
        num = torch.einsum("bhqf,bhfd->bhqd", phi_q, kv)
        den = torch.einsum("bhqf,bhf->bhq", phi_q, z)[..., None] + 1e-6
        o = num / den
        return (lambda x, *d: x.permute(*d))(o, 0, 2, 1, 3).reshape(B, S, D) @ wo

    def _B_ref(x, w_r, w_gate, w_up, w_down):
        B, S, D = x.shape
        C = 8
        r = x @ w_r
        idx = torch.argsort(-r, axis=-1)[:, :C]
        idx_e = (lambda x, n, axis: torch.repeat_interleave(x, n, dim=axis))(idx.reshape(B, C, 1), D, axis=2)
        x_sel = (lambda x, i, axis: torch.take_along_dim(x, i, dim=axis))(x, idx_e, axis=1)
        g = _silu(x_sel @ w_gate)
        u = x_sel @ w_up
        y = (g * u) @ w_down
        r_sel = _sigmoid((lambda x, i, axis: torch.take_along_dim(x, i, dim=axis))(r, idx, axis=1))
        y = y * r_sel.reshape(B, C, 1)
        b_off = (torch.arange(B) * S).reshape(B, 1)
        flat_idx = (idx + b_off).reshape(B * C)
        zero = (x * 0.0).reshape(B * S, D)
        upd = _scatter_add(zero, flat_idx, y.reshape(B * C, D), axis=0)
        return x + upd.reshape(B, S, D)

    x = A_x
    h = x + _A_ref(_layernorm(x, axis=-1), A_wqkv, A_w_phi, A_wo)
    h2 = h + _B_ref(_layernorm(h, axis=-1), B_w_r, B_w_gate, B_w_up, B_w_down)
    return h2
```

```asm
; @launch grid=(256,1,1) block=(512,1,1) lds=163840
.amdgcn_target "amdgcn-amd-amdhsa--gfx950"
.text
.globl sequential_preLN__linear_kernel_hedgehog__moe_arch_mod__prompt_kernel
.p2align 8
.type sequential_preLN__linear_kernel_hedgehog__moe_arch_mod__prompt_kernel,@function
sequential_preLN__linear_kernel_hedgehog__moe_arch_mod__prompt_kernel:
    s_cmp_ge_u32 s2, 256
    s_cbranch_scc1 L_end
    s_load_dwordx16 s[4:19], s[0:1], 0
    s_load_dwordx8 s[20:27], s[0:1], 64
    s_getpc_b64 s[68:69]
L_pc:
    s_andn2_b32 s70, s2, 7
    v_lshrrev_b32 v10, 5, v0
    v_lshl_add_u32 v10, s70, 1, v10
    v_min_u32 v10, (L_code_end-L_pc)/128-1, v10
    v_lshlrev_b32_e64 v10, 7, v10
    global_load_dword v4, v10, s[68:69]
    v_lshrrev_b32 v10, 6, v0
    v_and_b32 v1, 63, v0
    s_lshr_b32 s55, s2, 3
    v_readfirstlane_b32 s86, v10
    s_and_b32 s56, s2, 7
    v_lshlrev_b32 v2, 4, v1
    v_and_b32 v0, 0xff, v0
    s_and_b32 s52, s86, 3
    s_lshr_b32 s86, s86, 2
    s_and_b32 s68, s2, 3
    s_lshl_b32 s68, s68, 3
    s_and_b32 s69, s55, 7
    s_add_u32 s53, s68, s69
    s_and_b32 s68, s56, 4
    s_lshr_b32 s70, s55, 3
    s_add_u32 s54, s68, s70
    s_mul_i32 s69, s69, 5
    s_lshr_b32 s69, s69, 2
    s_mul_i32 s70, s70, 5
    s_lshr_b32 s70, s70, 1
    s_add_u32 s87, s69, s70
    s_lshr_b32 s68, s68, 8
    s_add_u32 s87, s87, s68
    s_cmp_ge_u32 s87, 10
    s_cselect_b32 s68, 10, 0
    s_sub_u32 s87, s87, s68
    s_cmp_lg_u32 s86, 0
    s_cbranch_scc1 L_B
    s_setprio 1
    s_lshl_b32 s68, s53, 2
    s_add_u32 s69, s68, s52
    s_mul_i32 s69, s69, 20480
    v_lshrrev_b32_e64 v128, 3, v1
    v_mul_u32_u24 v128, 1280, v128
    v_lshrrev_b32 v130, 4, v1
    v_and_b32 v129, 7, v1
    v_xor_b32_e64 v129, v129, v130
    v_lshl_add_u32 v128, v129, 4, v128
    v_add_u32 v120, s69, v128
    v_xor_b32 v129, 64, v120
    v_add_u32 v121, 9216, v129
    s_mul_i32 s81, s52, 20480
    s_add_u32 s81, s81, 73728
    s_mov_b32 m0, s81
    s_lshl_b32 s63, s87, 7
    s_mov_b32 s30, 2621440
    s_mov_b32 s31, 0x20000
    s_waitcnt lgkmcnt(0)
    s_mov_b32 s28, s4
    s_and_b32 s29, s5, 0xffff
    buffer_load_dwordx4 v120, s[28:31], s63 offen offset:0  lds
    buffer_load_dwordx4 v121, s[28:31], s63 offen offset:1024  lds
    s_add_u32 m0, s81, 2048
    s_add_u32 s63, s63, 128
    s_cmp_eq_u32 s63, 1280
    s_cselect_b32 s63, 0, s63
    s_nop 0
    buffer_load_dwordx4 v120, s[28:31], s63 offen offset:0  lds
    buffer_load_dwordx4 v121, s[28:31], s63 offen offset:1024  lds
    s_add_u32 m0, s81, 4096
    s_add_u32 s63, s63, 128
    s_cmp_eq_u32 s63, 1280
    s_cselect_b32 s63, 0, s63
    buffer_load_dwordx4 v120, s[28:31], s63 offen offset:0  lds
    buffer_load_dwordx4 v121, s[28:31], s63 offen offset:1024  lds
    s_load_dword s57, s[26:27], 0
    s_mov_b32 s36, s26
    s_and_b32 s37, s27, 0xffff
    s_mov_b32 s38, 268435456
    s_mov_b32 s39, 0x20000
    v_lshrrev_b32_e64 v48, 4, v1
    v_bfe_u32 v49, v1, 2, 2
    v_and_b32 v50, 3, v1
    v_and_b32 v51, 15, v1
    v_lshrrev_b32 v52, 5, v1
    v_and_b32 v53, 1, v48
    v_lshl_add_u32 v54, v53, 2, v50
    v_mov_b32_e64 v58, 1073741824
    v_bfe_u32 v55, v1, 1, 3
    v_xor_b32_e64 v55, v55, v48
    v_lshl_add_u32 v55, v55, 4, s81
    v_lshl_add_u32 v124, v51, 7, v55
    v_xor_b32_e64 v125, 64, v124
    v_lshl_add_u32 v55, v52, 4, v49
    v_lshl_add_u32 v55, v53, 2, v55
    v_mul_u32_u24 v55, 160, v55
    v_mad_u32_u24 v6, v50, 40, v55
    v_add_u32 v7, 61440, v6
    v_add_u32 v8, 61440, v2
    v_mul_u32_u24 v55, 800, v48
    v_mad_u32_u24 v55, v49, 40, v55
    v_add_u32 v55, 159744, v55
    v_cmp_eq_u32_e64 vcc, v50, v48
    v_mov_b32 v56, 162944
    s_lshl_b32 s88, s52, 11
    v_cndmask_b32 v126, v56, v55, vcc
    s_add_u32 s88, s88, 122880
    v_lshl_add_u32 v55, v51, 7, s88
    v_lshl_add_u32 v55, v48, 13, v55
    v_bfe_u32 v56, v1, 1, 1
    v_lshl_add_u32 v55, v56, 6, v55
    v_and_b32_e64 v56, 1, v1
    v_lshl_add_u32 v55, v56, 4, v55
    v_bfe_u32 v56, v1, 2, 1
    v_lshl_add_u32 v9, v56, 5, v55
    s_lshl_b32 s88, s52, 13
    s_add_u32 s88, s88, 122880
    v_lshl_add_u32 v55, v52, 3, v49
    v_lshl_add_u32 v55, v55, 7, s88
    v_lshrrev_b32 v56, 1, v49
    v_and_b32_e64 v57, 1, v49
    v_lshl_add_u32 v56, v56, 2, v57
    v_lshlrev_b32 v56, 4, v56
    v_min_u32 v57, 4, v54
    v_add_lshl_u32 v57, v57, 0, 3
    v_xad_u32 v11, v57, v56, v55
    v_xor_b32 v12, 544, v11
    v_min_u32_e64 v57, 4, v54
    v_add_lshl_u32 v57, v57, 5, 3
    v_xad_u32 v13, v57, v56, v55
    v_xor_b32 v14, 544, v13
    v_min_u32_e64 v57, 5, v54
    v_add_lshl_u32 v57, v57, 10, 3
    v_xad_u32 v15, v57, v56, v55
    v_xor_b32 v16, 544, v15
    v_and_b32 v57, 31, v1
    v_cmp_gt_u32 vcc, 24, v57
    v_mad_u32_u24 v55, v52, 24, v57
    s_mul_i32 s88, s52, 3840
    v_lshl_add_u32 v55, v55, 4, s88
    v_cndmask_b32_e64 v17, v58, v55, vcc
    v_mul_u32_u24 v56, 1536, v52
    v_add_u32 v18, v56, v17
    v_cmp_eq_u32 vcc, v49, v48
    s_mov_b32 s89, 105
    v_mul_u32_u24 v56, 1280, v52
    v_mad_u32_u24 v55, v48, s89, v50
    v_mov_b32 v57, 423
    v_cndmask_b32 v55, v57, v55, vcc
    v_lshlrev_b32 v55, 4, v55
    v_add_u32 v19, 147456, v55
    v_lshl_add_u32 v55, v51, 4, v56
    v_lshl_add_u32 v21, v53, 3, v55
    v_mul_u32_u24 v56, 768, v53
    v_add_u32 v20, v55, v56
    s_mul_i32 s88, s56, 12
    s_max_u32 s88, s88, 68
    s_cmp_eq_u32 s56, 5
    s_cselect_b32 s88, 56, s88
    s_cselect_b32 s70, 32, 28
    s_add_u32 s88, s88, 136
    s_cmp_lt_u32 s55, s70
    s_cselect_b32 s88, s88, 224
    s_lshl_b32 s70, s56, 4
    s_add_u32 s70, s70, 80
    s_cmp_lt_u32 s55, 16
    s_cselect_b32 s88, s70, s88
    s_lshl_b32 s70, s56, 5
    s_cmp_lt_u32 s56, 5
    s_cselect_b32 s88, s70, s88
    s_add_u32 s12, s88, s55
    s_waitcnt lgkmcnt(0)
    s_add_u32 s57, s57, 2654435761
    s_lshl_b32 s88, s52, 2
    v_mov_b32 v31, 1073741824
    v_mov_b32 v3, s88
    v_cmp_eq_u32 vcc, 0, v1
    s_waitcnt vmcnt(6)
    v_mov_b32 v4, s57
    s_mov_b32 s79, 0xffff0000
    v_cndmask_b32_e64 v3, v31, v3, vcc
    s_mov_b32 s92, 0x3fb8aa3b
    s_mov_b32 s93, 0x3fb8aa3b
    s_mov_b32 s80, 0x3f803f80
    v_lshlrev_b32_e64 v23, 2, v1
    v_and_b32 v23, 0x7f, v23
    s_add_u32 m0, s81, 6144
    s_add_u32 s63, s63, 128
    s_cmp_eq_u32 s63, 1280
    s_cselect_b32 s63, 0, s63
    s_nop 0
    buffer_load_dwordx4 v120, s[28:31], s63 offen offset:0  lds
    buffer_load_dwordx4 v121, s[28:31], s63 offen offset:1024  lds
    s_add_u32 m0, s81, 8192
    s_add_u32 s63, s63, 128
    s_cmp_eq_u32 s63, 1280
    s_cselect_b32 s63, 0, s63
    s_nop 0
    buffer_load_dwordx4 v120, s[28:31], s63 offen offset:0  lds
    buffer_load_dwordx4 v121, s[28:31], s63 offen offset:1024  lds
    s_add_u32 m0, s81, 10240
    s_add_u32 s63, s63, 128
    s_cmp_eq_u32 s63, 1280
    s_cselect_b32 s63, 0, s63
    s_nop 0
    buffer_load_dwordx4 v120, s[28:31], s63 offen offset:0  lds
    buffer_load_dwordx4 v121, s[28:31], s63 offen offset:1024  lds
    s_add_u32 m0, s81, 12288
    s_add_u32 s63, s63, 128
    s_cmp_eq_u32 s63, 1280
    s_cselect_b32 s63, 0, s63
    buffer_load_dwordx4 v120, s[28:31], s63 offen offset:0  lds
    buffer_load_dwordx4 v121, s[28:31], s63 offen offset:1024  lds
    s_waitcnt vmcnt(12)
    ds_read_b128 v[176:179], v124 offset:0
    ds_read_b128 v[180:183], v125 offset:0
    s_add_u32 m0, s81, 14336
    s_add_u32 s63, s63, 128
    s_cmp_eq_u32 s63, 1280
    s_cselect_b32 s63, 0, s63
    buffer_load_dwordx4 v120, s[28:31], s63 offen offset:0  lds
    buffer_load_dwordx4 v121, s[28:31], s63 offen offset:1024  lds
    s_waitcnt vmcnt(12)
    ds_read_b128 v[184:187], v124 offset:2048
    ds_read_b128 v[188:191], v125 offset:2048
    s_waitcnt lgkmcnt(3)
    s_nop 0
    v_dot2_f32_bf16 v24, v176, s80, 0
    v_dot2_f32_bf16 v25, v176, v176, 0
    v_dot2_f32_bf16 v24, v177, s80, v24
    v_dot2_f32_bf16 v25, v177, v177, v25
    v_dot2_f32_bf16 v24, v178, s80, v24
    v_dot2_f32_bf16 v25, v178, v178, v25
    v_dot2_f32_bf16 v24, v179, s80, v24
    v_dot2_f32_bf16 v25, v179, v179, v25
    s_waitcnt lgkmcnt(2)
    s_nop 0
    v_dot2_f32_bf16 v24, v180, s80, v24
    v_dot2_f32_bf16 v25, v180, v180, v25
    v_dot2_f32_bf16 v24, v181, s80, v24
    v_dot2_f32_bf16 v25, v181, v181, v25
    v_dot2_f32_bf16 v24, v182, s80, v24
    v_dot2_f32_bf16 v25, v182, v182, v25
    v_dot2_f32_bf16 v24, v183, s80, v24
    v_dot2_f32_bf16 v25, v183, v183, v25
    s_add_u32 m0, s81, 16384
    s_add_u32 s63, s63, 128
    s_cmp_eq_u32 s63, 1280
    s_cselect_b32 s63, 0, s63
    buffer_load_dwordx4 v120, s[28:31], s63 offen offset:0  lds
    buffer_load_dwordx4 v121, s[28:31], s63 offen offset:1024  lds
    s_waitcnt vmcnt(12)
    ds_read_b128 v[192:195], v124 offset:4096
    ds_read_b128 v[196:199], v125 offset:4096
    s_waitcnt lgkmcnt(3)
    s_nop 0
    v_dot2_f32_bf16 v24, v184, s80, v24
    v_dot2_f32_bf16 v25, v184, v184, v25
    v_dot2_f32_bf16 v24, v185, s80, v24
    v_dot2_f32_bf16 v25, v185, v185, v25
    v_dot2_f32_bf16 v24, v186, s80, v24
    v_dot2_f32_bf16 v25, v186, v186, v25
    v_dot2_f32_bf16 v24, v187, s80, v24
    v_dot2_f32_bf16 v25, v187, v187, v25
    s_waitcnt lgkmcnt(2)
    s_nop 0
    v_dot2_f32_bf16 v24, v188, s80, v24
    v_dot2_f32_bf16 v25, v188, v188, v25
    v_dot2_f32_bf16 v24, v189, s80, v24
    v_dot2_f32_bf16 v25, v189, v189, v25
    v_dot2_f32_bf16 v24, v190, s80, v24
    v_dot2_f32_bf16 v25, v190, v190, v25
    v_dot2_f32_bf16 v24, v191, s80, v24
    v_dot2_f32_bf16 v25, v191, v191, v25
    s_add_u32 m0, s81, 18432
    s_add_u32 s63, s63, 128
    s_cmp_eq_u32 s63, 1280
    s_cselect_b32 s63, 0, s63
    buffer_load_dwordx4 v120, s[28:31], s63 offen offset:0  lds
    buffer_load_dwordx4 v121, s[28:31], s63 offen offset:1024  lds
    s_barrier
    ds_read_b64_tr_b16 v[68:69], v126 offset:0
    ds_read_b64_tr_b16 v[70:71], v126 offset:160
    ds_read_b64_tr_b16 v[72:73], v126 offset:320
    ds_read_b64_tr_b16 v[74:75], v126 offset:480
    ds_read_b64_tr_b16 v[76:77], v126 offset:640
    ds_read_b64_tr_b16 v[78:79], v126 offset:8
    ds_read_b64_tr_b16 v[80:81], v126 offset:168
    ds_read_b64_tr_b16 v[82:83], v126 offset:328
    ds_read_b64_tr_b16 v[84:85], v126 offset:488
    ds_read_b64_tr_b16 v[86:87], v126 offset:648
    ds_read_b64_tr_b16 v[88:89], v126 offset:16
    ds_read_b64_tr_b16 v[90:91], v126 offset:176
    ds_read_b64_tr_b16 v[92:93], v126 offset:336
    ds_read_b64_tr_b16 v[94:95], v126 offset:496
    ds_read_b64_tr_b16 v[96:97], v126 offset:656
    ds_read_b64_tr_b16 v[98:99], v126 offset:24
    ds_read_b64_tr_b16 v[100:101], v126 offset:184
    ds_read_b64_tr_b16 v[102:103], v126 offset:344
    ds_read_b64_tr_b16 v[104:105], v126 offset:504
    ds_read_b64_tr_b16 v[106:107], v126 offset:664
    ds_read_b64_tr_b16 v[108:109], v126 offset:32
    ds_read_b64_tr_b16 v[110:111], v126 offset:192
    ds_read_b64_tr_b16 v[112:113], v126 offset:352
    ds_read_b64_tr_b16 v[114:115], v126 offset:512
    ds_read_b64_tr_b16 v[116:117], v126 offset:672
    s_waitcnt vmcnt(12)
    ds_read_b128 v[200:203], v124 offset:6144
    ds_read_b128 v[204:207], v125 offset:6144
    s_waitcnt lgkmcnt(15)
    v_dot2_f32_bf16 v24, v192, s80, v24
    v_dot2_f32_bf16 v25, v192, v192, v25
    v_dot2_f32_bf16 v24, v193, s80, v24
    v_dot2_f32_bf16 v25, v193, v193, v25
    v_dot2_f32_bf16 v24, v194, s80, v24
    v_dot2_f32_bf16 v25, v194, v194, v25
    v_dot2_f32_bf16 v24, v195, s80, v24
    v_dot2_f32_bf16 v25, v195, v195, v25
    v_dot2_f32_bf16 v24, v196, s80, v24
    v_dot2_f32_bf16 v25, v196, v196, v25
    v_dot2_f32_bf16 v24, v197, s80, v24
    v_dot2_f32_bf16 v25, v197, v197, v25
    v_dot2_f32_bf16 v24, v198, s80, v24
    v_dot2_f32_bf16 v25, v198, v198, v25
    v_dot2_f32_bf16 v24, v199, s80, v24
    v_dot2_f32_bf16 v25, v199, v199, v25
    s_waitcnt vmcnt(10)
    ds_read_b128 v[208:211], v124 offset:8192
    ds_read_b128 v[212:215], v125 offset:8192
    s_waitcnt lgkmcnt(3)
    v_dot2_f32_bf16 v24, v200, s80, v24
    v_dot2_f32_bf16 v25, v200, v200, v25
    v_dot2_f32_bf16 v24, v201, s80, v24
    v_dot2_f32_bf16 v25, v201, v201, v25
    v_dot2_f32_bf16 v24, v202, s80, v24
    v_dot2_f32_bf16 v25, v202, v202, v25
    v_dot2_f32_bf16 v24, v203, s80, v24
    v_dot2_f32_bf16 v25, v203, v203, v25
    s_waitcnt lgkmcnt(2)
    s_nop 0
    v_dot2_f32_bf16 v24, v204, s80, v24
    v_dot2_f32_bf16 v25, v204, v204, v25
    v_dot2_f32_bf16 v24, v205, s80, v24
    v_dot2_f32_bf16 v25, v205, v205, v25
    v_dot2_f32_bf16 v24, v206, s80, v24
    v_dot2_f32_bf16 v25, v206, v206, v25
    v_dot2_f32_bf16 v24, v207, s80, v24
    v_dot2_f32_bf16 v25, v207, v207, v25
    s_waitcnt vmcnt(8)
    ds_read_b128 v[216:219], v124 offset:10240
    ds_read_b128 v[220:223], v125 offset:10240
    s_waitcnt lgkmcnt(3)
    v_dot2_f32_bf16 v24, v208, s80, v24
    v_dot2_f32_bf16 v25, v208, v208, v25
    v_dot2_f32_bf16 v24, v209, s80, v24
    v_dot2_f32_bf16 v25, v209, v209, v25
    v_dot2_f32_bf16 v24, v210, s80, v24
    v_dot2_f32_bf16 v25, v210, v210, v25
    v_dot2_f32_bf16 v24, v211, s80, v24
    v_dot2_f32_bf16 v25, v211, v211, v25
    s_waitcnt lgkmcnt(2)
    s_nop 0
    v_dot2_f32_bf16 v24, v212, s80, v24
    v_dot2_f32_bf16 v25, v212, v212, v25
    v_dot2_f32_bf16 v24, v213, s80, v24
    v_dot2_f32_bf16 v25, v213, v213, v25
    v_dot2_f32_bf16 v24, v214, s80, v24
    v_dot2_f32_bf16 v25, v214, v214, v25
    v_dot2_f32_bf16 v24, v215, s80, v24
    v_dot2_f32_bf16 v25, v215, v215, v25
    s_waitcnt vmcnt(6)
    ds_read_b128 v[224:227], v124 offset:12288
    ds_read_b128 v[228:231], v125 offset:12288
    s_waitcnt lgkmcnt(3)
    v_dot2_f32_bf16 v24, v216, s80, v24
    v_dot2_f32_bf16 v25, v216, v216, v25
    v_dot2_f32_bf16 v24, v217, s80, v24
    v_dot2_f32_bf16 v25, v217, v217, v25
    v_dot2_f32_bf16 v24, v218, s80, v24
    v_dot2_f32_bf16 v25, v218, v218, v25
    v_dot2_f32_bf16 v24, v219, s80, v24
    v_dot2_f32_bf16 v25, v219, v219, v25
    s_waitcnt lgkmcnt(2)
    s_nop 0
    v_dot2_f32_bf16 v24, v220, s80, v24
    v_dot2_f32_bf16 v25, v220, v220, v25
    v_dot2_f32_bf16 v24, v221, s80, v24
    v_dot2_f32_bf16 v25, v221, v221, v25
    v_dot2_f32_bf16 v24, v222, s80, v24
    v_dot2_f32_bf16 v25, v222, v222, v25
    v_dot2_f32_bf16 v24, v223, s80, v24
    v_dot2_f32_bf16 v25, v223, v223, v25
    s_waitcnt vmcnt(4)
    ds_read_b128 v[232:235], v124 offset:14336
    ds_read_b128 v[236:239], v125 offset:14336
    s_waitcnt lgkmcnt(3)
    v_dot2_f32_bf16 v24, v224, s80, v24
    v_dot2_f32_bf16 v25, v224, v224, v25
    v_dot2_f32_bf16 v24, v225, s80, v24
    v_dot2_f32_bf16 v25, v225, v225, v25
    v_dot2_f32_bf16 v24, v226, s80, v24
    v_dot2_f32_bf16 v25, v226, v226, v25
    v_dot2_f32_bf16 v24, v227, s80, v24
    v_dot2_f32_bf16 v25, v227, v227, v25
    s_waitcnt lgkmcnt(2)
    s_nop 0
    v_dot2_f32_bf16 v24, v228, s80, v24
    v_dot2_f32_bf16 v25, v228, v228, v25
    v_dot2_f32_bf16 v24, v229, s80, v24
    v_dot2_f32_bf16 v25, v229, v229, v25
    v_dot2_f32_bf16 v24, v230, s80, v24
    v_dot2_f32_bf16 v25, v230, v230, v25
    v_dot2_f32_bf16 v24, v231, s80, v24
    v_dot2_f32_bf16 v25, v231, v231, v25
    s_waitcnt vmcnt(2)
    ds_read_b128 v[240:243], v124 offset:16384
    ds_read_b128 v[244:247], v125 offset:16384
    s_waitcnt lgkmcnt(3)
    v_dot2_f32_bf16 v24, v232, s80, v24
    v_dot2_f32_bf16 v25, v232, v232, v25
    v_dot2_f32_bf16 v24, v233, s80, v24
    v_dot2_f32_bf16 v25, v233, v233, v25
    v_dot2_f32_bf16 v24, v234, s80, v24
    v_dot2_f32_bf16 v25, v234, v234, v25
    v_dot2_f32_bf16 v24, v235, s80, v24
    v_dot2_f32_bf16 v25, v235, v235, v25
    s_waitcnt lgkmcnt(2)
    s_nop 0
    v_dot2_f32_bf16 v24, v236, s80, v24
    v_dot2_f32_bf16 v25, v236, v236, v25
    v_dot2_f32_bf16 v24, v237, s80, v24
    v_dot2_f32_bf16 v25, v237, v237, v25
    v_dot2_f32_bf16 v24, v238, s80, v24
    v_dot2_f32_bf16 v25, v238, v238, v25
    v_dot2_f32_bf16 v24, v239, s80, v24
    v_dot2_f32_bf16 v25, v239, v239, v25
    s_waitcnt vmcnt(0)
    ds_read_b128 v[248:251], v124 offset:18432
    ds_read_b128 v[252:255], v125 offset:18432
    s_waitcnt lgkmcnt(3)
    v_dot2_f32_bf16 v24, v240, s80, v24
    v_dot2_f32_bf16 v25, v240, v240, v25
    v_dot2_f32_bf16 v24, v241, s80, v24
    v_dot2_f32_bf16 v25, v241, v241, v25
    v_dot2_f32_bf16 v24, v242, s80, v24
    v_dot2_f32_bf16 v25, v242, v242, v25
    v_dot2_f32_bf16 v24, v243, s80, v24
    v_dot2_f32_bf16 v25, v243, v243, v25
    s_waitcnt lgkmcnt(2)
    s_nop 0
    v_dot2_f32_bf16 v24, v244, s80, v24
    v_dot2_f32_bf16 v25, v244, v244, v25
    v_dot2_f32_bf16 v24, v245, s80, v24
    v_dot2_f32_bf16 v25, v245, v245, v25
    v_dot2_f32_bf16 v24, v246, s80, v24
    v_dot2_f32_bf16 v25, v246, v246, v25
    v_dot2_f32_bf16 v24, v247, s80, v24
    v_dot2_f32_bf16 v25, v247, v247, v25
    s_waitcnt lgkmcnt(1)
    s_nop 0
    v_dot2_f32_bf16 v24, v248, s80, v24
    v_dot2_f32_bf16 v25, v248, v248, v25
    v_dot2_f32_bf16 v24, v249, s80, v24
    v_dot2_f32_bf16 v25, v249, v249, v25
    v_dot2_f32_bf16 v24, v250, s80, v24
    v_dot2_f32_bf16 v25, v250, v250, v25
    v_dot2_f32_bf16 v24, v251, s80, v24
    v_dot2_f32_bf16 v25, v251, v251, v25
    s_waitcnt lgkmcnt(0)
    s_nop 0
    v_dot2_f32_bf16 v24, v252, s80, v24
    v_dot2_f32_bf16 v25, v252, v252, v25
    v_dot2_f32_bf16 v24, v253, s80, v24
    v_dot2_f32_bf16 v25, v253, v253, v25
    v_dot2_f32_bf16 v24, v254, s80, v24
    v_dot2_f32_bf16 v25, v254, v254, v25
    v_dot2_f32_bf16 v24, v255, s80, v24
    v_dot2_f32_bf16 v25, v255, v255, v25
    s_nop 1
    v_mov_b32 v26, v24
    v_mov_b32 v27, v25
    s_barrier
    v_permlane16_swap_b32 v26, v24
    v_permlane16_swap_b32 v27, v25
    v_pk_add_f32 v[24:25], v[24:25], v[26:27]
    v_mov_b32 v26, v24
    v_mov_b32_e64 v27, v25
    s_nop 0
    v_permlane32_swap_b32 v26, v24
    v_permlane32_swap_b32 v27, v25
    v_pk_add_f32 v[24:25], v[24:25], v[26:27]
    v_mul_f32 v24, 0x3acccccd, v24
    v_mul_f32 v25, 0x3acccccd, v25
    v_fma_f32 v25, -v24, v24, v25
    v_max_f32_e64 v25, 0, v25
    v_cvt_pk_bf16_f32 v25, 0, v25
    v_add_f32 v25, 0x3727c5ac, v25
    v_cvt_pk_bf16_f32 v25, 0, v25
    v_sqrt_f32_e64 v25, v25
    v_cvt_pk_bf16_f32 v24, 0, v24
    v_cvt_pk_bf16_f32 v25, 0, v25
    v_rcp_f32_e64 v28, v25
    v_xor_b32 v24, 0x80000000, v24
    s_mov_b32 s90, 0x3f80
    s_mov_b32 s91, 0x3f800000
    s_nop 0
    v_dot2_f32_bf16 v48, v176, s90, v24
    v_dot2_f32_bf16 v49, v176, s91, v24
    v_dot2_f32_bf16 v50, v177, s90, v24
    v_dot2_f32_bf16 v51, v177, s91, v24
    v_dot2_f32_bf16 v52, v178, s90, v24
    v_dot2_f32_bf16 v53, v178, s91, v24
    v_dot2_f32_bf16 v54, v179, s90, v24
    v_dot2_f32_bf16 v55, v179, s91, v24
    v_dot2_f32_bf16 v56, v180, s90, v24
    v_dot2_f32_bf16 v57, v180, s91, v24
    v_dot2_f32_bf16 v58, v181, s90, v24
    v_dot2_f32_bf16 v59, v181, s91, v24
    v_dot2_f32_bf16 v60, v182, s90, v24
    v_dot2_f32_bf16 v61, v182, s91, v24
    v_dot2_f32_bf16 v62, v183, s90, v24
    v_dot2_f32_bf16 v63, v183, s91, v24
    v_cvt_pk_bf16_f32 v48, 0, v48
    v_cvt_pk_bf16_f32 v49, 0, v49
    v_cvt_pk_bf16_f32 v50, 0, v50
    v_cvt_pk_bf16_f32 v51, 0, v51
    v_cvt_pk_bf16_f32 v52, 0, v52
    v_cvt_pk_bf16_f32 v53, 0, v53
    v_cvt_pk_bf16_f32 v54, 0, v54
    v_cvt_pk_bf16_f32 v55, 0, v55
    v_cvt_pk_bf16_f32 v56, 0, v56
    v_cvt_pk_bf16_f32 v57, 0, v57
    v_cvt_pk_bf16_f32 v58, 0, v58
    v_cvt_pk_bf16_f32 v59, 0, v59
    v_cvt_pk_bf16_f32 v60, 0, v60
    v_cvt_pk_bf16_f32 v61, 0, v61
    v_cvt_pk_bf16_f32 v62, 0, v62
    v_cvt_pk_bf16_f32 v63, 0, v63
    v_pk_mul_f32 v[48:49], v[48:49], v[28:29] op_sel_hi:[1,0]
    v_pk_mul_f32 v[50:51], v[50:51], v[28:29] op_sel_hi:[1,0]
    v_pk_mul_f32 v[52:53], v[52:53], v[28:29] op_sel_hi:[1,0]
    v_pk_mul_f32 v[54:55], v[54:55], v[28:29] op_sel_hi:[1,0]
    v_pk_mul_f32 v[56:57], v[56:57], v[28:29] op_sel_hi:[1,0]
    v_pk_mul_f32 v[58:59], v[58:59], v[28:29] op_sel_hi:[1,0]
    v_pk_mul_f32 v[60:61], v[60:61], v[28:29] op_sel_hi:[1,0]
    v_pk_mul_f32 v[62:63], v[62:63], v[28:29] op_sel_hi:[1,0]
    v_cvt_pk_bf16_f32 v176, v48, v49
    v_cvt_pk_bf16_f32 v177, v50, v51
    v_cvt_pk_bf16_f32 v178, v52, v53
    v_cvt_pk_bf16_f32 v179, v54, v55
    v_cvt_pk_bf16_f32 v180, v56, v57
    v_cvt_pk_bf16_f32 v181, v58, v59
    v_cvt_pk_bf16_f32 v182, v60, v61
    v_cvt_pk_bf16_f32 v183, v62, v63
    v_dot2_f32_bf16 v48, v184, s90, v24
    v_dot2_f32_bf16 v49, v184, s91, v24
    v_dot2_f32_bf16 v50, v185, s90, v24
    v_dot2_f32_bf16 v51, v185, s91, v24
    v_dot2_f32_bf16 v52, v186, s90, v24
    v_dot2_f32_bf16 v53, v186, s91, v24
    v_dot2_f32_bf16 v54, v187, s90, v24
    v_dot2_f32_bf16 v55, v187, s91, v24
    v_dot2_f32_bf16 v56, v188, s90, v24
    v_dot2_f32_bf16 v57, v188, s91, v24
    v_dot2_f32_bf16 v58, v189, s90, v24
    v_dot2_f32_bf16 v59, v189, s91, v24
    v_dot2_f32_bf16 v60, v190, s90, v24
    v_dot2_f32_bf16 v61, v190, s91, v24
    v_dot2_f32_bf16 v62, v191, s90, v24
    v_dot2_f32_bf16 v63, v191, s91, v24
    v_cvt_pk_bf16_f32 v48, 0, v48
    v_cvt_pk_bf16_f32 v49, 0, v49
    v_cvt_pk_bf16_f32 v50, 0, v50
    v_cvt_pk_bf16_f32 v51, 0, v51
    v_cvt_pk_bf16_f32 v52, 0, v52
    v_cvt_pk_bf16_f32 v53, 0, v53
    v_cvt_pk_bf16_f32 v54, 0, v54
    v_cvt_pk_bf16_f32 v55, 0, v55
    v_cvt_pk_bf16_f32 v56, 0, v56
    v_cvt_pk_bf16_f32 v57, 0, v57
    v_cvt_pk_bf16_f32 v58, 0, v58
    v_cvt_pk_bf16_f32 v59, 0, v59
    v_cvt_pk_bf16_f32 v60, 0, v60
    v_cvt_pk_bf16_f32 v61, 0, v61
    v_cvt_pk_bf16_f32 v62, 0, v62
    v_cvt_pk_bf16_f32 v63, 0, v63
    v_pk_mul_f32 v[48:49], v[48:49], v[28:29] op_sel_hi:[1,0]
    v_pk_mul_f32 v[50:51], v[50:51], v[28:29] op_sel_hi:[1,0]
    v_pk_mul_f32 v[52:53], v[52:53], v[28:29] op_sel_hi:[1,0]
    v_pk_mul_f32 v[54:55], v[54:55], v[28:29] op_sel_hi:[1,0]
    v_pk_mul_f32 v[56:57], v[56:57], v[28:29] op_sel_hi:[1,0]
    v_pk_mul_f32 v[58:59], v[58:59], v[28:29] op_sel_hi:[1,0]
    v_pk_mul_f32 v[60:61], v[60:61], v[28:29] op_sel_hi:[1,0]
    v_pk_mul_f32 v[62:63], v[62:63], v[28:29] op_sel_hi:[1,0]
    v_cvt_pk_bf16_f32 v184, v48, v49
    v_cvt_pk_bf16_f32 v185, v50, v51
    v_cvt_pk_bf16_f32 v186, v52, v53
    v_cvt_pk_bf16_f32 v187, v54, v55
    v_cvt_pk_bf16_f32 v188, v56, v57
    v_cvt_pk_bf16_f32 v189, v58, v59
    v_cvt_pk_bf16_f32 v190, v60, v61
    v_cvt_pk_bf16_f32 v191, v62, v63
    v_dot2_f32_bf16 v48, v192, s90, v24
    v_dot2_f32_bf16 v49, v192, s91, v24
    v_dot2_f32_bf16 v50, v193, s90, v24
    v_dot2_f32_bf16 v51, v193, s91, v24
    v_dot2_f32_bf16 v52, v194, s90, v24
    v_dot2_f32_bf16 v53, v194, s91, v24
    v_dot2_f32_bf16 v54, v195, s90, v24
    v_dot2_f32_bf16 v55, v195, s91, v24
    v_dot2_f32_bf16 v56, v196, s90, v24
    v_dot2_f32_bf16 v57, v196, s91, v24
    v_dot2_f32_bf16 v58, v197, s90, v24
    v_dot2_f32_bf16 v59, v197, s91, v24
    v_dot2_f32_bf16 v60, v198, s90, v24
    v_dot2_f32_bf16 v61, v198, s91, v24
    v_dot2_f32_bf16 v62, v199, s90, v24
    v_dot2_f32_bf16 v63, v199, s91, v24
    v_cvt_pk_bf16_f32 v48, 0, v48
    v_cvt_pk_bf16_f32 v49, 0, v49
    v_cvt_pk_bf16_f32 v50, 0, v50
    v_cvt_pk_bf16_f32 v51, 0, v51
    v_cvt_pk_bf16_f32 v52, 0, v52
    v_cvt_pk_bf16_f32 v53, 0, v53
    v_cvt_pk_bf16_f32 v54, 0, v54
    v_cvt_pk_bf16_f32 v55, 0, v55
    v_cvt_pk_bf16_f32 v56, 0, v56
    v_cvt_pk_bf16_f32 v57, 0, v57
    v_cvt_pk_bf16_f32 v58, 0, v58
    v_cvt_pk_bf16_f32 v59, 0, v59
    v_cvt_pk_bf16_f32 v60, 0, v60
    v_cvt_pk_bf16_f32 v61, 0, v61
    v_cvt_pk_bf16_f32 v62, 0, v62
    v_cvt_pk_bf16_f32 v63, 0, v63
    v_pk_mul_f32 v[48:49], v[48:49], v[28:29] op_sel_hi:[1,0]
    v_pk_mul_f32 v[50:51], v[50:51], v[28:29] op_sel_hi:[1,0]
    v_pk_mul_f32 v[52:53], v[52:53], v[28:29] op_sel_hi:[1,0]
    v_pk_mul_f32 v[54:55], v[54:55], v[28:29] op_sel_hi:[1,0]
    v_pk_mul_f32 v[56:57], v[56:57], v[28:29] op_sel_hi:[1,0]
    v_pk_mul_f32 v[58:59], v[58:59], v[28:29] op_sel_hi:[1,0]
    v_pk_mul_f32 v[60:61], v[60:61], v[28:29] op_sel_hi:[1,0]
    v_pk_mul_f32 v[62:63], v[62:63], v[28:29] op_sel_hi:[1,0]
    v_cvt_pk_bf16_f32 v192, v48, v49
    v_cvt_pk_bf16_f32 v193, v50, v51
    v_cvt_pk_bf16_f32 v194, v52, v53
    v_cvt_pk_bf16_f32 v195, v54, v55
    v_cvt_pk_bf16_f32 v196, v56, v57
    v_cvt_pk_bf16_f32 v197, v58, v59
    v_cvt_pk_bf16_f32 v198, v60, v61
    v_cvt_pk_bf16_f32 v199, v62, v63
    v_dot2_f32_bf16 v48, v200, s90, v24
    v_dot2_f32_bf16 v49, v200, s91, v24
    v_dot2_f32_bf16 v50, v201, s90, v24
    v_dot2_f32_bf16 v51, v201, s91, v24
    v_dot2_f32_bf16 v52, v202, s90, v24
    v_dot2_f32_bf16 v53, v202, s91, v24
    v_dot2_f32_bf16 v54, v203, s90, v24
    v_dot2_f32_bf16 v55, v203, s91, v24
    v_dot2_f32_bf16 v56, v204, s90, v24
    v_dot2_f32_bf16 v57, v204, s91, v24
    v_dot2_f32_bf16 v58, v205, s90, v24
    v_dot2_f32_bf16 v59, v205, s91, v24
    v_dot2_f32_bf16 v60, v206, s90, v24
    v_dot2_f32_bf16 v61, v206, s91, v24
    v_dot2_f32_bf16 v62, v207, s90, v24
    v_dot2_f32_bf16 v63, v207, s91, v24
    v_cvt_pk_bf16_f32 v48, 0, v48
    v_cvt_pk_bf16_f32 v49, 0, v49
    v_cvt_pk_bf16_f32 v50, 0, v50
    v_cvt_pk_bf16_f32 v51, 0, v51
    v_cvt_pk_bf16_f32 v52, 0, v52
    v_cvt_pk_bf16_f32 v53, 0, v53
    v_cvt_pk_bf16_f32 v54, 0, v54
    v_cvt_pk_bf16_f32 v55, 0, v55
    v_cvt_pk_bf16_f32 v56, 0, v56
    v_cvt_pk_bf16_f32 v57, 0, v57
    v_cvt_pk_bf16_f32 v58, 0, v58
    v_cvt_pk_bf16_f32 v59, 0, v59
    v_cvt_pk_bf16_f32 v60, 0, v60
    v_cvt_pk_bf16_f32 v61, 0, v61
    v_cvt_pk_bf16_f32 v62, 0, v62
    v_cvt_pk_bf16_f32 v63, 0, v63
    v_pk_mul_f32 v[48:49], v[48:49], v[28:29] op_sel_hi:[1,0]
    v_pk_mul_f32 v[50:51], v[50:51], v[28:29] op_sel_hi:[1,0]
    v_pk_mul_f32 v[52:53], v[52:53], v[28:29] op_sel_hi:[1,0]
    v_pk_mul_f32 v[54:55], v[54:55], v[28:29] op_sel_hi:[1,0]
    v_pk_mul_f32 v[56:57], v[56:57], v[28:29] op_sel_hi:[1,0]
    v_pk_mul_f32 v[58:59], v[58:59], v[28:29] op_sel_hi:[1,0]
    v_pk_mul_f32 v[60:61], v[60:61], v[28:29] op_sel_hi:[1,0]
    v_pk_mul_f32 v[62:63], v[62:63], v[28:29] op_sel_hi:[1,0]
    v_cvt_pk_bf16_f32 v200, v48, v49
    v_cvt_pk_bf16_f32 v201, v50, v51
    v_cvt_pk_bf16_f32 v202, v52, v53
    v_cvt_pk_bf16_f32 v203, v54, v55
    v_cvt_pk_bf16_f32 v204, v56, v57
    v_cvt_pk_bf16_f32 v205, v58, v59
    v_cvt_pk_bf16_f32 v206, v60, v61
    v_cvt_pk_bf16_f32 v207, v62, v63
    v_dot2_f32_bf16 v48, v208, s90, v24
    v_dot2_f32_bf16 v49, v208, s91, v24
    v_dot2_f32_bf16 v50, v209, s90, v24
    v_dot2_f32_bf16 v51, v209, s91, v24
    v_dot2_f32_bf16 v52, v210, s90, v24
    v_dot2_f32_bf16 v53, v210, s91, v24
    v_dot2_f32_bf16 v54, v211, s90, v24
    v_dot2_f32_bf16 v55, v211, s91, v24
    v_dot2_f32_bf16 v56, v212, s90, v24
    v_dot2_f32_bf16 v57, v212, s91, v24
    v_dot2_f32_bf16 v58, v213, s90, v24
    v_dot2_f32_bf16 v59, v213, s91, v24
    v_dot2_f32_bf16 v60, v214, s90, v24
    v_dot2_f32_bf16 v61, v214, s91, v24
    v_dot2_f32_bf16 v62, v215, s90, v24
    v_dot2_f32_bf16 v63, v215, s91, v24
    v_cvt_pk_bf16_f32 v48, 0, v48
    v_cvt_pk_bf16_f32 v49, 0, v49
    v_cvt_pk_bf16_f32 v50, 0, v50
    v_cvt_pk_bf16_f32 v51, 0, v51
    v_cvt_pk_bf16_f32 v52, 0, v52
    v_cvt_pk_bf16_f32 v53, 0, v53
    v_cvt_pk_bf16_f32 v54, 0, v54
    v_cvt_pk_bf16_f32 v55, 0, v55
    v_cvt_pk_bf16_f32 v56, 0, v56
    v_cvt_pk_bf16_f32 v57, 0, v57
    v_cvt_pk_bf16_f32 v58, 0, v58
    v_cvt_pk_bf16_f32 v59, 0, v59
    v_cvt_pk_bf16_f32 v60, 0, v60
    v_cvt_pk_bf16_f32 v61, 0, v61
    v_cvt_pk_bf16_f32 v62, 0, v62
    v_cvt_pk_bf16_f32 v63, 0, v63
    v_pk_mul_f32 v[48:49], v[48:49], v[28:29] op_sel_hi:[1,0]
    v_pk_mul_f32 v[50:51], v[50:51], v[28:29] op_sel_hi:[1,0]
    v_pk_mul_f32 v[52:53], v[52:53], v[28:29] op_sel_hi:[1,0]
    v_pk_mul_f32 v[54:55], v[54:55], v[28:29] op_sel_hi:[1,0]
    v_pk_mul_f32 v[56:57], v[56:57], v[28:29] op_sel_hi:[1,0]
    v_pk_mul_f32 v[58:59], v[58:59], v[28:29] op_sel_hi:[1,0]
    v_pk_mul_f32 v[60:61], v[60:61], v[28:29] op_sel_hi:[1,0]
    v_pk_mul_f32 v[62:63], v[62:63], v[28:29] op_sel_hi:[1,0]
    v_cvt_pk_bf16_f32 v208, v48, v49
    v_cvt_pk_bf16_f32 v209, v50, v51
    v_cvt_pk_bf16_f32 v210, v52, v53
    v_cvt_pk_bf16_f32 v211, v54, v55
    v_cvt_pk_bf16_f32 v212, v56, v57
    v_cvt_pk_bf16_f32 v213, v58, v59
    v_cvt_pk_bf16_f32 v214, v60, v61
    v_cvt_pk_bf16_f32 v215, v62, v63
    v_dot2_f32_bf16 v48, v216, s90, v24
    v_dot2_f32_bf16 v49, v216, s91, v24
    v_dot2_f32_bf16 v50, v217, s90, v24
    v_dot2_f32_bf16 v51, v217, s91, v24
    v_dot2_f32_bf16 v52, v218, s90, v24
    v_dot2_f32_bf16 v53, v218, s91, v24
    v_dot2_f32_bf16 v54, v219, s90, v24
    v_dot2_f32_bf16 v55, v219, s91, v24
    v_dot2_f32_bf16 v56, v220, s90, v24
    v_dot2_f32_bf16 v57, v220, s91, v24
    v_dot2_f32_bf16 v58, v221, s90, v24
    v_dot2_f32_bf16 v59, v221, s91, v24
    v_dot2_f32_bf16 v60, v222, s90, v24
    v_dot2_f32_bf16 v61, v222, s91, v24
    v_dot2_f32_bf16 v62, v223, s90, v24
    v_dot2_f32_bf16 v63, v223, s91, v24
    v_cvt_pk_bf16_f32 v48, 0, v48
    v_cvt_pk_bf16_f32 v49, 0, v49
    v_cvt_pk_bf16_f32 v50, 0, v50
    v_cvt_pk_bf16_f32 v51, 0, v51
    v_cvt_pk_bf16_f32 v52, 0, v52
    v_cvt_pk_bf16_f32 v53, 0, v53
    v_cvt_pk_bf16_f32 v54, 0, v54
    v_cvt_pk_bf16_f32 v55, 0, v55
    v_cvt_pk_bf16_f32 v56, 0, v56
    v_cvt_pk_bf16_f32 v57, 0, v57
    v_cvt_pk_bf16_f32 v58, 0, v58
    v_cvt_pk_bf16_f32 v59, 0, v59
    v_cvt_pk_bf16_f32 v60, 0, v60
    v_cvt_pk_bf16_f32 v61, 0, v61
    v_cvt_pk_bf16_f32 v62, 0, v62
    v_cvt_pk_bf16_f32 v63, 0, v63
    v_pk_mul_f32 v[48:49], v[48:49], v[28:29] op_sel_hi:[1,0]
    v_pk_mul_f32 v[50:51], v[50:51], v[28:29] op_sel_hi:[1,0]
    v_pk_mul_f32 v[52:53], v[52:53], v[28:29] op_sel_hi:[1,0]
    v_pk_mul_f32 v[54:55], v[54:55], v[28:29] op_sel_hi:[1,0]
    v_pk_mul_f32 v[56:57], v[56:57], v[28:29] op_sel_hi:[1,0]
    v_pk_mul_f32 v[58:59], v[58:59], v[28:29] op_sel_hi:[1,0]
    v_pk_mul_f32 v[60:61], v[60:61], v[28:29] op_sel_hi:[1,0]
    v_pk_mul_f32 v[62:63], v[62:63], v[28:29] op_sel_hi:[1,0]
    v_cvt_pk_bf16_f32 v216, v48, v49
    v_cvt_pk_bf16_f32 v217, v50, v51
    v_cvt_pk_bf16_f32 v218, v52, v53
    v_cvt_pk_bf16_f32 v219, v54, v55
    v_cvt_pk_bf16_f32 v220, v56, v57
    v_cvt_pk_bf16_f32 v221, v58, v59
    v_cvt_pk_bf16_f32 v222, v60, v61
    v_cvt_pk_bf16_f32 v223, v62, v63
    v_dot2_f32_bf16 v48, v224, s90, v24
    v_dot2_f32_bf16 v49, v224, s91, v24
    v_dot2_f32_bf16 v50, v225, s90, v24
    v_dot2_f32_bf16 v51, v225, s91, v24
    v_dot2_f32_bf16 v52, v226, s90, v24
    v_dot2_f32_bf16 v53, v226, s91, v24
    v_dot2_f32_bf16 v54, v227, s90, v24
    v_dot2_f32_bf16 v55, v227, s91, v24
    v_dot2_f32_bf16 v56, v228, s90, v24
    v_dot2_f32_bf16 v57, v228, s91, v24
    v_dot2_f32_bf16 v58, v229, s90, v24
    v_dot2_f32_bf16 v59, v229, s91, v24
    v_dot2_f32_bf16 v60, v230, s90, v24
    v_dot2_f32_bf16 v61, v230, s91, v24
    v_dot2_f32_bf16 v62, v231, s90, v24
    v_dot2_f32_bf16 v63, v231, s91, v24
    v_cvt_pk_bf16_f32 v48, 0, v48
    v_cvt_pk_bf16_f32 v49, 0, v49
    v_cvt_pk_bf16_f32 v50, 0, v50
    v_cvt_pk_bf16_f32 v51, 0, v51
    v_cvt_pk_bf16_f32 v52, 0, v52
    v_cvt_pk_bf16_f32 v53, 0, v53
    v_cvt_pk_bf16_f32 v54, 0, v54
    v_cvt_pk_bf16_f32 v55, 0, v55
    v_cvt_pk_bf16_f32 v56, 0, v56
    v_cvt_pk_bf16_f32 v57, 0, v57
    v_cvt_pk_bf16_f32 v58, 0, v58
    v_cvt_pk_bf16_f32 v59, 0, v59
    v_cvt_pk_bf16_f32 v60, 0, v60
    v_cvt_pk_bf16_f32 v61, 0, v61
    v_cvt_pk_bf16_f32 v62, 0, v62
    v_cvt_pk_bf16_f32 v63, 0, v63
    v_pk_mul_f32 v[48:49], v[48:49], v[28:29] op_sel_hi:[1,0]
    v_pk_mul_f32 v[50:51], v[50:51], v[28:29] op_sel_hi:[1,0]
    v_pk_mul_f32 v[52:53], v[52:53], v[28:29] op_sel_hi:[1,0]
    v_pk_mul_f32 v[54:55], v[54:55], v[28:29] op_sel_hi:[1,0]
    v_pk_mul_f32 v[56:57], v[56:57], v[28:29] op_sel_hi:[1,0]
    v_pk_mul_f32 v[58:59], v[58:59], v[28:29] op_sel_hi:[1,0]
    v_pk_mul_f32 v[60:61], v[60:61], v[28:29] op_sel_hi:[1,0]
    v_pk_mul_f32 v[62:63], v[62:63], v[28:29] op_sel_hi:[1,0]
    v_cvt_pk_bf16_f32 v224, v48, v49
    v_cvt_pk_bf16_f32 v225, v50, v51
    v_cvt_pk_bf16_f32 v226, v52, v53
    v_cvt_pk_bf16_f32 v227, v54, v55
    v_cvt_pk_bf16_f32 v228, v56, v57
    v_cvt_pk_bf16_f32 v229, v58, v59
    v_cvt_pk_bf16_f32 v230, v60, v61
    v_cvt_pk_bf16_f32 v231, v62, v63
    v_dot2_f32_bf16 v48, v232, s90, v24
    v_dot2_f32_bf16 v49, v232, s91, v24
    v_dot2_f32_bf16 v50, v233, s90, v24
    v_dot2_f32_bf16 v51, v233, s91, v24
    v_dot2_f32_bf16 v52, v234, s90, v24
    v_dot2_f32_bf16 v53, v234, s91, v24
    v_dot2_f32_bf16 v54, v235, s90, v24
    v_dot2_f32_bf16 v55, v235, s91, v24
    v_dot2_f32_bf16 v56, v236, s90, v24
    v_dot2_f32_bf16 v57, v236, s91, v24
    v_dot2_f32_bf16 v58, v237, s90, v24
    v_dot2_f32_bf16 v59, v237, s91, v24
    v_dot2_f32_bf16 v60, v238, s90, v24
    v_dot2_f32_bf16 v61, v238, s91, v24
    v_dot2_f32_bf16 v62, v239, s90, v24
    v_dot2_f32_bf16 v63, v239, s91, v24
    v_cvt_pk_bf16_f32 v48, 0, v48
    v_cvt_pk_bf16_f32 v49, 0, v49
    v_cvt_pk_bf16_f32 v50, 0, v50
    v_cvt_pk_bf16_f32 v51, 0, v51
    v_cvt_pk_bf16_f32 v52, 0, v52
    v_cvt_pk_bf16_f32 v53, 0, v53
    v_cvt_pk_bf16_f32 v54, 0, v54
    v_cvt_pk_bf16_f32 v55, 0, v55
    v_cvt_pk_bf16_f32 v56, 0, v56
    v_cvt_pk_bf16_f32 v57, 0, v57
    v_cvt_pk_bf16_f32 v58, 0, v58
    v_cvt_pk_bf16_f32 v59, 0, v59
    v_cvt_pk_bf16_f32 v60, 0, v60
    v_cvt_pk_bf16_f32 v61, 0, v61
    v_cvt_pk_bf16_f32 v62, 0, v62
    v_cvt_pk_bf16_f32 v63, 0, v63
    v_pk_mul_f32 v[48:49], v[48:49], v[28:29] op_sel_hi:[1,0]
    v_pk_mul_f32 v[50:51], v[50:51], v[28:29] op_sel_hi:[1,0]
    v_pk_mul_f32 v[52:53], v[52:53], v[28:29] op_sel_hi:[1,0]
    v_pk_mul_f32 v[54:55], v[54:55], v[28:29] op_sel_hi:[1,0]
    v_pk_mul_f32 v[56:57], v[56:57], v[28:29] op_sel_hi:[1,0]
    v_pk_mul_f32 v[58:59], v[58:59], v[28:29] op_sel_hi:[1,0]
    v_pk_mul_f32 v[60:61], v[60:61], v[28:29] op_sel_hi:[1,0]
    v_pk_mul_f32 v[62:63], v[62:63], v[28:29] op_sel_hi:[1,0]
    v_cvt_pk_bf16_f32 v232, v48, v49
    v_cvt_pk_bf16_f32 v233, v50, v51
    v_cvt_pk_bf16_f32 v234, v52, v53
    v_cvt_pk_bf16_f32 v235, v54, v55
    v_cvt_pk_bf16_f32 v236, v56, v57
    v_cvt_pk_bf16_f32 v237, v58, v59
    v_cvt_pk_bf16_f32 v238, v60, v61
    v_cvt_pk_bf16_f32 v239, v62, v63
    v_dot2_f32_bf16 v48, v240, s90, v24
    v_dot2_f32_bf16 v49, v240, s91, v24
    v_dot2_f32_bf16 v50, v241, s90, v24
    v_dot2_f32_bf16 v51, v241, s91, v24
    v_dot2_f32_bf16 v52, v242, s90, v24
    v_dot2_f32_bf16 v53, v242, s91, v24
    v_dot2_f32_bf16 v54, v243, s90, v24
    v_dot2_f32_bf16 v55, v243, s91, v24
    v_dot2_f32_bf16 v56, v244, s90, v24
    v_dot2_f32_bf16 v57, v244, s91, v24
    v_dot2_f32_bf16 v58, v245, s90, v24
    v_dot2_f32_bf16 v59, v245, s91, v24
    v_dot2_f32_bf16 v60, v246, s90, v24
    v_dot2_f32_bf16 v61, v246, s91, v24
    v_dot2_f32_bf16 v62, v247, s90, v24
    v_dot2_f32_bf16 v63, v247, s91, v24
    v_cvt_pk_bf16_f32 v48, 0, v48
    v_cvt_pk_bf16_f32 v49, 0, v49
    v_cvt_pk_bf16_f32 v50, 0, v50
    v_cvt_pk_bf16_f32 v51, 0, v51
    v_cvt_pk_bf16_f32 v52, 0, v52
    v_cvt_pk_bf16_f32 v53, 0, v53
    v_cvt_pk_bf16_f32 v54, 0, v54
    v_cvt_pk_bf16_f32 v55, 0, v55
    v_cvt_pk_bf16_f32 v56, 0, v56
    v_cvt_pk_bf16_f32 v57, 0, v57
    v_cvt_pk_bf16_f32 v58, 0, v58
    v_cvt_pk_bf16_f32 v59, 0, v59
    v_cvt_pk_bf16_f32 v60, 0, v60
    v_cvt_pk_bf16_f32 v61, 0, v61
    v_cvt_pk_bf16_f32 v62, 0, v62
    v_cvt_pk_bf16_f32 v63, 0, v63
    v_pk_mul_f32 v[48:49], v[48:49], v[28:29] op_sel_hi:[1,0]
    v_pk_mul_f32 v[50:51], v[50:51], v[28:29] op_sel_hi:[1,0]
    v_pk_mul_f32 v[52:53], v[52:53], v[28:29] op_sel_hi:[1,0]
    v_pk_mul_f32 v[54:55], v[54:55], v[28:29] op_sel_hi:[1,0]
    v_pk_mul_f32 v[56:57], v[56:57], v[28:29] op_sel_hi:[1,0]
    v_pk_mul_f32 v[58:59], v[58:59], v[28:29] op_sel_hi:[1,0]
    v_pk_mul_f32 v[60:61], v[60:61], v[28:29] op_sel_hi:[1,0]
    v_pk_mul_f32 v[62:63], v[62:63], v[28:29] op_sel_hi:[1,0]
    v_cvt_pk_bf16_f32 v240, v48, v49
    v_cvt_pk_bf16_f32 v241, v50, v51
    v_cvt_pk_bf16_f32 v242, v52, v53
    v_cvt_pk_bf16_f32 v243, v54, v55
    v_cvt_pk_bf16_f32 v244, v56, v57
    v_cvt_pk_bf16_f32 v245, v58, v59
    v_cvt_pk_bf16_f32 v246, v60, v61
    v_cvt_pk_bf16_f32 v247, v62, v63
    s_barrier
    s_nop 0
    ds_read_b64_tr_b16 v[120:121], v6 offset:0
    ds_read_b64_tr_b16 v[122:123], v6 offset:1280
    ds_read_b64_tr_b16 v[124:125], v6 offset:8
    ds_read_b64_tr_b16 v[126:127], v6 offset:1288
    ds_read_b64_tr_b16 v[128:129], v6 offset:16
    ds_read_b64_tr_b16 v[130:131], v6 offset:1296
    ds_read_b64_tr_b16 v[132:133], v6 offset:24
    ds_read_b64_tr_b16 v[134:135], v6 offset:1304
    ds_read_b64_tr_b16 v[136:137], v6 offset:32
    ds_read_b64_tr_b16 v[138:139], v6 offset:1312
    ds_read_b64_tr_b16 v[140:141], v6 offset:5120
    ds_read_b64_tr_b16 v[142:143], v6 offset:6400
    ds_read_b64_tr_b16 v[144:145], v6 offset:5128
    ds_read_b64_tr_b16 v[146:147], v6 offset:6408
    ds_read_b64_tr_b16 v[148:149], v6 offset:5136
    ds_read_b64_tr_b16 v[150:151], v6 offset:6416
    ds_read_b64_tr_b16 v[152:153], v6 offset:5144
    ds_read_b64_tr_b16 v[154:155], v6 offset:6424
    ds_read_b64_tr_b16 v[156:157], v6 offset:5152
    ds_read_b64_tr_b16 v[158:159], v6 offset:6432
    v_dot2_f32_bf16 v48, v248, s90, v24
    v_dot2_f32_bf16 v49, v248, s91, v24
    v_dot2_f32_bf16 v50, v249, s90, v24
    v_dot2_f32_bf16 v51, v249, s91, v24
    v_dot2_f32_bf16 v52, v250, s90, v24
    v_dot2_f32_bf16 v53, v250, s91, v24
    v_dot2_f32_bf16 v54, v251, s90, v24
    v_dot2_f32_bf16 v55, v251, s91, v24
    v_dot2_f32_bf16 v56, v252, s90, v24
    v_dot2_f32_bf16 v57, v252, s91, v24
    v_dot2_f32_bf16 v58, v253, s90, v24
    v_dot2_f32_bf16 v59, v253, s91, v24
    v_dot2_f32_bf16 v60, v254, s90, v24
    v_dot2_f32_bf16 v61, v254, s91, v24
    v_dot2_f32_bf16 v62, v255, s90, v24
    v_dot2_f32_bf16 v63, v255, s91, v24
    v_cvt_pk_bf16_f32 v48, 0, v48
    v_cvt_pk_bf16_f32 v49, 0, v49
    v_cvt_pk_bf16_f32 v50, 0, v50
    v_cvt_pk_bf16_f32 v51, 0, v51
    v_cvt_pk_bf16_f32 v52, 0, v52
    v_cvt_pk_bf16_f32 v53, 0, v53
    v_cvt_pk_bf16_f32 v54, 0, v54
    v_cvt_pk_bf16_f32 v55, 0, v55
    v_cvt_pk_bf16_f32 v56, 0, v56
    v_cvt_pk_bf16_f32 v57, 0, v57
    v_cvt_pk_bf16_f32 v58, 0, v58
    v_cvt_pk_bf16_f32 v59, 0, v59
    v_cvt_pk_bf16_f32 v60, 0, v60
    v_cvt_pk_bf16_f32 v61, 0, v61
    v_cvt_pk_bf16_f32 v62, 0, v62
    v_cvt_pk_bf16_f32 v63, 0, v63
    v_pk_mul_f32 v[48:49], v[48:49], v[28:29] op_sel_hi:[1,0]
    v_pk_mul_f32 v[50:51], v[50:51], v[28:29] op_sel_hi:[1,0]
    v_pk_mul_f32 v[52:53], v[52:53], v[28:29] op_sel_hi:[1,0]
    v_pk_mul_f32 v[54:55], v[54:55], v[28:29] op_sel_hi:[1,0]
    v_pk_mul_f32 v[56:57], v[56:57], v[28:29] op_sel_hi:[1,0]
    v_pk_mul_f32 v[58:59], v[58:59], v[28:29] op_sel_hi:[1,0]
    v_pk_mul_f32 v[60:61], v[60:61], v[28:29] op_sel_hi:[1,0]
    v_pk_mul_f32 v[62:63], v[62:63], v[28:29] op_sel_hi:[1,0]
    v_cvt_pk_bf16_f32 v248, v48, v49
    v_cvt_pk_bf16_f32 v249, v50, v51
    v_cvt_pk_bf16_f32 v250, v52, v53
    v_cvt_pk_bf16_f32 v251, v54, v55
    v_cvt_pk_bf16_f32 v252, v56, v57
    v_cvt_pk_bf16_f32 v253, v58, v59
    v_cvt_pk_bf16_f32 v254, v60, v61
    v_cvt_pk_bf16_f32 v255, v62, v63
    s_waitcnt lgkmcnt(10)
    v_mfma_f32_16x16x32_bf16 v[24:27], v[120:123], v[176:179], 0
    ds_read_b64_tr_b16 v[160:161], v6 offset:10240
    ds_read_b64_tr_b16 v[162:163], v6 offset:11520
    v_mfma_f32_16x16x32_bf16 v[28:31], v[124:127], v[176:179], 0
    ds_read_b64_tr_b16 v[164:165], v6 offset:10248
    ds_read_b64_tr_b16 v[166:167], v6 offset:11528
    v_mfma_f32_16x16x32_bf16 v[32:35], v[128:131], v[176:179], 0
    ds_read_b64_tr_b16 v[168:169], v6 offset:10256
    ds_read_b64_tr_b16 v[170:171], v6 offset:11536
    v_mfma_f32_16x16x32_bf16 v[36:39], v[132:135], v[176:179], 0
    ds_read_b64_tr_b16 v[172:173], v6 offset:10264
    ds_read_b64_tr_b16 v[174:175], v6 offset:11544
    v_mfma_f32_16x16x32_bf16 v[40:43], v[136:139], v[176:179], 0
    ds_read_b64_tr_b16 v[120:121], v6 offset:10272
    ds_read_b64_tr_b16 v[122:123], v6 offset:11552
    s_waitcnt lgkmcnt(10)
    v_mfma_f32_16x16x32_bf16 v[24:27], v[140:143], v[180:183], v[24:27]
    ds_read_b64_tr_b16 v[124:125], v6 offset:15360
    ds_read_b64_tr_b16 v[126:127], v6 offset:16640
    v_mfma_f32_16x16x32_bf16 v[28:31], v[144:147], v[180:183], v[28:31]
    ds_read_b64_tr_b16 v[128:129], v6 offset:15368
    ds_read_b64_tr_b16 v[130:131], v6 offset:16648
    v_mfma_f32_16x16x32_bf16 v[32:35], v[148:151], v[180:183], v[32:35]
    ds_read_b64_tr_b16 v[132:133], v6 offset:15376
    ds_read_b64_tr_b16 v[134:135], v6 offset:16656
    v_mfma_f32_16x16x32_bf16 v[36:39], v[152:155], v[180:183], v[36:39]
    ds_read_b64_tr_b16 v[136:137], v6 offset:15384
    ds_read_b64_tr_b16 v[138:139], v6 offset:16664
    v_mfma_f32_16x16x32_bf16 v[40:43], v[156:159], v[180:183], v[40:43]
    ds_read_b64_tr_b16 v[140:141], v6 offset:15392
    ds_read_b64_tr_b16 v[142:143], v6 offset:16672
    s_waitcnt lgkmcnt(10)
    v_mfma_f32_16x16x32_bf16 v[24:27], v[160:163], v[184:187], v[24:27]
    s_barrier
    ds_read_b64_tr_b16 v[144:145], v6 offset:20480
    ds_read_b64_tr_b16 v[146:147], v6 offset:21760
    v_mfma_f32_16x16x32_bf16 v[28:31], v[164:167], v[184:187], v[28:31]
    ds_read_b64_tr_b16 v[148:149], v6 offset:20488
    ds_read_b64_tr_b16 v[150:151], v6 offset:21768
    v_mfma_f32_16x16x32_bf16 v[32:35], v[168:171], v[184:187], v[32:35]
    ds_read_b64_tr_b16 v[152:153], v6 offset:20496
    ds_read_b64_tr_b16 v[154:155], v6 offset:21776
    v_mfma_f32_16x16x32_bf16 v[36:39], v[172:175], v[184:187], v[36:39]
    ds_read_b64_tr_b16 v[156:157], v6 offset:20504
    ds_read_b64_tr_b16 v[158:159], v6 offset:21784
    v_mfma_f32_16x16x32_bf16 v[40:43], v[120:123], v[184:187], v[40:43]
    ds_read_b64_tr_b16 v[160:161], v6 offset:20512
    ds_read_b64_tr_b16 v[162:163], v6 offset:21792
    s_waitcnt lgkmcnt(10)
    v_mfma_f32_16x16x32_bf16 v[24:27], v[124:127], v[188:191], v[24:27]
    ds_read_b64_tr_b16 v[164:165], v6 offset:25600
    ds_read_b64_tr_b16 v[166:167], v6 offset:26880
    v_mfma_f32_16x16x32_bf16 v[28:31], v[128:131], v[188:191], v[28:31]
    ds_read_b64_tr_b16 v[168:169], v6 offset:25608
    ds_read_b64_tr_b16 v[170:171], v6 offset:26888
    v_mfma_f32_16x16x32_bf16 v[32:35], v[132:135], v[188:191], v[32:35]
    ds_read_b64_tr_b16 v[172:173], v6 offset:25616
    ds_read_b64_tr_b16 v[174:175], v6 offset:26896
    v_mfma_f32_16x16x32_bf16 v[36:39], v[136:139], v[188:191], v[36:39]
    ds_read_b64_tr_b16 v[120:121], v6 offset:25624
    ds_read_b64_tr_b16 v[122:123], v6 offset:26904
    v_mfma_f32_16x16x32_bf16 v[40:43], v[140:143], v[188:191], v[40:43]
    ds_read_b64_tr_b16 v[124:125], v6 offset:25632
    ds_read_b64_tr_b16 v[126:127], v6 offset:26912
    s_waitcnt lgkmcnt(10)
    v_mfma_f32_16x16x32_bf16 v[24:27], v[144:147], v[192:195], v[24:27]
    ds_read_b64_tr_b16 v[128:129], v6 offset:30720
    ds_read_b64_tr_b16 v[130:131], v6 offset:32000
    v_mfma_f32_16x16x32_bf16 v[28:31], v[148:151], v[192:195], v[28:31]
    ds_read_b64_tr_b16 v[132:133], v6 offset:30728
    ds_read_b64_tr_b16 v[134:135], v6 offset:32008
    v_mfma_f32_16x16x32_bf16 v[32:35], v[152:155], v[192:195], v[32:35]
    ds_read_b64_tr_b16 v[136:137], v6 offset:30736
    ds_read_b64_tr_b16 v[138:139], v6 offset:32016
    v_mfma_f32_16x16x32_bf16 v[36:39], v[156:159], v[192:195], v[36:39]
    ds_read_b64_tr_b16 v[140:141], v6 offset:30744
    ds_read_b64_tr_b16 v[142:143], v6 offset:32024
    v_mfma_f32_16x16x32_bf16 v[40:43], v[160:163], v[192:195], v[40:43]
    ds_read_b64_tr_b16 v[144:145], v6 offset:30752
    ds_read_b64_tr_b16 v[146:147], v6 offset:32032
    s_waitcnt lgkmcnt(10)
    v_mfma_f32_16x16x32_bf16 v[24:27], v[164:167], v[196:199], v[24:27]
    ds_read_b64_tr_b16 v[148:149], v6 offset:35840
    ds_read_b64_tr_b16 v[150:151], v6 offset:37120
    v_mfma_f32_16x16x32_bf16 v[28:31], v[168:171], v[196:199], v[28:31]
    ds_read_b64_tr_b16 v[152:153], v6 offset:35848
    ds_read_b64_tr_b16 v[154:155], v6 offset:37128
    v_mfma_f32_16x16x32_bf16 v[32:35], v[172:175], v[196:199], v[32:35]
    ds_read_b64_tr_b16 v[156:157], v6 offset:35856
    ds_read_b64_tr_b16 v[158:159], v6 offset:37136
    v_mfma_f32_16x16x32_bf16 v[36:39], v[120:123], v[196:199], v[36:39]
    ds_read_b64_tr_b16 v[160:161], v6 offset:35864
    ds_read_b64_tr_b16 v[162:163], v6 offset:37144
    v_mfma_f32_16x16x32_bf16 v[40:43], v[124:127], v[196:199], v[40:43]
    ds_read_b64_tr_b16 v[164:165], v6 offset:35872
    ds_read_b64_tr_b16 v[166:167], v6 offset:37152
    s_waitcnt lgkmcnt(10)
    v_mfma_f32_16x16x32_bf16 v[24:27], v[128:131], v[200:203], v[24:27]
    ds_read_b64_tr_b16 v[168:169], v6 offset:40960
    ds_read_b64_tr_b16 v[170:171], v6 offset:42240
    v_mfma_f32_16x16x32_bf16 v[28:31], v[132:135], v[200:203], v[28:31]
    ds_read_b64_tr_b16 v[172:173], v6 offset:40968
    ds_read_b64_tr_b16 v[174:175], v6 offset:42248
    v_mfma_f32_16x16x32_bf16 v[32:35], v[136:139], v[200:203], v[32:35]
    ds_read_b64_tr_b16 v[120:121], v6 offset:40976
    ds_read_b64_tr_b16 v[122:123], v6 offset:42256
    v_mfma_f32_16x16x32_bf16 v[36:39], v[140:143], v[200:203], v[36:39]
    ds_read_b64_tr_b16 v[124:125], v6 offset:40984
    ds_read_b64_tr_b16 v[126:127], v6 offset:42264
    v_mfma_f32_16x16x32_bf16 v[40:43], v[144:147], v[200:203], v[40:43]
    ds_read_b64_tr_b16 v[128:129], v6 offset:40992
    ds_read_b64_tr_b16 v[130:131], v6 offset:42272
    s_waitcnt lgkmcnt(10)
    v_mfma_f32_16x16x32_bf16 v[24:27], v[148:151], v[204:207], v[24:27]
    ds_read_b64_tr_b16 v[132:133], v6 offset:46080
    ds_read_b64_tr_b16 v[134:135], v6 offset:47360
    v_mfma_f32_16x16x32_bf16 v[28:31], v[152:155], v[204:207], v[28:31]
    ds_read_b64_tr_b16 v[136:137], v6 offset:46088
    ds_read_b64_tr_b16 v[138:139], v6 offset:47368
    v_mfma_f32_16x16x32_bf16 v[32:35], v[156:159], v[204:207], v[32:35]
    ds_read_b64_tr_b16 v[140:141], v6 offset:46096
    ds_read_b64_tr_b16 v[142:143], v6 offset:47376
    v_mfma_f32_16x16x32_bf16 v[36:39], v[160:163], v[204:207], v[36:39]
    ds_read_b64_tr_b16 v[144:145], v6 offset:46104
    ds_read_b64_tr_b16 v[146:147], v6 offset:47384
    v_mfma_f32_16x16x32_bf16 v[40:43], v[164:167], v[204:207], v[40:43]
    ds_read_b64_tr_b16 v[148:149], v6 offset:46112
    ds_read_b64_tr_b16 v[150:151], v6 offset:47392
    s_waitcnt lgkmcnt(10)
    v_mfma_f32_16x16x32_bf16 v[24:27], v[168:171], v[208:211], v[24:27]
    ds_read_b64_tr_b16 v[152:153], v6 offset:51200
    ds_read_b64_tr_b16 v[154:155], v6 offset:52480
    v_mfma_f32_16x16x32_bf16 v[28:31], v[172:175], v[208:211], v[28:31]
    ds_read_b64_tr_b16 v[156:157], v6 offset:51208
    ds_read_b64_tr_b16 v[158:159], v6 offset:52488
    v_mfma_f32_16x16x32_bf16 v[32:35], v[120:123], v[208:211], v[32:35]
    ds_read_b64_tr_b16 v[160:161], v6 offset:51216
    ds_read_b64_tr_b16 v[162:163], v6 offset:52496
    v_mfma_f32_16x16x32_bf16 v[36:39], v[124:127], v[208:211], v[36:39]
    ds_read_b64_tr_b16 v[164:165], v6 offset:51224
    ds_read_b64_tr_b16 v[166:167], v6 offset:52504
    v_mfma_f32_16x16x32_bf16 v[40:43], v[128:131], v[208:211], v[40:43]
    ds_read_b64_tr_b16 v[168:169], v6 offset:51232
    ds_read_b64_tr_b16 v[170:171], v6 offset:52512
    s_waitcnt lgkmcnt(10)
    v_mfma_f32_16x16x32_bf16 v[24:27], v[132:135], v[212:215], v[24:27]
    ds_read_b64_tr_b16 v[172:173], v6 offset:56320
    ds_read_b64_tr_b16 v[174:175], v6 offset:57600
    v_mfma_f32_16x16x32_bf16 v[28:31], v[136:139], v[212:215], v[28:31]
    ds_read_b64_tr_b16 v[120:121], v6 offset:56328
    ds_read_b64_tr_b16 v[122:123], v6 offset:57608
    v_mfma_f32_16x16x32_bf16 v[32:35], v[140:143], v[212:215], v[32:35]
    ds_read_b64_tr_b16 v[124:125], v6 offset:56336
    ds_read_b64_tr_b16 v[126:127], v6 offset:57616
    v_mfma_f32_16x16x32_bf16 v[36:39], v[144:147], v[212:215], v[36:39]
    ds_read_b64_tr_b16 v[128:129], v6 offset:56344
    ds_read_b64_tr_b16 v[130:131], v6 offset:57624
    v_mfma_f32_16x16x32_bf16 v[40:43], v[148:151], v[212:215], v[40:43]
    ds_read_b64_tr_b16 v[132:133], v6 offset:56352
    ds_read_b64_tr_b16 v[134:135], v6 offset:57632
    s_waitcnt lgkmcnt(10)
    v_mfma_f32_16x16x32_bf16 v[24:27], v[152:155], v[216:219], v[24:27]
    s_barrier
    ds_read_b64_tr_b16 v[136:137], v7 offset:0
    ds_read_b64_tr_b16 v[138:139], v7 offset:1280
    v_mfma_f32_16x16x32_bf16 v[28:31], v[156:159], v[216:219], v[28:31]
    ds_read_b64_tr_b16 v[140:141], v7 offset:8
    ds_read_b64_tr_b16 v[142:143], v7 offset:1288
    v_mfma_f32_16x16x32_bf16 v[32:35], v[160:163], v[216:219], v[32:35]
    ds_read_b64_tr_b16 v[144:145], v7 offset:16
    ds_read_b64_tr_b16 v[146:147], v7 offset:1296
    v_mfma_f32_16x16x32_bf16 v[36:39], v[164:167], v[216:219], v[36:39]
    ds_read_b64_tr_b16 v[148:149], v7 offset:24
    ds_read_b64_tr_b16 v[150:151], v7 offset:1304
    v_mfma_f32_16x16x32_bf16 v[40:43], v[168:171], v[216:219], v[40:43]
    ds_read_b64_tr_b16 v[152:153], v7 offset:32
    ds_read_b64_tr_b16 v[154:155], v7 offset:1312
    s_waitcnt lgkmcnt(10)
    v_mfma_f32_16x16x32_bf16 v[24:27], v[172:175], v[220:223], v[24:27]
    ds_read_b64_tr_b16 v[156:157], v7 offset:5120
    ds_read_b64_tr_b16 v[158:159], v7 offset:6400
    v_mfma_f32_16x16x32_bf16 v[28:31], v[120:123], v[220:223], v[28:31]
    ds_read_b64_tr_b16 v[160:161], v7 offset:5128
    ds_read_b64_tr_b16 v[162:163], v7 offset:6408
    v_mfma_f32_16x16x32_bf16 v[32:35], v[124:127], v[220:223], v[32:35]
    ds_read_b64_tr_b16 v[164:165], v7 offset:5136
    ds_read_b64_tr_b16 v[166:167], v7 offset:6416
    v_mfma_f32_16x16x32_bf16 v[36:39], v[128:131], v[220:223], v[36:39]
    ds_read_b64_tr_b16 v[168:169], v7 offset:5144
    ds_read_b64_tr_b16 v[170:171], v7 offset:6424
    v_mfma_f32_16x16x32_bf16 v[40:43], v[132:135], v[220:223], v[40:43]
    ds_read_b64_tr_b16 v[172:173], v7 offset:5152
    ds_read_b64_tr_b16 v[174:175], v7 offset:6432
    s_waitcnt lgkmcnt(10)
    v_mfma_f32_16x16x32_bf16 v[24:27], v[136:139], v[224:227], v[24:27]
    ds_read_b64_tr_b16 v[120:121], v7 offset:10240
    ds_read_b64_tr_b16 v[122:123], v7 offset:11520
    v_mfma_f32_16x16x32_bf16 v[28:31], v[140:143], v[224:227], v[28:31]
    ds_read_b64_tr_b16 v[124:125], v7 offset:10248
    ds_read_b64_tr_b16 v[126:127], v7 offset:11528
    v_mfma_f32_16x16x32_bf16 v[32:35], v[144:147], v[224:227], v[32:35]
    ds_read_b64_tr_b16 v[128:129], v7 offset:10256
    ds_read_b64_tr_b16 v[130:131], v7 offset:11536
    v_mfma_f32_16x16x32_bf16 v[36:39], v[148:151], v[224:227], v[36:39]
    ds_read_b64_tr_b16 v[132:133], v7 offset:10264
    ds_read_b64_tr_b16 v[134:135], v7 offset:11544
    v_mfma_f32_16x16x32_bf16 v[40:43], v[152:155], v[224:227], v[40:43]
    ds_read_b64_tr_b16 v[136:137], v7 offset:10272
    ds_read_b64_tr_b16 v[138:139], v7 offset:11552
    s_waitcnt lgkmcnt(10)
    v_mfma_f32_16x16x32_bf16 v[24:27], v[156:159], v[228:231], v[24:27]
    ds_read_b64_tr_b16 v[140:141], v7 offset:15360
    ds_read_b64_tr_b16 v[142:143], v7 offset:16640
    v_mfma_f32_16x16x32_bf16 v[28:31], v[160:163], v[228:231], v[28:31]
    ds_read_b64_tr_b16 v[144:145], v7 offset:15368
    ds_read_b64_tr_b16 v[146:147], v7 offset:16648
    v_mfma_f32_16x16x32_bf16 v[32:35], v[164:167], v[228:231], v[32:35]
    ds_read_b64_tr_b16 v[148:149], v7 offset:15376
    ds_read_b64_tr_b16 v[150:151], v7 offset:16656
    v_mfma_f32_16x16x32_bf16 v[36:39], v[168:171], v[228:231], v[36:39]
    ds_read_b64_tr_b16 v[152:153], v7 offset:15384
    ds_read_b64_tr_b16 v[154:155], v7 offset:16664
    v_mfma_f32_16x16x32_bf16 v[40:43], v[172:175], v[228:231], v[40:43]
    ds_read_b64_tr_b16 v[156:157], v7 offset:15392
    ds_read_b64_tr_b16 v[158:159], v7 offset:16672
    s_waitcnt lgkmcnt(10)
    v_mfma_f32_16x16x32_bf16 v[24:27], v[120:123], v[232:235], v[24:27]
    s_barrier
    ds_read_b64_tr_b16 v[160:161], v7 offset:20480
    ds_read_b64_tr_b16 v[162:163], v7 offset:21760
    v_mfma_f32_16x16x32_bf16 v[28:31], v[124:127], v[232:235], v[28:31]
    ds_read_b64_tr_b16 v[164:165], v7 offset:20488
    ds_read_b64_tr_b16 v[166:167], v7 offset:21768
    v_mfma_f32_16x16x32_bf16 v[32:35], v[128:131], v[232:235], v[32:35]
    ds_read_b64_tr_b16 v[168:169], v7 offset:20496
    ds_read_b64_tr_b16 v[170:171], v7 offset:21776
    v_mfma_f32_16x16x32_bf16 v[36:39], v[132:135], v[232:235], v[36:39]
    ds_read_b64_tr_b16 v[172:173], v7 offset:20504
    ds_read_b64_tr_b16 v[174:175], v7 offset:21784
    v_mfma_f32_16x16x32_bf16 v[40:43], v[136:139], v[232:235], v[40:43]
    ds_read_b64_tr_b16 v[120:121], v7 offset:20512
    ds_read_b64_tr_b16 v[122:123], v7 offset:21792
    s_waitcnt lgkmcnt(10)
    v_mfma_f32_16x16x32_bf16 v[24:27], v[140:143], v[236:239], v[24:27]
    ds_read_b64_tr_b16 v[124:125], v7 offset:25600
    ds_read_b64_tr_b16 v[126:127], v7 offset:26880
    v_mfma_f32_16x16x32_bf16 v[28:31], v[144:147], v[236:239], v[28:31]
    ds_read_b64_tr_b16 v[128:129], v7 offset:25608
    ds_read_b64_tr_b16 v[130:131], v7 offset:26888
    v_mfma_f32_16x16x32_bf16 v[32:35], v[148:151], v[236:239], v[32:35]
    ds_read_b64_tr_b16 v[132:133], v7 offset:25616
    ds_read_b64_tr_b16 v[134:135], v7 offset:26896
    v_mfma_f32_16x16x32_bf16 v[36:39], v[152:155], v[236:239], v[36:39]
    ds_read_b64_tr_b16 v[136:137], v7 offset:25624
    ds_read_b64_tr_b16 v[138:139], v7 offset:26904
    v_mfma_f32_16x16x32_bf16 v[40:43], v[156:159], v[236:239], v[40:43]
    ds_read_b64_tr_b16 v[140:141], v7 offset:25632
    ds_read_b64_tr_b16 v[142:143], v7 offset:26912
    s_waitcnt lgkmcnt(10)
    v_mfma_f32_16x16x32_bf16 v[24:27], v[160:163], v[240:243], v[24:27]
    ds_read_b64_tr_b16 v[144:145], v7 offset:30720
    ds_read_b64_tr_b16 v[146:147], v7 offset:32000
    v_mfma_f32_16x16x32_bf16 v[28:31], v[164:167], v[240:243], v[28:31]
    ds_read_b64_tr_b16 v[148:149], v7 offset:30728
    ds_read_b64_tr_b16 v[150:151], v7 offset:32008
    v_mfma_f32_16x16x32_bf16 v[32:35], v[168:171], v[240:243], v[32:35]
    ds_read_b64_tr_b16 v[152:153], v7 offset:30736
    ds_read_b64_tr_b16 v[154:155], v7 offset:32016
    v_mfma_f32_16x16x32_bf16 v[36:39], v[172:175], v[240:243], v[36:39]
    ds_read_b64_tr_b16 v[156:157], v7 offset:30744
    ds_read_b64_tr_b16 v[158:159], v7 offset:32024
    v_mfma_f32_16x16x32_bf16 v[40:43], v[120:123], v[240:243], v[40:43]
    ds_read_b64_tr_b16 v[160:161], v7 offset:30752
    ds_read_b64_tr_b16 v[162:163], v7 offset:32032
    s_waitcnt lgkmcnt(10)
    v_mfma_f32_16x16x32_bf16 v[24:27], v[124:127], v[244:247], v[24:27]
    ds_read_b64_tr_b16 v[164:165], v7 offset:35840
    ds_read_b64_tr_b16 v[166:167], v7 offset:37120
    v_mfma_f32_16x16x32_bf16 v[28:31], v[128:131], v[244:247], v[28:31]
    ds_read_b64_tr_b16 v[168:169], v7 offset:35848
    ds_read_b64_tr_b16 v[170:171], v7 offset:37128
    v_mfma_f32_16x16x32_bf16 v[32:35], v[132:135], v[244:247], v[32:35]
    ds_read_b64_tr_b16 v[172:173], v7 offset:35856
    ds_read_b64_tr_b16 v[174:175], v7 offset:37136
    v_mfma_f32_16x16x32_bf16 v[36:39], v[136:139], v[244:247], v[36:39]
    ds_read_b64_tr_b16 v[120:121], v7 offset:35864
    ds_read_b64_tr_b16 v[122:123], v7 offset:37144
    v_mfma_f32_16x16x32_bf16 v[40:43], v[140:143], v[244:247], v[40:43]
    ds_read_b64_tr_b16 v[124:125], v7 offset:35872
    ds_read_b64_tr_b16 v[126:127], v7 offset:37152
    s_waitcnt lgkmcnt(10)
    v_mfma_f32_16x16x32_bf16 v[24:27], v[144:147], v[248:251], v[24:27]
    v_mfma_f32_16x16x32_bf16 v[28:31], v[148:151], v[248:251], v[28:31]
    v_mfma_f32_16x16x32_bf16 v[32:35], v[152:155], v[248:251], v[32:35]
    v_mfma_f32_16x16x32_bf16 v[36:39], v[156:159], v[248:251], v[36:39]
    v_mfma_f32_16x16x32_bf16 v[40:43], v[160:163], v[248:251], v[40:43]
    s_waitcnt lgkmcnt(0)
    v_mfma_f32_16x16x32_bf16 v[24:27], v[164:167], v[252:255], v[24:27]
    v_mfma_f32_16x16x32_bf16 v[28:31], v[168:171], v[252:255], v[28:31]
    v_mfma_f32_16x16x32_bf16 v[32:35], v[172:175], v[252:255], v[32:35]
    v_mfma_f32_16x16x32_bf16 v[36:39], v[120:123], v[252:255], v[36:39]
    v_mfma_f32_16x16x32_bf16 v[40:43], v[124:127], v[252:255], v[40:43]
    s_barrier
    s_nop 2
    s_nop 0
    v_cvt_pk_bf16_f32 v48, v24, v25
    v_cvt_pk_bf16_f32 v49, v26, v27
    v_cvt_pk_bf16_f32 v50, v28, v29
    v_cvt_pk_bf16_f32 v51, v30, v31
    v_cvt_pk_bf16_f32 v52, v32, v33
    v_cvt_pk_bf16_f32 v53, v34, v35
    v_cvt_pk_bf16_f32 v54, v36, v37
    v_cvt_pk_bf16_f32 v55, v38, v39
    v_cvt_pk_bf16_f32 v56, v40, v41
    v_cvt_pk_bf16_f32 v57, v42, v43
    v_mfma_f32_16x16x32_bf16 v[24:27], v[68:71], v[48:51], 0
    v_mfma_f32_16x16x32_bf16 v[28:31], v[78:81], v[48:51], 0
    v_mfma_f32_16x16x32_bf16 v[32:35], v[88:91], v[48:51], 0
    v_mfma_f32_16x16x32_bf16 v[36:39], v[98:101], v[48:51], 0
    v_mfma_f32_16x16x32_bf16 v[40:43], v[108:111], v[48:51], 0
    v_mfma_f32_16x16x32_bf16 v[24:27], v[72:75], v[52:55], v[24:27]
    v_mfma_f32_16x16x32_bf16 v[28:31], v[82:85], v[52:55], v[28:31]
    v_mfma_f32_16x16x32_bf16 v[32:35], v[92:95], v[52:55], v[32:35]
    v_mfma_f32_16x16x32_bf16 v[36:39], v[102:105], v[52:55], v[36:39]
    v_mfma_f32_16x16x32_bf16 v[40:43], v[112:115], v[52:55], v[40:43]
    v_mfma_f32_16x16x16_bf16 v[24:27], v[76:77], v[56:57], v[24:27]
    v_mfma_f32_16x16x16_bf16 v[28:31], v[86:87], v[56:57], v[28:31]
    v_mfma_f32_16x16x16_bf16 v[32:35], v[96:97], v[56:57], v[32:35]
    v_mfma_f32_16x16x16_bf16 v[36:39], v[106:107], v[56:57], v[36:39]
    v_mfma_f32_16x16x16_bf16 v[40:43], v[116:117], v[56:57], v[40:43]
    s_nop 3
    v_cvt_pk_bf16_f32 v24, 0, v24
    v_cvt_pk_bf16_f32 v25, 0, v25
    v_max_f32 v44, v24, v25
    v_min_f32_e64 v46, v24, v25
    v_cvt_pk_bf16_f32 v26, 0, v26
    v_cvt_pk_bf16_f32 v27, 0, v27
    v_max3_f32 v44, v44, v26, v27
    v_min3_f32 v46, v46, v26, v27
    v_cvt_pk_bf16_f32 v28, 0, v28
    v_cvt_pk_bf16_f32 v29, 0, v29
    v_max3_f32 v44, v44, v28, v29
    v_min3_f32 v46, v46, v28, v29
    v_cvt_pk_bf16_f32 v30, 0, v30
    v_cvt_pk_bf16_f32 v31, 0, v31
    v_max3_f32 v44, v44, v30, v31
    v_min3_f32 v46, v46, v30, v31
    v_cvt_pk_bf16_f32 v32, 0, v32
    v_cvt_pk_bf16_f32 v33, 0, v33
    v_max3_f32 v44, v44, v32, v33
    v_min3_f32 v46, v46, v32, v33
    v_cvt_pk_bf16_f32 v34, 0, v34
    v_cvt_pk_bf16_f32 v35, 0, v35
    v_max3_f32 v44, v44, v34, v35
    v_min3_f32 v46, v46, v34, v35
    v_cvt_pk_bf16_f32 v36, 0, v36
    v_cvt_pk_bf16_f32 v37, 0, v37
    v_max3_f32 v44, v44, v36, v37
    v_min3_f32 v46, v46, v36, v37
    v_cvt_pk_bf16_f32 v38, 0, v38
    v_cvt_pk_bf16_f32 v39, 0, v39
    v_max3_f32 v44, v44, v38, v39
    v_min3_f32 v46, v46, v38, v39
    v_cvt_pk_bf16_f32 v40, 0, v40
    v_cvt_pk_bf16_f32 v41, 0, v41
    v_max3_f32 v44, v44, v40, v41
    v_min3_f32 v46, v46, v40, v41
    v_cvt_pk_bf16_f32 v42, 0, v42
    v_cvt_pk_bf16_f32 v43, 0, v43
    v_max3_f32 v44, v44, v42, v43
    v_min3_f32 v46, v46, v42, v43
    v_mul_f32 v44, s92, v44
    v_mul_f32 v46, s92, v46
    v_pk_fma_f32 v[48:49], v[24:25], s[92:93], v[44:45] op_sel_hi:[1,1,0] neg_lo:[0,0,1] neg_hi:[0,0,1]
    v_pk_fma_f32 v[50:51], v[26:27], s[92:93], v[44:45] op_sel_hi:[1,1,0] neg_lo:[0,0,1] neg_hi:[0,0,1]
    v_pk_fma_f32 v[52:53], v[28:29], s[92:93], v[44:45] op_sel_hi:[1,1,0] neg_lo:[0,0,1] neg_hi:[0,0,1]
    v_pk_fma_f32 v[54:55], v[30:31], s[92:93], v[44:45] op_sel_hi:[1,1,0] neg_lo:[0,0,1] neg_hi:[0,0,1]
    v_pk_fma_f32 v[56:57], v[32:33], s[92:93], v[44:45] op_sel_hi:[1,1,0] neg_lo:[0,0,1] neg_hi:[0,0,1]
    v_pk_fma_f32 v[58:59], v[34:35], s[92:93], v[44:45] op_sel_hi:[1,1,0] neg_lo:[0,0,1] neg_hi:[0,0,1]
    v_pk_fma_f32 v[60:61], v[36:37], s[92:93], v[44:45] op_sel_hi:[1,1,0] neg_lo:[0,0,1] neg_hi:[0,0,1]
    v_pk_fma_f32 v[62:63], v[38:39], s[92:93], v[44:45] op_sel_hi:[1,1,0] neg_lo:[0,0,1] neg_hi:[0,0,1]
    v_pk_fma_f32 v[64:65], v[40:41], s[92:93], v[44:45] op_sel_hi:[1,1,0] neg_lo:[0,0,1] neg_hi:[0,0,1]
    v_pk_fma_f32 v[66:67], v[42:43], s[92:93], v[44:45] op_sel_hi:[1,1,0] neg_lo:[0,0,1] neg_hi:[0,0,1]
    v_pk_fma_f32 v[24:25], v[24:25], s[92:93], v[46:47] op_sel_hi:[1,1,0] neg_lo:[1,0,0] neg_hi:[1,0,0]
    v_pk_fma_f32 v[26:27], v[26:27], s[92:93], v[46:47] op_sel_hi:[1,1,0] neg_lo:[1,0,0] neg_hi:[1,0,0]
    v_pk_fma_f32 v[28:29], v[28:29], s[92:93], v[46:47] op_sel_hi:[1,1,0] neg_lo:[1,0,0] neg_hi:[1,0,0]
    v_pk_fma_f32 v[30:31], v[30:31], s[92:93], v[46:47] op_sel_hi:[1,1,0] neg_lo:[1,0,0] neg_hi:[1,0,0]
    v_pk_fma_f32 v[32:33], v[32:33], s[92:93], v[46:47] op_sel_hi:[1,1,0] neg_lo:[1,0,0] neg_hi:[1,0,0]
    v_pk_fma_f32 v[34:35], v[34:35], s[92:93], v[46:47] op_sel_hi:[1,1,0] neg_lo:[1,0,0] neg_hi:[1,0,0]
    v_pk_fma_f32 v[36:37], v[36:37], s[92:93], v[46:47] op_sel_hi:[1,1,0] neg_lo:[1,0,0] neg_hi:[1,0,0]
    v_pk_fma_f32 v[38:39], v[38:39], s[92:93], v[46:47] op_sel_hi:[1,1,0] neg_lo:[1,0,0] neg_hi:[1,0,0]
    v_pk_fma_f32 v[40:41], v[40:41], s[92:93], v[46:47] op_sel_hi:[1,1,0] neg_lo:[1,0,0] neg_hi:[1,0,0]
    v_pk_fma_f32 v[42:43], v[42:43], s[92:93], v[46:47] op_sel_hi:[1,1,0] neg_lo:[1,0,0] neg_hi:[1,0,0]
    v_exp_f32 v48, v48
    v_exp_f32 v49, v49
    v_exp_f32 v50, v50
    v_exp_f32 v51, v51
    v_exp_f32 v52, v52
    v_exp_f32 v53, v53
    v_pk_add_f32 v[44:45], v[48:49], v[50:51]
    v_exp_f32 v54, v54
    v_exp_f32 v55, v55
    v_pk_add_f32 v[44:45], v[44:45], v[52:53]
    v_exp_f32 v56, v56
    v_exp_f32 v57, v57
    v_pk_add_f32 v[44:45], v[44:45], v[54:55]
    v_exp_f32 v58, v58
    v_exp_f32 v59, v59
    v_pk_add_f32 v[44:45], v[44:45], v[56:57]
    v_exp_f32 v60, v60
    v_exp_f32 v61, v61
    v_pk_add_f32 v[44:45], v[44:45], v[58:59]
    v_exp_f32 v62, v62
    v_exp_f32 v63, v63
    v_pk_add_f32 v[44:45], v[44:45], v[60:61]
    v_exp_f32 v64, v64
    v_exp_f32 v65, v65
    v_pk_add_f32 v[44:45], v[44:45], v[62:63]
    v_exp_f32 v66, v66
    v_exp_f32 v67, v67
    v_pk_add_f32 v[44:45], v[44:45], v[64:65]
    v_pk_add_f32 v[44:45], v[44:45], v[66:67]
    v_add_f32 v44, v44, v45
    v_rcp_f32_e64 v44, v44
    s_nop 0
    v_pk_mul_f32 v[48:49], v[48:49], v[44:45] op_sel_hi:[1,0]
    v_cvt_pk_bf16_f32 v48, v48, v49
    v_pk_mul_f32 v[50:51], v[50:51], v[44:45] op_sel_hi:[1,0]
    v_cvt_pk_bf16_f32 v49, v50, v51
    v_pk_mul_f32 v[52:53], v[52:53], v[44:45] op_sel_hi:[1,0]
    v_cvt_pk_bf16_f32 v50, v52, v53
    v_pk_mul_f32 v[54:55], v[54:55], v[44:45] op_sel_hi:[1,0]
    v_cvt_pk_bf16_f32 v51, v54, v55
    v_pk_mul_f32 v[56:57], v[56:57], v[44:45] op_sel_hi:[1,0]
    v_cvt_pk_bf16_f32 v52, v56, v57
    v_pk_mul_f32 v[58:59], v[58:59], v[44:45] op_sel_hi:[1,0]
    v_cvt_pk_bf16_f32 v53, v58, v59
    v_pk_mul_f32 v[60:61], v[60:61], v[44:45] op_sel_hi:[1,0]
    v_cvt_pk_bf16_f32 v54, v60, v61
    v_pk_mul_f32 v[62:63], v[62:63], v[44:45] op_sel_hi:[1,0]
    v_cvt_pk_bf16_f32 v55, v62, v63
    v_pk_mul_f32 v[64:65], v[64:65], v[44:45] op_sel_hi:[1,0]
    v_cvt_pk_bf16_f32 v56, v64, v65
    v_pk_mul_f32 v[66:67], v[66:67], v[44:45] op_sel_hi:[1,0]
    v_cvt_pk_bf16_f32 v57, v66, v67
    v_exp_f32 v24, v24
    v_exp_f32 v25, v25
    v_exp_f32 v26, v26
    v_exp_f32 v27, v27
    v_exp_f32 v28, v28
    v_exp_f32 v29, v29
    v_pk_add_f32 v[46:47], v[24:25], v[26:27]
    v_exp_f32 v30, v30
    v_exp_f32 v31, v31
    v_pk_add_f32 v[46:47], v[46:47], v[28:29]
    v_exp_f32 v32, v32
    v_exp_f32 v33, v33
    v_pk_add_f32 v[46:47], v[46:47], v[30:31]
    v_exp_f32 v34, v34
    v_exp_f32 v35, v35
    v_pk_add_f32 v[46:47], v[46:47], v[32:33]
    v_exp_f32 v36, v36
    v_exp_f32 v37, v37
    v_pk_add_f32 v[46:47], v[46:47], v[34:35]
    v_exp_f32 v38, v38
    v_exp_f32 v39, v39
    v_pk_add_f32 v[46:47], v[46:47], v[36:37]
    v_exp_f32 v40, v40
    v_exp_f32 v41, v41
    v_pk_add_f32 v[46:47], v[46:47], v[38:39]
    v_exp_f32 v42, v42
    v_exp_f32 v43, v43
    v_pk_add_f32 v[46:47], v[46:47], v[40:41]
    v_pk_add_f32 v[46:47], v[46:47], v[42:43]
    v_add_f32 v46, v46, v47
    v_rcp_f32_e64 v46, v46
    s_barrier
    ds_read_b128 v[120:123], v8 offset:40960
    ds_read_b128 v[124:127], v8 offset:41984
    ds_read_b128 v[128:131], v8 offset:43008
    ds_read_b128 v[132:135], v8 offset:44032
    ds_read_b128 v[136:139], v8 offset:45056
    ds_read_b128 v[140:143], v8 offset:46080
    ds_read_b128 v[144:147], v8 offset:47104
    ds_read_b128 v[148:151], v8 offset:48128
    ds_read_b128 v[152:155], v8 offset:49152
    ds_read_b128 v[156:159], v8 offset:50176
    ds_read_b128 v[160:163], v8 offset:51200
    ds_read_b128 v[164:167], v8 offset:52224
    v_pk_mul_f32 v[24:25], v[24:25], v[46:47] op_sel_hi:[1,0]
    v_cvt_pk_bf16_f32 v58, v24, v25
    v_pk_mul_f32 v[26:27], v[26:27], v[46:47] op_sel_hi:[1,0]
    v_cvt_pk_bf16_f32 v59, v26, v27
    v_pk_mul_f32 v[28:29], v[28:29], v[46:47] op_sel_hi:[1,0]
    v_cvt_pk_bf16_f32 v60, v28, v29
    v_pk_mul_f32 v[30:31], v[30:31], v[46:47] op_sel_hi:[1,0]
    v_cvt_pk_bf16_f32 v61, v30, v31
    v_pk_mul_f32 v[32:33], v[32:33], v[46:47] op_sel_hi:[1,0]
    v_cvt_pk_bf16_f32 v62, v32, v33
    v_pk_mul_f32 v[34:35], v[34:35], v[46:47] op_sel_hi:[1,0]
    v_cvt_pk_bf16_f32 v63, v34, v35
    v_pk_mul_f32 v[36:37], v[36:37], v[46:47] op_sel_hi:[1,0]
    v_cvt_pk_bf16_f32 v64, v36, v37
    v_pk_mul_f32 v[38:39], v[38:39], v[46:47] op_sel_hi:[1,0]
    v_cvt_pk_bf16_f32 v65, v38, v39
    v_pk_mul_f32 v[40:41], v[40:41], v[46:47] op_sel_hi:[1,0]
    v_cvt_pk_bf16_f32 v66, v40, v41
    v_pk_mul_f32 v[42:43], v[42:43], v[46:47] op_sel_hi:[1,0]
    v_cvt_pk_bf16_f32 v67, v42, v43
    s_waitcnt lgkmcnt(7)
    v_mfma_f32_16x16x32_bf16 v[24:27], v[120:123], v[176:179], 0
    ds_read_b128 v[168:171], v8 offset:53248
    v_mfma_f32_16x16x32_bf16 v[28:31], v[124:127], v[176:179], 0
    ds_read_b128 v[172:175], v8 offset:54272
    v_mfma_f32_16x16x32_bf16 v[32:35], v[128:131], v[176:179], 0
    ds_read_b128 v[120:123], v8 offset:55296
    v_mfma_f32_16x16x32_bf16 v[36:39], v[132:135], v[176:179], 0
    ds_read_b128 v[124:127], v8 offset:56320
    v_mfma_f32_16x16x32_bf16 v[40:43], v[136:139], v[176:179], 0
    ds_read_b128 v[128:131], v8 offset:57344
    s_waitcnt lgkmcnt(7)
    v_mfma_f32_16x16x32_bf16 v[24:27], v[140:143], v[180:183], v[24:27]
    ds_read_b128 v[132:135], v8 offset:58368
    v_mfma_f32_16x16x32_bf16 v[28:31], v[144:147], v[180:183], v[28:31]
    ds_read_b128 v[136:139], v8 offset:59392
    v_mfma_f32_16x16x32_bf16 v[32:35], v[148:151], v[180:183], v[32:35]
    ds_read_b128 v[140:143], v8 offset:60416
    v_mfma_f32_16x16x32_bf16 v[36:39], v[152:155], v[180:183], v[36:39]
    ds_read_b128 v[144:147], v2 offset:0
    v_mfma_f32_16x16x32_bf16 v[40:43], v[156:159], v[180:183], v[40:43]
    ds_read_b128 v[148:151], v2 offset:1024
    s_waitcnt lgkmcnt(7)
    v_mfma_f32_16x16x32_bf16 v[24:27], v[160:163], v[184:187], v[24:27]
    ds_read_b128 v[152:155], v2 offset:2048
    v_mfma_f32_16x16x32_bf16 v[28:31], v[164:167], v[184:187], v[28:31]
    ds_read_b128 v[156:159], v2 offset:3072
    v_mfma_f32_16x16x32_bf16 v[32:35], v[168:171], v[184:187], v[32:35]
    ds_read_b128 v[160:163], v2 offset:4096
    v_mfma_f32_16x16x32_bf16 v[36:39], v[172:175], v[184:187], v[36:39]
    ds_read_b128 v[164:167], v2 offset:5120
    v_mfma_f32_16x16x32_bf16 v[40:43], v[120:123], v[184:187], v[40:43]
    ds_read_b128 v[168:171], v2 offset:6144
    s_waitcnt lgkmcnt(7)
    v_mfma_f32_16x16x32_bf16 v[24:27], v[124:127], v[188:191], v[24:27]
    ds_read_b128 v[172:175], v2 offset:7168
    v_mfma_f32_16x16x32_bf16 v[28:31], v[128:131], v[188:191], v[28:31]
    ds_read_b128 v[120:123], v2 offset:8192
    v_mfma_f32_16x16x32_bf16 v[32:35], v[132:135], v[188:191], v[32:35]
    ds_read_b128 v[124:127], v2 offset:9216
    v_mfma_f32_16x16x32_bf16 v[36:39], v[136:139], v[188:191], v[36:39]
    ds_read_b128 v[128:131], v2 offset:10240
    v_mfma_f32_16x16x32_bf16 v[40:43], v[140:143], v[188:191], v[40:43]
    ds_read_b128 v[132:135], v2 offset:11264
    s_waitcnt lgkmcnt(7)
    v_mfma_f32_16x16x32_bf16 v[24:27], v[144:147], v[192:195], v[24:27]
    ds_read_b128 v[136:139], v2 offset:12288
    v_mfma_f32_16x16x32_bf16 v[28:31], v[148:151], v[192:195], v[28:31]
    ds_read_b128 v[140:143], v2 offset:13312
    v_mfma_f32_16x16x32_bf16 v[32:35], v[152:155], v[192:195], v[32:35]
    ds_read_b128 v[144:147], v2 offset:14336
    v_mfma_f32_16x16x32_bf16 v[36:39], v[156:159], v[192:195], v[36:39]
    ds_read_b128 v[148:151], v2 offset:15360
    v_mfma_f32_16x16x32_bf16 v[40:43], v[160:163], v[192:195], v[40:43]
    ds_read_b128 v[152:155], v2 offset:16384
    s_waitcnt lgkmcnt(7)
    v_mfma_f32_16x16x32_bf16 v[24:27], v[164:167], v[196:199], v[24:27]
    ds_read_b128 v[156:159], v2 offset:17408
    v_mfma_f32_16x16x32_bf16 v[28:31], v[168:171], v[196:199], v[28:31]
    ds_read_b128 v[160:163], v2 offset:18432
    v_mfma_f32_16x16x32_bf16 v[32:35], v[172:175], v[196:199], v[32:35]
    ds_read_b128 v[164:167], v2 offset:19456
    v_mfma_f32_16x16x32_bf16 v[36:39], v[120:123], v[196:199], v[36:39]
    ds_read_b128 v[168:171], v2 offset:20480
    v_mfma_f32_16x16x32_bf16 v[40:43], v[124:127], v[196:199], v[40:43]
    ds_read_b128 v[172:175], v2 offset:21504
    s_waitcnt lgkmcnt(7)
    v_mfma_f32_16x16x32_bf16 v[24:27], v[128:131], v[200:203], v[24:27]
    ds_read_b128 v[120:123], v2 offset:22528
    v_mfma_f32_16x16x32_bf16 v[28:31], v[132:135], v[200:203], v[28:31]
    ds_read_b128 v[124:127], v2 offset:23552
    v_mfma_f32_16x16x32_bf16 v[32:35], v[136:139], v[200:203], v[32:35]
    ds_read_b128 v[128:131], v2 offset:24576
    v_mfma_f32_16x16x32_bf16 v[36:39], v[140:143], v[200:203], v[36:39]
    ds_read_b128 v[132:135], v2 offset:25600
    v_mfma_f32_16x16x32_bf16 v[40:43], v[144:147], v[200:203], v[40:43]
    ds_read_b128 v[136:139], v2 offset:26624
    s_waitcnt lgkmcnt(7)
    v_mfma_f32_16x16x32_bf16 v[24:27], v[148:151], v[204:207], v[24:27]
    s_barrier
    ds_read_b128 v[140:143], v2 offset:27648
    v_mfma_f32_16x16x32_bf16 v[28:31], v[152:155], v[204:207], v[28:31]
    ds_read_b128 v[144:147], v2 offset:28672
    v_mfma_f32_16x16x32_bf16 v[32:35], v[156:159], v[204:207], v[32:35]
    ds_read_b128 v[148:151], v2 offset:29696
    v_mfma_f32_16x16x32_bf16 v[36:39], v[160:163], v[204:207], v[36:39]
    ds_read_b128 v[152:155], v2 offset:30720
    v_mfma_f32_16x16x32_bf16 v[40:43], v[164:167], v[204:207], v[40:43]
    ds_read_b128 v[156:159], v2 offset:31744
    s_waitcnt lgkmcnt(7)
    v_mfma_f32_16x16x32_bf16 v[24:27], v[168:171], v[208:211], v[24:27]
    ds_read_b128 v[160:163], v2 offset:32768
    v_mfma_f32_16x16x32_bf16 v[28:31], v[172:175], v[208:211], v[28:31]
    ds_read_b128 v[164:167], v2 offset:33792
    v_mfma_f32_16x16x32_bf16 v[32:35], v[120:123], v[208:211], v[32:35]
    ds_read_b128 v[168:171], v2 offset:34816
    v_mfma_f32_16x16x32_bf16 v[36:39], v[124:127], v[208:211], v[36:39]
    ds_read_b128 v[172:175], v2 offset:35840
    v_mfma_f32_16x16x32_bf16 v[40:43], v[128:131], v[208:211], v[40:43]
    ds_read_b128 v[120:123], v2 offset:36864
    s_waitcnt lgkmcnt(7)
    v_mfma_f32_16x16x32_bf16 v[24:27], v[132:135], v[212:215], v[24:27]
    ds_read_b128 v[124:127], v2 offset:37888
    v_mfma_f32_16x16x32_bf16 v[28:31], v[136:139], v[212:215], v[28:31]
    ds_read_b128 v[128:131], v2 offset:38912
    v_mfma_f32_16x16x32_bf16 v[32:35], v[140:143], v[212:215], v[32:35]
    ds_read_b128 v[132:135], v2 offset:39936
    v_mfma_f32_16x16x32_bf16 v[36:39], v[144:147], v[212:215], v[36:39]
    ds_read_b128 v[136:139], v2 offset:40960
    v_mfma_f32_16x16x32_bf16 v[40:43], v[148:151], v[212:215], v[40:43]
    ds_read_b128 v[140:143], v2 offset:41984
    s_waitcnt lgkmcnt(7)
    v_mfma_f32_16x16x32_bf16 v[24:27], v[152:155], v[216:219], v[24:27]
    ds_read_b128 v[144:147], v2 offset:43008
    v_mfma_f32_16x16x32_bf16 v[28:31], v[156:159], v[216:219], v[28:31]
    ds_read_b128 v[148:151], v2 offset:44032
    v_mfma_f32_16x16x32_bf16 v[32:35], v[160:163], v[216:219], v[32:35]
    ds_read_b128 v[152:155], v2 offset:45056
    v_mfma_f32_16x16x32_bf16 v[36:39], v[164:167], v[216:219], v[36:39]
    ds_read_b128 v[156:159], v2 offset:46080
    v_mfma_f32_16x16x32_bf16 v[40:43], v[168:171], v[216:219], v[40:43]
    ds_read_b128 v[160:163], v2 offset:47104
    s_waitcnt lgkmcnt(7)
    v_mfma_f32_16x16x32_bf16 v[24:27], v[172:175], v[220:223], v[24:27]
    s_barrier
    ds_read_b128 v[164:167], v2 offset:48128
    v_mfma_f32_16x16x32_bf16 v[28:31], v[120:123], v[220:223], v[28:31]
    ds_read_b128 v[168:171], v2 offset:49152
    v_mfma_f32_16x16x32_bf16 v[32:35], v[124:127], v[220:223], v[32:35]
    ds_read_b128 v[172:175], v2 offset:50176
    v_mfma_f32_16x16x32_bf16 v[36:39], v[128:131], v[220:223], v[36:39]
    ds_read_b128 v[120:123], v2 offset:51200
    v_mfma_f32_16x16x32_bf16 v[40:43], v[132:135], v[220:223], v[40:43]
    ds_read_b128 v[124:127], v2 offset:52224
    s_waitcnt lgkmcnt(7)
    v_mfma_f32_16x16x32_bf16 v[24:27], v[136:139], v[224:227], v[24:27]
    ds_read_b128 v[128:131], v2 offset:53248
    v_mfma_f32_16x16x32_bf16 v[28:31], v[140:143], v[224:227], v[28:31]
    ds_read_b128 v[132:135], v2 offset:54272
    v_mfma_f32_16x16x32_bf16 v[32:35], v[144:147], v[224:227], v[32:35]
    ds_read_b128 v[136:139], v2 offset:55296
    v_mfma_f32_16x16x32_bf16 v[36:39], v[148:151], v[224:227], v[36:39]
    ds_read_b128 v[140:143], v2 offset:56320
    v_mfma_f32_16x16x32_bf16 v[40:43], v[152:155], v[224:227], v[40:43]
    ds_read_b128 v[144:147], v2 offset:57344
    s_waitcnt lgkmcnt(7)
    v_mfma_f32_16x16x32_bf16 v[24:27], v[156:159], v[228:231], v[24:27]
    ds_read_b128 v[148:151], v2 offset:58368
    v_mfma_f32_16x16x32_bf16 v[28:31], v[160:163], v[228:231], v[28:31]
    ds_read_b128 v[152:155], v2 offset:59392
    v_mfma_f32_16x16x32_bf16 v[32:35], v[164:167], v[228:231], v[32:35]
    ds_read_b128 v[156:159], v2 offset:60416
    v_mfma_f32_16x16x32_bf16 v[36:39], v[168:171], v[228:231], v[36:39]
    ds_read_b128 v[160:163], v8 offset:0
    v_mfma_f32_16x16x32_bf16 v[40:43], v[172:175], v[228:231], v[40:43]
    ds_read_b128 v[164:167], v8 offset:1024
    s_waitcnt lgkmcnt(7)
    v_mfma_f32_16x16x32_bf16 v[24:27], v[120:123], v[232:235], v[24:27]
    ds_read_b128 v[168:171], v8 offset:2048
    v_mfma_f32_16x16x32_bf16 v[28:31], v[124:127], v[232:235], v[28:31]
    ds_read_b128 v[172:175], v8 offset:3072
    v_mfma_f32_16x16x32_bf16 v[32:35], v[128:131], v[232:235], v[32:35]
    ds_read_b128 v[120:123], v8 offset:4096
    v_mfma_f32_16x16x32_bf16 v[36:39], v[132:135], v[232:235], v[36:39]
    ds_read_b128 v[124:127], v8 offset:5120
    v_mfma_f32_16x16x32_bf16 v[40:43], v[136:139], v[232:235], v[40:43]
    ds_read_b128 v[128:131], v8 offset:6144
    s_waitcnt lgkmcnt(7)
    v_mfma_f32_16x16x32_bf16 v[24:27], v[140:143], v[236:239], v[24:27]
    ds_read_b128 v[132:135], v8 offset:7168
    v_mfma_f32_16x16x32_bf16 v[28:31], v[144:147], v[236:239], v[28:31]
    ds_read_b128 v[136:139], v8 offset:8192
    v_mfma_f32_16x16x32_bf16 v[32:35], v[148:151], v[236:239], v[32:35]
    ds_read_b128 v[140:143], v8 offset:9216
    v_mfma_f32_16x16x32_bf16 v[36:39], v[152:155], v[236:239], v[36:39]
    ds_read_b128 v[144:147], v8 offset:10240
    v_mfma_f32_16x16x32_bf16 v[40:43], v[156:159], v[236:239], v[40:43]
    ds_read_b128 v[148:151], v8 offset:11264
    s_waitcnt lgkmcnt(7)
    v_mfma_f32_16x16x32_bf16 v[24:27], v[160:163], v[240:243], v[24:27]
    ds_read_b128 v[152:155], v8 offset:12288
    v_mfma_f32_16x16x32_bf16 v[28:31], v[164:167], v[240:243], v[28:31]
    ds_read_b128 v[156:159], v8 offset:13312
    v_mfma_f32_16x16x32_bf16 v[32:35], v[168:171], v[240:243], v[32:35]
    ds_read_b128 v[160:163], v8 offset:14336
    v_mfma_f32_16x16x32_bf16 v[36:39], v[172:175], v[240:243], v[36:39]
    ds_read_b128 v[164:167], v8 offset:15360
    v_mfma_f32_16x16x32_bf16 v[40:43], v[120:123], v[240:243], v[40:43]
    ds_read_b128 v[168:171], v8 offset:16384
    s_waitcnt lgkmcnt(7)
    v_mfma_f32_16x16x32_bf16 v[24:27], v[124:127], v[244:247], v[24:27]
    ds_read_b128 v[172:175], v8 offset:17408
    v_mfma_f32_16x16x32_bf16 v[28:31], v[128:131], v[244:247], v[28:31]
    ds_read_b128 v[120:123], v8 offset:18432
    v_mfma_f32_16x16x32_bf16 v[32:35], v[132:135], v[244:247], v[32:35]
    ds_read_b128 v[124:127], v8 offset:19456
    v_mfma_f32_16x16x32_bf16 v[36:39], v[136:139], v[244:247], v[36:39]
    v_mfma_f32_16x16x32_bf16 v[40:43], v[140:143], v[244:247], v[40:43]
    s_waitcnt lgkmcnt(5)
    v_mfma_f32_16x16x32_bf16 v[24:27], v[144:147], v[248:251], v[24:27]
    v_mfma_f32_16x16x32_bf16 v[28:31], v[148:151], v[248:251], v[28:31]
    v_mfma_f32_16x16x32_bf16 v[32:35], v[152:155], v[248:251], v[32:35]
    v_mfma_f32_16x16x32_bf16 v[36:39], v[156:159], v[248:251], v[36:39]
    v_mfma_f32_16x16x32_bf16 v[40:43], v[160:163], v[248:251], v[40:43]
    s_waitcnt lgkmcnt(0)
    v_mfma_f32_16x16x32_bf16 v[24:27], v[164:167], v[252:255], v[24:27]
    v_mfma_f32_16x16x32_bf16 v[28:31], v[168:171], v[252:255], v[28:31]
    v_mfma_f32_16x16x32_bf16 v[32:35], v[172:175], v[252:255], v[32:35]
    v_mfma_f32_16x16x32_bf16 v[36:39], v[120:123], v[252:255], v[36:39]
    v_mfma_f32_16x16x32_bf16 v[40:43], v[124:127], v[252:255], v[40:43]
    ds_write_b128 v9, v[48:51]
    v_xor_b32_e64 v10, 16, v9
    ds_write_b128 v10, v[52:55]
    s_nop 0
    v_cvt_pk_bf16_f32 v24, v24, v25
    v_cvt_pk_bf16_f32 v25, v26, v27
    v_cvt_pk_bf16_f32 v26, v28, v29
    v_xor_b32 v10, 32, v9
    ds_write_b128 v10, v[56:59]
    v_cvt_pk_bf16_f32 v27, v30, v31
    v_cvt_pk_bf16_f32 v28, v32, v33
    v_cvt_pk_bf16_f32 v29, v34, v35
    v_xor_b32_e64 v10, 48, v9
    ds_write_b128 v10, v[60:63]
    v_cvt_pk_bf16_f32 v30, v36, v37
    v_cvt_pk_bf16_f32 v31, v38, v39
    v_xor_b32_e64 v10, 64, v9
    ds_write_b128 v10, v[64:67]
    v_cvt_pk_bf16_f32 v32, v40, v41
    v_cvt_pk_bf16_f32 v33, v42, v43
    v_mov_b32 v34, 0x3f80
    v_mov_b32_e64 v35, 0
    v_xor_b32 v10, 80, v9
    ds_write_b128 v10, v[24:27]
    v_xor_b32 v10, 96, v9
    ds_write_b128 v10, v[28:31]
    v_xor_b32 v10, 112, v9
    ds_write_b128 v10, v[32:35]
    s_lshl_b32 s88, s54, 5
    s_add_u32 s88, s88, s53
    s_lshl_b32 s89, s88, 7
    s_add_u32 s89, s89, 126976
    s_cmp_eq_u32 s52, 0
    s_cselect_b32 s89, s89, 1073741824
    s_nop 0
    s_mul_i32 s88, s88, 15488
    s_add_u32 s88, s88, 2097152
    s_mov_b32 s96, 117835008
    s_mov_b32 s97, 117835009
    s_mov_b32 s98, 117835010
    s_mov_b32 s99, 117835011
    s_waitcnt lgkmcnt(0)
    s_barrier
    ds_read_b64_tr_b16 v[128:129], v15 offset:0
    ds_read_b64_tr_b16 v[130:131], v16 offset:0
    ds_read_b64_tr_b16 v[120:121], v11 offset:0
    ds_read_b64_tr_b16 v[122:123], v12 offset:0
    ds_read_b64_tr_b16 v[140:141], v15 offset:2048
    ds_read_b64_tr_b16 v[142:143], v16 offset:2048
    ds_read_b64_tr_b16 v[132:133], v11 offset:2048
    ds_read_b64_tr_b16 v[134:135], v12 offset:2048
    ds_read_b64_tr_b16 v[152:153], v15 offset:4096
    ds_read_b64_tr_b16 v[154:155], v16 offset:4096
    ds_read_b64_tr_b16 v[144:145], v11 offset:4096
    ds_read_b64_tr_b16 v[146:147], v12 offset:4096
    s_waitcnt lgkmcnt(8)
    v_mfma_f32_32x32x16_bf16 v[24:39], v[120:123], v[128:131], 0
    ds_read_b64_tr_b16 v[164:165], v15 offset:6144
    ds_read_b64_tr_b16 v[166:167], v16 offset:6144
    ds_read_b64_tr_b16 v[156:157], v11 offset:6144
    ds_read_b64_tr_b16 v[158:159], v12 offset:6144
    s_waitcnt lgkmcnt(8)
    v_mfma_f32_32x32x16_bf16 v[24:39], v[132:135], v[140:143], v[24:39]
    ds_read_b64_tr_b16 v[124:125], v13 offset:0
    ds_read_b64_tr_b16 v[126:127], v14 offset:0
    ds_read_b64_tr_b16 v[136:137], v13 offset:2048
    ds_read_b64_tr_b16 v[138:139], v14 offset:2048
    s_waitcnt lgkmcnt(8)
    v_mfma_f32_32x32x16_bf16 v[24:39], v[144:147], v[152:155], v[24:39]
    ds_read_b64_tr_b16 v[148:149], v13 offset:4096
    ds_read_b64_tr_b16 v[150:151], v14 offset:4096
    ds_read_b64_tr_b16 v[160:161], v13 offset:6144
    ds_read_b64_tr_b16 v[162:163], v14 offset:6144
    s_waitcnt lgkmcnt(8)
    v_mfma_f32_32x32x16_bf16 v[24:39], v[156:159], v[164:167], v[24:39]
    s_waitcnt lgkmcnt(6)
    v_mfma_f32_32x32x16_bf16 v[40:55], v[124:127], v[128:131], 0
    s_waitcnt lgkmcnt(4)
    v_mfma_f32_32x32x16_bf16 v[40:55], v[136:139], v[140:143], v[40:55]
    s_nop 7
    s_nop 0
    v_perm_b32 v24, v24, v4, s96
    v_perm_b32 v25, v25, v4, s97
    v_perm_b32 v26, v26, v4, s98
    v_perm_b32 v27, v27, v4, s99
    buffer_store_dwordx4 v[24:27], v17, s[36:39], s88 offen offset:0 sc1
    s_waitcnt lgkmcnt(2)
    v_mfma_f32_32x32x16_bf16 v[40:55], v[148:151], v[152:155], v[40:55]
    s_nop 0
    v_perm_b32 v28, v28, v4, s96
    v_perm_b32 v29, v29, v4, s97
    v_perm_b32 v30, v30, v4, s98
    v_perm_b32 v31, v31, v4, s99
    buffer_store_dwordx4 v[28:31], v17, s[36:39], s88 offen offset:768 sc1
    s_waitcnt lgkmcnt(0)
    v_mfma_f32_32x32x16_bf16 v[40:55], v[160:163], v[164:167], v[40:55]
    s_nop 0
    ds_read_b128 v[120:123], v8 offset:20480
    ds_read_b128 v[124:127], v8 offset:21504
    ds_read_b128 v[128:131], v8 offset:22528
    ds_read_b128 v[132:135], v8 offset:23552
    ds_read_b128 v[136:139], v8 offset:24576
    ds_read_b128 v[140:143], v8 offset:25600
    ds_read_b128 v[144:147], v8 offset:26624
    ds_read_b128 v[148:151], v8 offset:27648
    ds_read_b128 v[152:155], v8 offset:28672
    ds_read_b128 v[156:159], v8 offset:29696
    ds_read_b128 v[160:163], v8 offset:30720
    ds_read_b128 v[164:167], v8 offset:31744
    v_perm_b32 v40, v40, v4, s96
    v_perm_b32 v41, v41, v4, s97
    v_perm_b32 v42, v42, v4, s98
    v_perm_b32 v43, v43, v4, s99
    buffer_store_dwordx4 v[40:43], v17, s[36:39], s88 offen offset:1920 sc1
    v_perm_b32 v44, v44, v4, s96
    v_perm_b32 v45, v45, v4, s97
    v_perm_b32 v46, v46, v4, s98
    v_perm_b32 v47, v47, v4, s99
    buffer_store_dwordx4 v[44:47], v17, s[36:39], s88 offen offset:2688 sc1
    v_permlane32_swap_b32 v32, v48
    v_permlane32_swap_b32 v33, v49
    v_permlane32_swap_b32 v34, v50
    v_permlane32_swap_b32 v35, v51
    v_perm_b32 v32, v32, v4, s96
    v_perm_b32 v33, v33, v4, s97
    v_perm_b32 v34, v34, v4, s98
    v_perm_b32 v35, v35, v4, s99
    buffer_store_dwordx4 v[32:35], v18, s[36:39], s88 offen offset:1536 sc1
    s_waitcnt lgkmcnt(7)
    v_mfma_f32_16x16x32_bf16 v[24:27], v[120:123], v[176:179], 0
    ds_read_b128 v[168:171], v8 offset:32768
    v_mfma_f32_16x16x32_bf16 v[28:31], v[124:127], v[176:179], 0
    ds_read_b128 v[172:175], v8 offset:33792
    v_mfma_f32_16x16x32_bf16 v[32:35], v[128:131], v[176:179], 0
    ds_read_b128 v[120:123], v8 offset:34816
    v_mfma_f32_16x16x32_bf16 v[36:39], v[132:135], v[176:179], 0
    ds_read_b128 v[124:127], v8 offset:35840
    v_mfma_f32_16x16x32_bf16 v[40:43], v[136:139], v[176:179], 0
    ds_read_b128 v[128:131], v8 offset:36864
    s_waitcnt lgkmcnt(7)
    v_mfma_f32_16x16x32_bf16 v[24:27], v[140:143], v[180:183], v[24:27]
    ds_read_b128 v[132:135], v8 offset:37888
    v_mfma_f32_16x16x32_bf16 v[28:31], v[144:147], v[180:183], v[28:31]
    ds_read_b128 v[136:139], v8 offset:38912
    v_mfma_f32_16x16x32_bf16 v[32:35], v[148:151], v[180:183], v[32:35]
    ds_read_b128 v[140:143], v8 offset:39936
    v_mfma_f32_16x16x32_bf16 v[36:39], v[152:155], v[180:183], v[36:39]
    ds_read_b128 v[144:147], v8 offset:40960
    v_mfma_f32_16x16x32_bf16 v[40:43], v[156:159], v[180:183], v[40:43]
    ds_read_b128 v[148:151], v8 offset:41984
    s_waitcnt lgkmcnt(7)
    v_mfma_f32_16x16x32_bf16 v[24:27], v[160:163], v[184:187], v[24:27]
    ds_read_b128 v[152:155], v8 offset:43008
    v_mfma_f32_16x16x32_bf16 v[28:31], v[164:167], v[184:187], v[28:31]
    ds_read_b128 v[156:159], v8 offset:44032
    v_mfma_f32_16x16x32_bf16 v[32:35], v[168:171], v[184:187], v[32:35]
    ds_read_b128 v[160:163], v8 offset:45056
    v_mfma_f32_16x16x32_bf16 v[36:39], v[172:175], v[184:187], v[36:39]
    ds_read_b128 v[164:167], v8 offset:46080
    v_mfma_f32_16x16x32_bf16 v[40:43], v[120:123], v[184:187], v[40:43]
    ds_read_b128 v[168:171], v8 offset:47104
    s_waitcnt lgkmcnt(7)
    v_mfma_f32_16x16x32_bf16 v[24:27], v[124:127], v[188:191], v[24:27]
    ds_read_b128 v[172:175], v8 offset:48128
    v_mfma_f32_16x16x32_bf16 v[28:31], v[128:131], v[188:191], v[28:31]
    ds_read_b128 v[120:123], v8 offset:49152
    v_mfma_f32_16x16x32_bf16 v[32:35], v[132:135], v[188:191], v[32:35]
    ds_read_b128 v[124:127], v8 offset:50176
    v_mfma_f32_16x16x32_bf16 v[36:39], v[136:139], v[188:191], v[36:39]
    ds_read_b128 v[128:131], v8 offset:51200
    v_mfma_f32_16x16x32_bf16 v[40:43], v[140:143], v[188:191], v[40:43]
    ds_read_b128 v[132:135], v8 offset:52224
    s_waitcnt lgkmcnt(7)
    v_mfma_f32_16x16x32_bf16 v[24:27], v[144:147], v[192:195], v[24:27]
    ds_read_b128 v[136:139], v8 offset:53248
    v_mfma_f32_16x16x32_bf16 v[28:31], v[148:151], v[192:195], v[28:31]
    ds_read_b128 v[140:143], v8 offset:54272
    v_mfma_f32_16x16x32_bf16 v[32:35], v[152:155], v[192:195], v[32:35]
    ds_read_b128 v[144:147], v8 offset:55296
    v_mfma_f32_16x16x32_bf16 v[36:39], v[156:159], v[192:195], v[36:39]
    ds_read_b128 v[148:151], v8 offset:56320
    v_mfma_f32_16x16x32_bf16 v[40:43], v[160:163], v[192:195], v[40:43]
    ds_read_b128 v[152:155], v8 offset:57344
    s_waitcnt lgkmcnt(7)
    v_mfma_f32_16x16x32_bf16 v[24:27], v[164:167], v[196:199], v[24:27]
    ds_read_b128 v[156:159], v8 offset:58368
    v_mfma_f32_16x16x32_bf16 v[28:31], v[168:171], v[196:199], v[28:31]
    ds_read_b128 v[160:163], v8 offset:59392
    v_mfma_f32_16x16x32_bf16 v[32:35], v[172:175], v[196:199], v[32:35]
    ds_read_b128 v[164:167], v8 offset:60416
    v_mfma_f32_16x16x32_bf16 v[36:39], v[120:123], v[196:199], v[36:39]
    ds_read_b128 v[168:171], v2 offset:0
    v_mfma_f32_16x16x32_bf16 v[40:43], v[124:127], v[196:199], v[40:43]
    ds_read_b128 v[172:175], v2 offset:1024
    s_waitcnt lgkmcnt(7)
    v_mfma_f32_16x16x32_bf16 v[24:27], v[128:131], v[200:203], v[24:27]
    ds_read_b128 v[120:123], v2 offset:2048
    v_mfma_f32_16x16x32_bf16 v[28:31], v[132:135], v[200:203], v[28:31]
    ds_read_b128 v[124:127], v2 offset:3072
    v_mfma_f32_16x16x32_bf16 v[32:35], v[136:139], v[200:203], v[32:35]
    ds_read_b128 v[128:131], v2 offset:4096
    v_mfma_f32_16x16x32_bf16 v[36:39], v[140:143], v[200:203], v[36:39]
    ds_read_b128 v[132:135], v2 offset:5120
    v_mfma_f32_16x16x32_bf16 v[40:43], v[144:147], v[200:203], v[40:43]
    ds_read_b128 v[136:139], v2 offset:6144
    s_waitcnt lgkmcnt(7)
    v_mfma_f32_16x16x32_bf16 v[24:27], v[148:151], v[204:207], v[24:27]
    ds_read_b128 v[140:143], v2 offset:7168
    v_mfma_f32_16x16x32_bf16 v[28:31], v[152:155], v[204:207], v[28:31]
    ds_read_b128 v[144:147], v2 offset:8192
    v_mfma_f32_16x16x32_bf16 v[32:35], v[156:159], v[204:207], v[32:35]
    ds_read_b128 v[148:151], v2 offset:9216
    v_mfma_f32_16x16x32_bf16 v[36:39], v[160:163], v[204:207], v[36:39]
    ds_read_b128 v[152:155], v2 offset:10240
    v_mfma_f32_16x16x32_bf16 v[40:43], v[164:167], v[204:207], v[40:43]
    ds_read_b128 v[156:159], v2 offset:11264
    s_waitcnt lgkmcnt(7)
    v_mfma_f32_16x16x32_bf16 v[24:27], v[168:171], v[208:211], v[24:27]
    ds_read_b128 v[160:163], v2 offset:12288
    v_mfma_f32_16x16x32_bf16 v[28:31], v[172:175], v[208:211], v[28:31]
    ds_read_b128 v[164:167], v2 offset:13312
    v_mfma_f32_16x16x32_bf16 v[32:35], v[120:123], v[208:211], v[32:35]
    ds_read_b128 v[168:171], v2 offset:14336
    v_mfma_f32_16x16x32_bf16 v[36:39], v[124:127], v[208:211], v[36:39]
    ds_read_b128 v[172:175], v2 offset:15360
    v_mfma_f32_16x16x32_bf16 v[40:43], v[128:131], v[208:211], v[40:43]
    ds_read_b128 v[120:123], v2 offset:16384
    s_waitcnt lgkmcnt(7)
    v_mfma_f32_16x16x32_bf16 v[24:27], v[132:135], v[212:215], v[24:27]
    ds_read_b128 v[124:127], v2 offset:17408
    v_mfma_f32_16x16x32_bf16 v[28:31], v[136:139], v[212:215], v[28:31]
    ds_read_b128 v[128:131], v2 offset:18432
    v_mfma_f32_16x16x32_bf16 v[32:35], v[140:143], v[212:215], v[32:35]
    ds_read_b128 v[132:135], v2 offset:19456
    v_mfma_f32_16x16x32_bf16 v[36:39], v[144:147], v[212:215], v[36:39]
    s_barrier
    ds_read_b128 v[136:139], v2 offset:20480
    v_mfma_f32_16x16x32_bf16 v[40:43], v[148:151], v[212:215], v[40:43]
    ds_read_b128 v[140:143], v2 offset:21504
    s_waitcnt lgkmcnt(7)
    v_mfma_f32_16x16x32_bf16 v[24:27], v[152:155], v[216:219], v[24:27]
    ds_read_b128 v[144:147], v2 offset:22528
    v_mfma_f32_16x16x32_bf16 v[28:31], v[156:159], v[216:219], v[28:31]
    ds_read_b128 v[148:151], v2 offset:23552
    v_mfma_f32_16x16x32_bf16 v[32:35], v[160:163], v[216:219], v[32:35]
    ds_read_b128 v[152:155], v2 offset:24576
    v_mfma_f32_16x16x32_bf16 v[36:39], v[164:167], v[216:219], v[36:39]
    ds_read_b128 v[156:159], v2 offset:25600
    v_mfma_f32_16x16x32_bf16 v[40:43], v[168:171], v[216:219], v[40:43]
    ds_read_b128 v[160:163], v2 offset:26624
    s_waitcnt lgkmcnt(7)
    v_mfma_f32_16x16x32_bf16 v[24:27], v[172:175], v[220:223], v[24:27]
    ds_read_b128 v[164:167], v2 offset:27648
    v_mfma_f32_16x16x32_bf16 v[28:31], v[120:123], v[220:223], v[28:31]
    ds_read_b128 v[168:171], v2 offset:28672
    v_mfma_f32_16x16x32_bf16 v[32:35], v[124:127], v[220:223], v[32:35]
    ds_read_b128 v[172:175], v2 offset:29696
    v_mfma_f32_16x16x32_bf16 v[36:39], v[128:131], v[220:223], v[36:39]
    ds_read_b128 v[120:123], v2 offset:30720
    v_mfma_f32_16x16x32_bf16 v[40:43], v[132:135], v[220:223], v[40:43]
    ds_read_b128 v[124:127], v2 offset:31744
    s_waitcnt lgkmcnt(7)
    v_mfma_f32_16x16x32_bf16 v[24:27], v[136:139], v[224:227], v[24:27]
    ds_read_b128 v[128:131], v2 offset:32768
    v_mfma_f32_16x16x32_bf16 v[28:31], v[140:143], v[224:227], v[28:31]
    ds_read_b128 v[132:135], v2 offset:33792
    v_mfma_f32_16x16x32_bf16 v[32:35], v[144:147], v[224:227], v[32:35]
    ds_read_b128 v[136:139], v2 offset:34816
    v_mfma_f32_16x16x32_bf16 v[36:39], v[148:151], v[224:227], v[36:39]
    ds_read_b128 v[140:143], v2 offset:35840
    v_mfma_f32_16x16x32_bf16 v[40:43], v[152:155], v[224:227], v[40:43]
    ds_read_b128 v[144:147], v2 offset:36864
    s_waitcnt lgkmcnt(7)
    v_mfma_f32_16x16x32_bf16 v[24:27], v[156:159], v[228:231], v[24:27]
    ds_read_b128 v[148:151], v2 offset:37888
    v_mfma_f32_16x16x32_bf16 v[28:31], v[160:163], v[228:231], v[28:31]
    ds_read_b128 v[152:155], v2 offset:38912
    v_mfma_f32_16x16x32_bf16 v[32:35], v[164:167], v[228:231], v[32:35]
    ds_read_b128 v[156:159], v2 offset:39936
    v_mfma_f32_16x16x32_bf16 v[36:39], v[168:171], v[228:231], v[36:39]
    ds_read_b128 v[160:163], v2 offset:40960
    v_mfma_f32_16x16x32_bf16 v[40:43], v[172:175], v[228:231], v[40:43]
    ds_read_b128 v[164:167], v2 offset:41984
    s_waitcnt lgkmcnt(7)
    v_mfma_f32_16x16x32_bf16 v[24:27], v[120:123], v[232:235], v[24:27]
    ds_read_b128 v[168:171], v2 offset:43008
    v_mfma_f32_16x16x32_bf16 v[28:31], v[124:127], v[232:235], v[28:31]
    ds_read_b128 v[172:175], v2 offset:44032
    v_mfma_f32_16x16x32_bf16 v[32:35], v[128:131], v[232:235], v[32:35]
    ds_read_b128 v[120:123], v2 offset:45056
    v_mfma_f32_16x16x32_bf16 v[36:39], v[132:135], v[232:235], v[36:39]
    ds_read_b128 v[124:127], v2 offset:46080
    v_mfma_f32_16x16x32_bf16 v[40:43], v[136:139], v[232:235], v[40:43]
    ds_read_b128 v[128:131], v2 offset:47104
    s_waitcnt lgkmcnt(7)
    v_mfma_f32_16x16x32_bf16 v[24:27], v[140:143], v[236:239], v[24:27]
    ds_read_b128 v[132:135], v2 offset:48128
    v_mfma_f32_16x16x32_bf16 v[28:31], v[144:147], v[236:239], v[28:31]
    ds_read_b128 v[136:139], v2 offset:49152
    v_mfma_f32_16x16x32_bf16 v[32:35], v[148:151], v[236:239], v[32:35]
    ds_read_b128 v[140:143], v2 offset:50176
    v_mfma_f32_16x16x32_bf16 v[36:39], v[152:155], v[236:239], v[36:39]
    ds_read_b128 v[144:147], v2 offset:51200
    v_mfma_f32_16x16x32_bf16 v[40:43], v[156:159], v[236:239], v[40:43]
    ds_read_b128 v[148:151], v2 offset:52224
    s_waitcnt lgkmcnt(7)
    v_mfma_f32_16x16x32_bf16 v[24:27], v[160:163], v[240:243], v[24:27]
    ds_read_b128 v[152:155], v2 offset:53248
    v_mfma_f32_16x16x32_bf16 v[28:31], v[164:167], v[240:243], v[28:31]
    ds_read_b128 v[156:159], v2 offset:54272
    v_mfma_f32_16x16x32_bf16 v[32:35], v[168:171], v[240:243], v[32:35]
    ds_read_b128 v[160:163], v2 offset:55296
    v_mfma_f32_16x16x32_bf16 v[36:39], v[172:175], v[240:243], v[36:39]
    ds_read_b128 v[164:167], v2 offset:56320
    v_mfma_f32_16x16x32_bf16 v[40:43], v[120:123], v[240:243], v[40:43]
    ds_read_b128 v[168:171], v2 offset:57344
    s_waitcnt lgkmcnt(7)
    v_mfma_f32_16x16x32_bf16 v[24:27], v[124:127], v[244:247], v[24:27]
    ds_read_b128 v[172:175], v2 offset:58368
    v_mfma_f32_16x16x32_bf16 v[28:31], v[128:131], v[244:247], v[28:31]
    ds_read_b128 v[120:123], v2 offset:59392
    v_mfma_f32_16x16x32_bf16 v[32:35], v[132:135], v[244:247], v[32:35]
    ds_read_b128 v[124:127], v2 offset:60416
    v_mfma_f32_16x16x32_bf16 v[36:39], v[136:139], v[244:247], v[36:39]
    v_mfma_f32_16x16x32_bf16 v[40:43], v[140:143], v[244:247], v[40:43]
    s_waitcnt lgkmcnt(5)
    v_mfma_f32_16x16x32_bf16 v[24:27], v[144:147], v[248:251], v[24:27]
    v_mfma_f32_16x16x32_bf16 v[28:31], v[148:151], v[248:251], v[28:31]
    v_mfma_f32_16x16x32_bf16 v[32:35], v[152:155], v[248:251], v[32:35]
    v_mfma_f32_16x16x32_bf16 v[36:39], v[156:159], v[248:251], v[36:39]
    v_mfma_f32_16x16x32_bf16 v[40:43], v[160:163], v[248:251], v[40:43]
    s_waitcnt lgkmcnt(0)
    v_mfma_f32_16x16x32_bf16 v[24:27], v[164:167], v[252:255], v[24:27]
    v_mfma_f32_16x16x32_bf16 v[28:31], v[168:171], v[252:255], v[28:31]
    v_mfma_f32_16x16x32_bf16 v[32:35], v[172:175], v[252:255], v[32:35]
    v_mfma_f32_16x16x32_bf16 v[36:39], v[120:123], v[252:255], v[36:39]
    v_mfma_f32_16x16x32_bf16 v[40:43], v[124:127], v[252:255], v[40:43]
    s_nop 3
    v_cvt_pk_bf16_f32 v48, v24, v25
    v_cvt_pk_bf16_f32 v49, v26, v27
    v_cvt_pk_bf16_f32 v50, v28, v29
    v_cvt_pk_bf16_f32 v51, v30, v31
    v_cvt_pk_bf16_f32 v52, v32, v33
    v_cvt_pk_bf16_f32 v53, v34, v35
    v_cvt_pk_bf16_f32 v54, v36, v37
    v_cvt_pk_bf16_f32 v55, v38, v39
    v_cvt_pk_bf16_f32 v56, v40, v41
    v_cvt_pk_bf16_f32 v57, v42, v43
    v_mfma_f32_16x16x32_bf16 v[24:27], v[68:71], v[48:51], 0
    v_mfma_f32_16x16x32_bf16 v[28:31], v[78:81], v[48:51], 0
    v_mfma_f32_16x16x32_bf16 v[32:35], v[88:91], v[48:51], 0
    v_mfma_f32_16x16x32_bf16 v[36:39], v[98:101], v[48:51], 0
    v_mfma_f32_16x16x32_bf16 v[40:43], v[108:111], v[48:51], 0
    v_mfma_f32_16x16x32_bf16 v[24:27], v[72:75], v[52:55], v[24:27]
    v_mfma_f32_16x16x32_bf16 v[28:31], v[82:85], v[52:55], v[28:31]
    v_mfma_f32_16x16x32_bf16 v[32:35], v[92:95], v[52:55], v[32:35]
    v_mfma_f32_16x16x32_bf16 v[36:39], v[102:105], v[52:55], v[36:39]
    v_mfma_f32_16x16x32_bf16 v[40:43], v[112:115], v[52:55], v[40:43]
    v_mfma_f32_16x16x16_bf16 v[24:27], v[76:77], v[56:57], v[24:27]
    v_mfma_f32_16x16x16_bf16 v[28:31], v[86:87], v[56:57], v[28:31]
    v_mfma_f32_16x16x16_bf16 v[32:35], v[96:97], v[56:57], v[32:35]
    v_mfma_f32_16x16x16_bf16 v[36:39], v[106:107], v[56:57], v[36:39]
    v_mfma_f32_16x16x16_bf16 v[40:43], v[116:117], v[56:57], v[40:43]
    s_nop 3
    v_cvt_pk_bf16_f32 v24, 0, v24
    v_cvt_pk_bf16_f32 v25, 0, v25
    v_max_f32 v44, v24, v25
    v_min_f32_e64 v46, v24, v25
    v_cvt_pk_bf16_f32 v26, 0, v26
    v_cvt_pk_bf16_f32 v27, 0, v27
    v_max3_f32 v44, v44, v26, v27
    v_min3_f32 v46, v46, v26, v27
    v_cvt_pk_bf16_f32 v28, 0, v28
    v_cvt_pk_bf16_f32 v29, 0, v29
    v_max3_f32 v44, v44, v28, v29
    v_min3_f32 v46, v46, v28, v29
    v_cvt_pk_bf16_f32 v30, 0, v30
    v_cvt_pk_bf16_f32 v31, 0, v31
    v_max3_f32 v44, v44, v30, v31
    v_min3_f32 v46, v46, v30, v31
    v_cvt_pk_bf16_f32 v32, 0, v32
    v_cvt_pk_bf16_f32 v33, 0, v33
    v_max3_f32 v44, v44, v32, v33
    v_min3_f32 v46, v46, v32, v33
    v_cvt_pk_bf16_f32 v34, 0, v34
    v_cvt_pk_bf16_f32 v35, 0, v35
    v_max3_f32 v44, v44, v34, v35
    v_min3_f32 v46, v46, v34, v35
    v_cvt_pk_bf16_f32 v36, 0, v36
    v_cvt_pk_bf16_f32 v37, 0, v37
    v_max3_f32 v44, v44, v36, v37
    v_min3_f32 v46, v46, v36, v37
    v_cvt_pk_bf16_f32 v38, 0, v38
    v_cvt_pk_bf16_f32 v39, 0, v39
    v_max3_f32 v44, v44, v38, v39
    v_min3_f32 v46, v46, v38, v39
    v_cvt_pk_bf16_f32 v40, 0, v40
    v_cvt_pk_bf16_f32 v41, 0, v41
    v_max3_f32 v44, v44, v40, v41
    v_min3_f32 v46, v46, v40, v41
    v_cvt_pk_bf16_f32 v42, 0, v42
    v_cvt_pk_bf16_f32 v43, 0, v43
    v_max3_f32 v44, v44, v42, v43
    v_min3_f32 v46, v46, v42, v43
    v_mul_f32 v44, s92, v44
    v_mul_f32 v46, s92, v46
    v_pk_fma_f32 v[48:49], v[24:25], s[92:93], v[44:45] op_sel_hi:[1,1,0] neg_lo:[0,0,1] neg_hi:[0,0,1]
    v_pk_fma_f32 v[50:51], v[26:27], s[92:93], v[44:45] op_sel_hi:[1,1,0] neg_lo:[0,0,1] neg_hi:[0,0,1]
    v_pk_fma_f32 v[52:53], v[28:29], s[92:93], v[44:45] op_sel_hi:[1,1,0] neg_lo:[0,0,1] neg_hi:[0,0,1]
    v_pk_fma_f32 v[54:55], v[30:31], s[92:93], v[44:45] op_sel_hi:[1,1,0] neg_lo:[0,0,1] neg_hi:[0,0,1]
    v_pk_fma_f32 v[56:57], v[32:33], s[92:93], v[44:45] op_sel_hi:[1,1,0] neg_lo:[0,0,1] neg_hi:[0,0,1]
    v_pk_fma_f32 v[58:59], v[34:35], s[92:93], v[44:45] op_sel_hi:[1,1,0] neg_lo:[0,0,1] neg_hi:[0,0,1]
    v_pk_fma_f32 v[60:61], v[36:37], s[92:93], v[44:45] op_sel_hi:[1,1,0] neg_lo:[0,0,1] neg_hi:[0,0,1]
    v_pk_fma_f32 v[62:63], v[38:39], s[92:93], v[44:45] op_sel_hi:[1,1,0] neg_lo:[0,0,1] neg_hi:[0,0,1]
    v_pk_fma_f32 v[64:65], v[40:41], s[92:93], v[44:45] op_sel_hi:[1,1,0] neg_lo:[0,0,1] neg_hi:[0,0,1]
    v_pk_fma_f32 v[66:67], v[42:43], s[92:93], v[44:45] op_sel_hi:[1,1,0] neg_lo:[0,0,1] neg_hi:[0,0,1]
    v_pk_fma_f32 v[24:25], v[24:25], s[92:93], v[46:47] op_sel_hi:[1,1,0] neg_lo:[1,0,0] neg_hi:[1,0,0]
    v_pk_fma_f32 v[26:27], v[26:27], s[92:93], v[46:47] op_sel_hi:[1,1,0] neg_lo:[1,0,0] neg_hi:[1,0,0]
    v_pk_fma_f32 v[28:29], v[28:29], s[92:93], v[46:47] op_sel_hi:[1,1,0] neg_lo:[1,0,0] neg_hi:[1,0,0]
    v_pk_fma_f32 v[30:31], v[30:31], s[92:93], v[46:47] op_sel_hi:[1,1,0] neg_lo:[1,0,0] neg_hi:[1,0,0]
    v_pk_fma_f32 v[32:33], v[32:33], s[92:93], v[46:47] op_sel_hi:[1,1,0] neg_lo:[1,0,0] neg_hi:[1,0,0]
    v_pk_fma_f32 v[34:35], v[34:35], s[92:93], v[46:47] op_sel_hi:[1,1,0] neg_lo:[1,0,0] neg_hi:[1,0,0]
    v_pk_fma_f32 v[36:37], v[36:37], s[92:93], v[46:47] op_sel_hi:[1,1,0] neg_lo:[1,0,0] neg_hi:[1,0,0]
    v_pk_fma_f32 v[38:39], v[38:39], s[92:93], v[46:47] op_sel_hi:[1,1,0] neg_lo:[1,0,0] neg_hi:[1,0,0]
    v_pk_fma_f32 v[40:41], v[40:41], s[92:93], v[46:47] op_sel_hi:[1,1,0] neg_lo:[1,0,0] neg_hi:[1,0,0]
    v_pk_fma_f32 v[42:43], v[42:43], s[92:93], v[46:47] op_sel_hi:[1,1,0] neg_lo:[1,0,0] neg_hi:[1,0,0]
    v_exp_f32 v48, v48
    v_exp_f32 v49, v49
    v_exp_f32 v50, v50
    v_exp_f32 v51, v51
    v_exp_f32 v52, v52
    v_exp_f32 v53, v53
    v_pk_add_f32 v[44:45], v[48:49], v[50:51]
    v_exp_f32 v54, v54
    v_exp_f32 v55, v55
    v_pk_add_f32 v[44:45], v[44:45], v[52:53]
    v_exp_f32 v56, v56
    v_exp_f32 v57, v57
    v_pk_add_f32 v[44:45], v[44:45], v[54:55]
    v_exp_f32 v58, v58
    v_exp_f32 v59, v59
    v_pk_add_f32 v[44:45], v[44:45], v[56:57]
    v_exp_f32 v60, v60
    v_exp_f32 v61, v61
    v_pk_add_f32 v[44:45], v[44:45], v[58:59]
    v_exp_f32 v62, v62
    v_exp_f32 v63, v63
    v_pk_add_f32 v[44:45], v[44:45], v[60:61]
    v_exp_f32 v64, v64
    v_exp_f32 v65, v65
    v_pk_add_f32 v[44:45], v[44:45], v[62:63]
    v_exp_f32 v66, v66
    v_exp_f32 v67, v67
    v_pk_add_f32 v[44:45], v[44:45], v[64:65]
    v_pk_add_f32 v[44:45], v[44:45], v[66:67]
    v_add_f32 v44, v44, v45
    v_rcp_f32_e64 v44, v44
    s_nop 0
    v_pk_mul_f32 v[48:49], v[48:49], v[44:45] op_sel_hi:[1,0]
    v_cvt_pk_bf16_f32 v176, v48, v49
    v_pk_mul_f32 v[50:51], v[50:51], v[44:45] op_sel_hi:[1,0]
    v_cvt_pk_bf16_f32 v177, v50, v51
    v_pk_mul_f32 v[52:53], v[52:53], v[44:45] op_sel_hi:[1,0]
    v_cvt_pk_bf16_f32 v180, v52, v53
    v_pk_mul_f32 v[54:55], v[54:55], v[44:45] op_sel_hi:[1,0]
    v_cvt_pk_bf16_f32 v181, v54, v55
    v_pk_mul_f32 v[56:57], v[56:57], v[44:45] op_sel_hi:[1,0]
    v_cvt_pk_bf16_f32 v178, v56, v57
    v_pk_mul_f32 v[58:59], v[58:59], v[44:45] op_sel_hi:[1,0]
    v_cvt_pk_bf16_f32 v179, v58, v59
    v_pk_mul_f32 v[60:61], v[60:61], v[44:45] op_sel_hi:[1,0]
    v_cvt_pk_bf16_f32 v182, v60, v61
    v_pk_mul_f32 v[62:63], v[62:63], v[44:45] op_sel_hi:[1,0]
    v_cvt_pk_bf16_f32 v183, v62, v63
    v_pk_mul_f32 v[64:65], v[64:65], v[44:45] op_sel_hi:[1,0]
    v_cvt_pk_bf16_f32 v192, v64, v65
    v_pk_mul_f32 v[66:67], v[66:67], v[44:45] op_sel_hi:[1,0]
    v_cvt_pk_bf16_f32 v193, v66, v67
    v_exp_f32 v24, v24
    v_exp_f32 v25, v25
    v_exp_f32 v26, v26
    v_exp_f32 v27, v27
    v_exp_f32 v28, v28
    v_exp_f32 v29, v29
    v_pk_add_f32 v[46:47], v[24:25], v[26:27]
    v_exp_f32 v30, v30
    v_exp_f32 v31, v31
    v_pk_add_f32 v[46:47], v[46:47], v[28:29]
    v_exp_f32 v32, v32
    v_exp_f32 v33, v33
    v_pk_add_f32 v[46:47], v[46:47], v[30:31]
    v_exp_f32 v34, v34
    v_exp_f32 v35, v35
    v_pk_add_f32 v[46:47], v[46:47], v[32:33]
    v_exp_f32 v36, v36
    v_exp_f32 v37, v37
    v_pk_add_f32 v[46:47], v[46:47], v[34:35]
    v_exp_f32 v38, v38
    v_exp_f32 v39, v39
    v_pk_add_f32 v[46:47], v[46:47], v[36:37]
    v_exp_f32 v40, v40
    v_exp_f32 v41, v41
    v_pk_add_f32 v[46:47], v[46:47], v[38:39]
    v_exp_f32 v42, v42
    v_exp_f32 v43, v43
    v_pk_add_f32 v[46:47], v[46:47], v[40:41]
    v_pk_add_f32 v[46:47], v[46:47], v[42:43]
    v_add_f32 v46, v46, v47
    v_rcp_f32_e64 v46, v46
    s_nop 0
    v_pk_mul_f32 v[24:25], v[24:25], v[46:47] op_sel_hi:[1,0]
    v_cvt_pk_bf16_f32 v184, v24, v25
    v_pk_mul_f32 v[26:27], v[26:27], v[46:47] op_sel_hi:[1,0]
    v_cvt_pk_bf16_f32 v185, v26, v27
    v_pk_mul_f32 v[28:29], v[28:29], v[46:47] op_sel_hi:[1,0]
    v_cvt_pk_bf16_f32 v188, v28, v29
    v_pk_mul_f32 v[30:31], v[30:31], v[46:47] op_sel_hi:[1,0]
    v_cvt_pk_bf16_f32 v189, v30, v31
    v_pk_mul_f32 v[32:33], v[32:33], v[46:47] op_sel_hi:[1,0]
    v_cvt_pk_bf16_f32 v186, v32, v33
    v_pk_mul_f32 v[34:35], v[34:35], v[46:47] op_sel_hi:[1,0]
    v_cvt_pk_bf16_f32 v187, v34, v35
    v_pk_mul_f32 v[36:37], v[36:37], v[46:47] op_sel_hi:[1,0]
    v_cvt_pk_bf16_f32 v190, v36, v37
    v_pk_mul_f32 v[38:39], v[38:39], v[46:47] op_sel_hi:[1,0]
    v_cvt_pk_bf16_f32 v191, v38, v39
    v_pk_mul_f32 v[40:41], v[40:41], v[46:47] op_sel_hi:[1,0]
    v_cvt_pk_bf16_f32 v194, v40, v41
    v_pk_mul_f32 v[42:43], v[42:43], v[46:47] op_sel_hi:[1,0]
    v_cvt_pk_bf16_f32 v195, v42, v43
    s_lshl2_add_u32 s88, s53, s52
    s_lshl3_add_u32 s88, s88, s54
    s_lshl_b32 s94, s88, 7
    s_add_u32 s94, s94, 1048576
    s_mul_i32 s88, s88, 2560
    s_add_u32 s88, s88, 6291456
    s_barrier
    ds_read_b128 v[68:71], v19 offset:320
    ds_read_b128 v[72:75], v19 offset:656
    ds_read_b128 v[76:79], v19 offset:992
    ds_read_b128 v[80:83], v19 offset:1328
    ds_read_b128 v[84:87], v19 offset:1664
    ds_read_b128 v[88:91], v19 offset:256
    ds_read_b128 v[92:95], v19 offset:592
    ds_read_b128 v[96:99], v19 offset:928
    ds_read_b128 v[100:103], v19 offset:1264
    ds_read_b128 v[104:107], v19 offset:1600
    s_waitcnt lgkmcnt(9)
    v_mfma_f32_16x16x32_bf16 v[44:47], v[68:71], v[176:179], 0
    ds_read_b128 v[108:111], v19 offset:0
    ds_read_b128 v[112:115], v19 offset:336
    s_waitcnt lgkmcnt(10)
    v_mfma_f32_16x16x32_bf16 v[44:47], v[72:75], v[180:183], v[44:47]
    ds_read_b128 v[116:119], v19 offset:672
    ds_read_b128 v[120:123], v19 offset:1008
    s_waitcnt lgkmcnt(11)
    v_mfma_f32_16x16x32_bf16 v[44:47], v[76:79], v[184:187], v[44:47]
    ds_read_b128 v[124:127], v19 offset:1344
    ds_read_b128 v[128:131], v19 offset:64
    s_waitcnt lgkmcnt(12)
    v_mfma_f32_16x16x32_bf16 v[44:47], v[80:83], v[188:191], v[44:47]
    ds_read_b128 v[132:135], v19 offset:400
    ds_read_b128 v[136:139], v19 offset:736
    s_waitcnt lgkmcnt(13)
    v_mfma_f32_16x16x32_bf16 v[44:47], v[84:87], v[192:195], v[44:47]
    ds_read_b128 v[140:143], v19 offset:1072
    ds_read_b128 v[144:147], v19 offset:1408
    s_waitcnt lgkmcnt(10)
    v_mfma_f32_16x16x32_bf16 v[40:43], v[88:91], v[176:179], 0
    ds_read_b128 v[148:151], v19 offset:128
    ds_read_b128 v[152:155], v19 offset:464
    v_mfma_f32_16x16x32_bf16 v[40:43], v[92:95], v[180:183], v[40:43]
    ds_read_b128 v[156:159], v19 offset:800
    ds_read_b128 v[160:163], v19 offset:1136
    v_mfma_f32_16x16x32_bf16 v[40:43], v[96:99], v[184:187], v[40:43]
    ds_read_b128 v[164:167], v19 offset:1472
    ds_read_b128 v[168:171], v19 offset:192
    v_cvt_pk_bf16_f32 v44, 0, v44
    v_mfma_f32_16x16x32_bf16 v[40:43], v[100:103], v[188:191], v[40:43]
    ds_read_b128 v[172:175], v19 offset:528
    ds_read_b128 v[196:199], v19 offset:864
    v_add_f32 v44, 0x358637bd, v44
    v_mfma_f32_16x16x32_bf16 v[40:43], v[104:107], v[192:195], v[40:43]
    ds_read_b128 v[200:203], v19 offset:1200
    ds_read_b128 v[204:207], v19 offset:1536
    v_cvt_pk_bf16_f32 v44, 0, v44
    s_waitcnt lgkmcnt(15)
    v_mfma_f32_16x16x32_bf16 v[24:27], v[108:111], v[176:179], 0
    v_rcp_f32 v44, v44
    v_mfma_f32_16x16x32_bf16 v[24:27], v[112:115], v[180:183], v[24:27]
    v_mfma_f32_16x16x32_bf16 v[24:27], v[116:119], v[184:187], v[24:27]
    v_cvt_pk_bf16_f32 v40, 0, v40
    v_cvt_pk_bf16_f32 v41, 0, v41
    v_cvt_pk_bf16_f32 v42, 0, v42
    v_mfma_f32_16x16x32_bf16 v[24:27], v[120:123], v[188:191], v[24:27]
    v_cvt_pk_bf16_f32 v43, 0, v43
    v_mul_f32 v40, v40, v44
    v_mul_f32 v41, v41, v44
    v_mfma_f32_16x16x32_bf16 v[24:27], v[124:127], v[192:195], v[24:27]
    v_mul_f32 v42, v42, v44
    v_mul_f32 v43, v43, v44
    v_cvt_pk_bf16_f32 v56, v40, v41
    s_waitcnt lgkmcnt(10)
    v_mfma_f32_16x16x32_bf16 v[28:31], v[128:131], v[176:179], 0
    v_cvt_pk_bf16_f32 v57, v42, v43
    buffer_store_dwordx2 v[56:57], v21, s[36:39], s88 offen offset:512 sc1
    v_mfma_f32_16x16x32_bf16 v[28:31], v[132:135], v[180:183], v[28:31]
    v_mfma_f32_16x16x32_bf16 v[28:31], v[136:139], v[184:187], v[28:31]
    v_cvt_pk_bf16_f32 v24, 0, v24
    v_cvt_pk_bf16_f32 v25, 0, v25
    v_cvt_pk_bf16_f32 v26, 0, v26
    v_mfma_f32_16x16x32_bf16 v[28:31], v[140:143], v[188:191], v[28:31]
    v_cvt_pk_bf16_f32 v27, 0, v27
    v_mul_f32 v24, v24, v44
    v_mul_f32_e64 v25, v25, v44
    v_mfma_f32_16x16x32_bf16 v[28:31], v[144:147], v[192:195], v[28:31]
    v_mul_f32 v26, v26, v44
    v_mul_f32 v27, v27, v44
    v_cvt_pk_bf16_f32 v48, v24, v25
    s_waitcnt lgkmcnt(5)
    v_mfma_f32_16x16x32_bf16 v[32:35], v[148:151], v[176:179], 0
    v_cvt_pk_bf16_f32 v49, v26, v27
    v_mfma_f32_16x16x32_bf16 v[32:35], v[152:155], v[180:183], v[32:35]
    v_mfma_f32_16x16x32_bf16 v[32:35], v[156:159], v[184:187], v[32:35]
    v_cvt_pk_bf16_f32 v28, 0, v28
    v_cvt_pk_bf16_f32 v29, 0, v29
    v_cvt_pk_bf16_f32 v30, 0, v30
    v_mfma_f32_16x16x32_bf16 v[32:35], v[160:163], v[188:191], v[32:35]
    v_cvt_pk_bf16_f32 v31, 0, v31
    v_mul_f32 v28, v28, v44
    v_mul_f32_e64 v29, v29, v44
    v_mfma_f32_16x16x32_bf16 v[32:35], v[164:167], v[192:195], v[32:35]
    v_mul_f32 v30, v30, v44
    v_mul_f32 v31, v31, v44
    v_cvt_pk_bf16_f32 v50, v28, v29
    s_waitcnt lgkmcnt(0)
    v_mfma_f32_16x16x32_bf16 v[36:39], v[168:171], v[176:179], 0
    v_cvt_pk_bf16_f32 v51, v30, v31
    buffer_store_dwordx4 v[48:51], v20, s[36:39], s88 offen sc1
    buffer_store_dword v4, v23, s[36:39], s94 offen sc1
    v_mfma_f32_16x16x32_bf16 v[36:39], v[172:175], v[180:183], v[36:39]
    v_mfma_f32_16x16x32_bf16 v[36:39], v[196:199], v[184:187], v[36:39]
    v_cvt_pk_bf16_f32 v32, 0, v32
    v_cvt_pk_bf16_f32 v33, 0, v33
    v_cvt_pk_bf16_f32 v34, 0, v34
    v_mfma_f32_16x16x32_bf16 v[36:39], v[200:203], v[188:191], v[36:39]
    v_cvt_pk_bf16_f32 v35, 0, v35
    v_mul_f32 v32, v32, v44
    v_mul_f32_e64 v33, v33, v44
    v_mfma_f32_16x16x32_bf16 v[36:39], v[204:207], v[192:195], v[36:39]
    v_mul_f32 v34, v34, v44
    v_mul_f32 v35, v35, v44
    v_cvt_pk_bf16_f32 v52, v32, v33
    v_cvt_pk_bf16_f32 v53, v34, v35
    s_nop 3
    v_cvt_pk_bf16_f32 v36, 0, v36
    v_cvt_pk_bf16_f32 v37, 0, v37
    v_cvt_pk_bf16_f32 v38, 0, v38
    v_cvt_pk_bf16_f32 v39, 0, v39
    v_mul_f32 v36, v36, v44
    v_mul_f32 v37, v37, v44
    v_mul_f32 v38, v38, v44
    v_mul_f32_e64 v39, v39, v44
    v_cvt_pk_bf16_f32 v54, v36, v37
    v_cvt_pk_bf16_f32 v55, v38, v39
    buffer_store_dwordx4 v[52:55], v20, s[36:39], s88 offen offset:256 sc1
    s_cmp_lt_u32 s12, 160
    s_cbranch_scc0 L_fin
    s_barrier
    s_mul_i32 s96, s12, 205
    s_lshr_b32 s96, s96, 10
    s_mul_i32 s69, s96, 5
    s_sub_u32 s97, s12, s69
    v_lshrrev_b32 v24, 4, v1
    v_and_b32 v25, 15, v1
    v_lshlrev_b32 v12, 7, v1
    v_and_b32 v12, 0x380, v12
    s_lshl_b32 s89, s96, 2
    s_add_u32 s89, s89, s52
    s_lshl_b32 s68, s89, 10
    s_add_u32 s68, s68, 1048576
    s_mul_i32 s98, s89, 20480
    s_and_b32 s70, s96, 3
    s_mul_i32 s70, s70, 5120
    s_add_u32 s69, s98, 6291456
    s_mul_i32 s71, s52, 20480
    s_add_u32 s71, s71, 65536
    s_add_u32 s58, s69, s70
    s_add_u32 s70, s70, 5120
    s_cmp_eq_u32 s70, 20480
    s_cselect_b32 s70, 0, s70
    s_add_u32 s59, s69, s70
    s_add_u32 s70, s70, 5120
    s_cmp_eq_u32 s70, 20480
    s_cselect_b32 s70, 0, s70
    s_add_u32 s60, s69, s70
    s_add_u32 s70, s70, 5120
    s_cmp_eq_u32 s70, 20480
    s_cselect_b32 s70, 0, s70
    s_add_u32 s61, s69, s70
    s_mov_b32 s28, s4
    s_and_b32 s29, s5, 0xffff
    s_mov_b32 s30, 2621440
    s_mov_b32 s31, 0x20000
    s_mov_b32 s44, s14
    s_and_b32 s45, s15, 0xffff
    s_mov_b32 s46, 1280
    s_mov_b32 s47, 0x20000
    s_mov_b32 s48, s22
    s_and_b32 s49, s23, 0xffff
    s_mov_b32 s50, 2621440
    s_mov_b32 s51, 0x20000
    s_lshl_b32 s69, s97, 8
    v_lshl_add_u32 v21, v25, 4, s69
    v_mul_u32_u24 v27, 1280, v24
    v_add_u32 v11, v21, v27
    v_xor_b32 v26, v25, v24
    v_lshlrev_b32 v26, 4, v26
    v_lshl_add_u32 v26, v24, 8, v26
    s_lshl_b32 s69, s52, 12
    s_add_u32 s69, s69, 0
    v_add_u32 v13, s69, v26
    v_xor_b32 v14, 64, v13
    v_bfe_u32 v26, v1, 2, 2
    v_lshl_add_u32 v26, v26, 2, v24
    v_and_b32 v27, 3, v1
    v_mov_b32 v24, 1073741824
    v_lshlrev_b32 v25, 4, v26
    v_cmp_eq_u32 vcc, 0, v27
    v_lshl_add_u32 v16, v27, 10, v25
    v_add_u32 v17, 0x1000, v25
    v_cndmask_b32 v15, v24, v25, vcc
    v_lshlrev_b32 v25, 7, v26
    v_cndmask_b32 v20, v24, v25, vcc
    v_lshlrev_b32 v25, 2, v26
    v_cndmask_b32 v19, v24, v25, vcc
    s_lshl_b32 s69, s89, 4
    s_sub_u32 s69, 2047, s69
    v_sub_u32 v18, s69, v26
    s_lshl_b32 s69, s89, 7
    s_add_u32 s69, s69, 69632
    s_cmp_eq_u32 s97, 0
    s_cselect_b32 s95, s69, 1073741824
    s_mul_i32 s69, s96, 5
    s_add_u32 s69, s69, s97
    s_lshl_b32 s69, s69, 2
    s_add_u32 s69, s69, s52
    s_lshl_b32 s69, s69, 7
    s_add_u32 s94, s69, 1179648
    s_mov_b32 s90, 0x3f80
    s_mov_b32 s91, 0x3f800000
    s_waitcnt vmcnt(0)
    buffer_load_dword v24, v12, s[36:39], s68 offen sc1
    s_waitcnt vmcnt(0)
    v_cmp_ne_u32 vcc, s57, v24
    s_cbranch_vccnz spin_f3_32001
ok_f3_32002:
    s_add_u32 m0, s71, 0
    s_nop 0
    buffer_load_dwordx4 v2, s[36:39], s58 offen offset:0 sc1 lds
    buffer_load_dwordx4 v2, s[36:39], s58 offen offset:1024 sc1 lds
    buffer_load_dwordx4 v2, s[36:39], s58 offen offset:2048 sc1 lds
    buffer_load_dwordx4 v2, s[36:39], s58 offen offset:3072 sc1 lds
    s_add_u32 m0, s71, 4096
    s_add_u32 s58, s58, 4096
    buffer_load_dwordx4 v2, s[36:39], s58 offen offset:0 sc1 lds
    s_add_u32 m0, s71, 5120
    s_nop 0
    buffer_load_dwordx4 v2, s[36:39], s59 offen offset:0 sc1 lds
    buffer_load_dwordx4 v2, s[36:39], s59 offen offset:1024 sc1 lds
    buffer_load_dwordx4 v2, s[36:39], s59 offen offset:2048 sc1 lds
    s_waitcnt vmcnt(7)
    s_barrier
    buffer_load_dwordx4 v2, s[36:39], s59 offen offset:3072 sc1 lds
    s_add_u32 m0, s71, 9216
    s_add_u32 s59, s59, 4096
    buffer_load_dwordx4 v2, s[36:39], s59 offen offset:0 sc1 lds
    s_waitcnt vmcnt(7)
    s_barrier
    s_add_u32 m0, s71, 10240
    s_nop 0
    buffer_load_dwordx4 v2, s[36:39], s60 offen offset:0 sc1 lds
    buffer_load_dwordx4 v2, s[36:39], s60 offen offset:1024 sc1 lds
    buffer_load_dwordx4 v2, s[36:39], s60 offen offset:2048 sc1 lds
    s_waitcnt vmcnt(7)
    s_barrier
    buffer_load_dwordx4 v2, s[36:39], s60 offen offset:3072 sc1 lds
    s_add_u32 m0, s71, 14336
    s_add_u32 s60, s60, 4096
    buffer_load_dwordx4 v2, s[36:39], s60 offen offset:0 sc1 lds
    s_add_u32 m0, s71, 15360
    s_nop 0
    buffer_load_dwordx4 v2, s[36:39], s61 offen offset:0 sc1 lds
    buffer_load_dwordx4 v2, s[36:39], s61 offen offset:1024 sc1 lds
    s_waitcnt vmcnt(7)
    s_barrier
    s_nop 0
    buffer_load_dwordx4 v2, s[36:39], s61 offen offset:2048 sc1 lds
    buffer_load_dwordx4 v2, s[36:39], s61 offen offset:3072 sc1 lds
    s_add_u32 m0, s71, 19456
    s_add_u32 s61, s61, 4096
    buffer_load_dwordx4 v2, s[36:39], s61 offen offset:0 sc1 lds
    s_waitcnt vmcnt(5)
    s_barrier
    s_mov_b32 s68, s98
    s_nop 0
    buffer_load_dwordx4 v[32:35], v11, s[28:31], s68 offen
    s_add_u32 s68, s68, 5120
    buffer_load_dwordx4 v[36:39], v11, s[28:31], s68 offen
    s_add_u32 s68, s68, 5120
    buffer_load_dwordx4 v[40:43], v11, s[28:31], s68 offen
    s_add_u32 s68, s68, 5120
    buffer_load_dwordx4 v[44:47], v11, s[28:31], s68 offen
    buffer_load_dwordx4 v[28:31], v21, s[44:47], 0 offen
    buffer_load_dwordx4 v[48:51], v2, s[44:47], 0 offen
    buffer_load_dwordx4 v[52:55], v2, s[44:47], 0 offen offset:1024
    s_waitcnt vmcnt(7)
    s_barrier
    s_setprio 0
    s_or_b32 s68, s2, s52
    s_cmp_eq_u32 s68, 0
    s_cselect_b32 s68, 0, 1073741824
    buffer_store_dword v4, v3, s[36:39], s68 offen sc1
    s_waitcnt vmcnt(7)
    v_lshlrev_b32 v160, 16, v32
    v_and_b32 v161, s79, v32
    v_lshlrev_b32 v162, 16, v33
    v_and_b32 v163, s79, v33
    v_lshlrev_b32 v164, 16, v34
    v_and_b32 v165, s79, v34
    v_lshlrev_b32 v166, 16, v35
    v_and_b32 v167, s79, v35
    s_waitcnt vmcnt(6)
    v_lshlrev_b32 v168, 16, v36
    v_and_b32 v169, s79, v36
    v_lshlrev_b32 v170, 16, v37
    v_and_b32 v171, s79, v37
    v_lshlrev_b32 v172, 16, v38
    v_and_b32 v173, s79, v38
    v_lshlrev_b32 v174, 16, v39
    v_and_b32 v175, s79, v39
    s_waitcnt vmcnt(5)
    v_lshlrev_b32 v176, 16, v40
    v_and_b32 v177, s79, v40
    v_lshlrev_b32 v178, 16, v41
    v_and_b32 v179, s79, v41
    v_lshlrev_b32 v180, 16, v42
    v_and_b32 v181, s79, v42
    v_lshlrev_b32 v182, 16, v43
    v_and_b32 v183, s79, v43
    s_waitcnt vmcnt(4)
    v_lshlrev_b32 v184, 16, v44
    v_and_b32 v185, s79, v44
    v_lshlrev_b32 v186, 16, v45
    v_and_b32 v187, s79, v45
    v_lshlrev_b32 v188, 16, v46
    v_and_b32 v189, s79, v46
    v_lshlrev_b32 v190, 16, v47
    v_and_b32_e64 v191, s79, v47
    s_waitcnt vmcnt(2)
    v_dot2_f32_bf16 v22, v48, s80, 0
    v_dot2_f32_bf16 v22, v49, s80, v22
    v_dot2_f32_bf16 v22, v50, s80, v22
    v_dot2_f32_bf16 v22, v51, s80, v22
    s_waitcnt vmcnt(1)
    v_dot2_f32_bf16 v22, v52, s80, v22
    v_dot2_f32_bf16 v22, v53, s80, v22
    v_dot2_f32_bf16 v22, v54, s80, v22
    v_dot2_f32_bf16 v22, v55, s80, v22
    s_nop 2
    v_add_f32_dpp v22, v22, v22 row_ror:1 row_mask:0xf bank_mask:0xf
    s_nop 1
    v_add_f32_dpp v22, v22, v22 row_ror:2 row_mask:0xf bank_mask:0xf
    s_nop 1
    v_add_f32_dpp v22, v22, v22 row_ror:4 row_mask:0xf bank_mask:0xf
    s_nop 1
    v_add_f32_dpp v22, v22, v22 row_ror:8 row_mask:0xf bank_mask:0xf
    v_mov_b32 v26, v22
    s_nop 1
    v_permlane16_swap_b32 v26, v22
    v_add_f32 v22, v22, v26
    v_mov_b32 v26, v22
    s_nop 1
    v_permlane32_swap_b32 v26, v22
    v_add_f32_e64 v22, v22, v26
    s_mul_i32 s68, s96, 5120
    s_lshl_b32 s69, s52, 8
    s_add_u32 s68, s68, s69
    s_add_u32 s68, s68, 303104
    s_lshl_b32 s69, s97, 10
    s_add_u32 s69, s69, s68
    s_add_u32 s70, s98, 8912896
    v_mov_b32_e64 v127, s57
    s_waitcnt vmcnt(0)
    s_barrier
    ds_read_b128 v[96:99], v13 offset:0
    ds_read_b128 v[100:103], v14 offset:1024
    ds_read_b128 v[104:107], v13 offset:2048
    ds_read_b128 v[108:111], v14 offset:3072
    s_waitcnt lgkmcnt(3)
    s_nop 0
    v_dot2_f32_bf16 v64, v96, s90, v160
    v_dot2_f32_bf16 v65, v96, s91, v161
    v_dot2_f32_bf16 v66, v97, s90, v162
    v_dot2_f32_bf16 v67, v97, s91, v163
    v_dot2_f32_bf16 v68, v98, s90, v164
    v_dot2_f32_bf16 v69, v98, s91, v165
    v_dot2_f32_bf16 v70, v99, s90, v166
    v_dot2_f32_bf16 v71, v99, s91, v167
    v_cvt_pk_bf16_f32 v96, v64, v65
    v_cvt_pk_bf16_f32 v97, v66, v67
    v_cvt_pk_bf16_f32 v98, v68, v69
    v_cvt_pk_bf16_f32 v99, v70, v71
    s_waitcnt lgkmcnt(2)
    s_nop 0
    v_dot2_f32_bf16 v72, v100, s90, v168
    v_dot2_f32_bf16 v73, v100, s91, v169
    v_dot2_f32_bf16 v74, v101, s90, v170
    v_dot2_f32_bf16 v75, v101, s91, v171
    v_dot2_f32_bf16 v76, v102, s90, v172
    v_dot2_f32_bf16 v77, v102, s91, v173
    v_dot2_f32_bf16 v78, v103, s90, v174
    v_dot2_f32_bf16 v79, v103, s91, v175
    v_cvt_pk_bf16_f32 v100, v72, v73
    v_cvt_pk_bf16_f32 v101, v74, v75
    v_cvt_pk_bf16_f32 v102, v76, v77
    v_cvt_pk_bf16_f32 v103, v78, v79
    s_waitcnt lgkmcnt(1)
    s_nop 0
    v_dot2_f32_bf16 v80, v104, s90, v176
    v_dot2_f32_bf16 v81, v104, s91, v177
    v_dot2_f32_bf16 v82, v105, s90, v178
    v_dot2_f32_bf16 v83, v105, s91, v179
    v_dot2_f32_bf16 v84, v106, s90, v180
    v_dot2_f32_bf16 v85, v106, s91, v181
    v_dot2_f32_bf16 v86, v107, s90, v182
    v_dot2_f32_bf16 v87, v107, s91, v183
    v_cvt_pk_bf16_f32 v104, v80, v81
    v_cvt_pk_bf16_f32 v105, v82, v83
    v_cvt_pk_bf16_f32 v106, v84, v85
    v_cvt_pk_bf16_f32 v107, v86, v87
    s_waitcnt lgkmcnt(0)
    s_nop 0
    v_dot2_f32_bf16 v88, v108, s90, v184
    v_dot2_f32_bf16 v89, v108, s91, v185
    v_dot2_f32_bf16 v90, v109, s90, v186
    v_dot2_f32_bf16 v91, v109, s91, v187
    v_dot2_f32_bf16 v92, v110, s90, v188
    v_dot2_f32_bf16 v93, v110, s91, v189
    v_dot2_f32_bf16 v94, v111, s90, v190
    v_dot2_f32_bf16 v95, v111, s91, v191
    v_cvt_pk_bf16_f32 v108, v88, v89
    v_cvt_pk_bf16_f32 v109, v90, v91
    v_cvt_pk_bf16_f32 v110, v92, v93
    v_cvt_pk_bf16_f32 v111, v94, v95
    v_dot2_f32_bf16 v112, v96, s80, 0
    v_dot2_f32_bf16 v116, v96, v96, 0
    v_dot2_f32_bf16 v120, v96, v28, 0
    v_dot2_f32_bf16 v112, v97, s80, v112
    v_dot2_f32_bf16 v116, v97, v97, v116
    v_dot2_f32_bf16 v120, v97, v29, v120
    v_dot2_f32_bf16 v112, v98, s80, v112
    v_dot2_f32_bf16 v116, v98, v98, v116
    v_dot2_f32_bf16 v120, v98, v30, v120
    v_dot2_f32_bf16 v112, v99, s80, v112
    v_dot2_f32_bf16 v116, v99, v99, v116
    v_dot2_f32_bf16 v120, v99, v31, v120
    v_dot2_f32_bf16 v113, v100, s80, 0
    v_dot2_f32_bf16 v117, v100, v100, 0
    v_dot2_f32_bf16 v121, v100, v28, 0
    v_dot2_f32_bf16 v113, v101, s80, v113
    v_dot2_f32_bf16 v117, v101, v101, v117
    v_dot2_f32_bf16 v121, v101, v29, v121
    v_dot2_f32_bf16 v113, v102, s80, v113
    v_dot2_f32_bf16 v117, v102, v102, v117
    v_dot2_f32_bf16 v121, v102, v30, v121
    v_dot2_f32_bf16 v113, v103, s80, v113
    v_dot2_f32_bf16 v117, v103, v103, v117
    v_dot2_f32_bf16 v121, v103, v31, v121
    v_dot2_f32_bf16 v114, v104, s80, 0
    v_dot2_f32_bf16 v118, v104, v104, 0
    v_dot2_f32_bf16 v122, v104, v28, 0
    v_dot2_f32_bf16 v114, v105, s80, v114
    v_dot2_f32_bf16 v118, v105, v105, v118
    v_dot2_f32_bf16 v122, v105, v29, v122
    v_dot2_f32_bf16 v114, v106, s80, v114
    v_dot2_f32_bf16 v118, v106, v106, v118
    v_dot2_f32_bf16 v122, v106, v30, v122
    v_dot2_f32_bf16 v114, v107, s80, v114
    v_dot2_f32_bf16 v118, v107, v107, v118
    v_dot2_f32_bf16 v122, v107, v31, v122
    v_dot2_f32_bf16 v115, v108, s80, 0
    v_dot2_f32_bf16 v119, v108, v108, 0
    v_dot2_f32_bf16 v123, v108, v28, 0
    v_dot2_f32_bf16 v115, v109, s80, v115
    v_dot2_f32_bf16 v119, v109, v109, v119
    v_dot2_f32_bf16 v123, v109, v29, v123
    v_dot2_f32_bf16 v115, v110, s80, v115
    v_dot2_f32_bf16 v119, v110, v110, v119
    v_dot2_f32_bf16 v123, v110, v30, v123
    v_dot2_f32_bf16 v115, v111, s80, v115
    v_dot2_f32_bf16 v119, v111, v111, v119
    v_dot2_f32_bf16 v123, v111, v31, v123
    v_add_f32_dpp v112, v112, v112 row_ror:8 row_mask:0xf bank_mask:0x3
    v_add_f32_dpp v113, v113, v113 row_ror:8 row_mask:0xf bank_mask:0x3
    v_add_f32_dpp v116, v116, v116 row_ror:8 row_mask:0xf bank_mask:0x3
    v_add_f32_dpp v117, v117, v117 row_ror:8 row_mask:0xf bank_mask:0x3
    v_add_f32_dpp v120, v120, v120 row_ror:8 row_mask:0xf bank_mask:0x3
    v_add_f32_dpp v121, v121, v121 row_ror:8 row_mask:0xf bank_mask:0x3
    v_add_f32_dpp v112, v114, v114 row_ror:8 row_mask:0xf bank_mask:0xc
    v_add_f32_dpp v113, v115, v115 row_ror:8 row_mask:0xf bank_mask:0xc
    v_add_f32_dpp v116, v118, v118 row_ror:8 row_mask:0xf bank_mask:0xc
    v_add_f32_dpp v117, v119, v119 row_ror:8 row_mask:0xf bank_mask:0xc
    v_add_f32_dpp v120, v122, v122 row_ror:8 row_mask:0xf bank_mask:0xc
    v_add_f32_dpp v121, v123, v123 row_ror:8 row_mask:0xf bank_mask:0xc
    v_add_f32_dpp v112, v112, v112 row_half_mirror row_mask:0xf bank_mask:0x5
    v_add_f32_dpp v116, v116, v116 row_half_mirror row_mask:0xf bank_mask:0x5
    v_add_f32_dpp v120, v120, v120 row_half_mirror row_mask:0xf bank_mask:0x5
    v_add_f32_dpp v112, v113, v113 row_half_mirror row_mask:0xf bank_mask:0xa
    v_add_f32_dpp v116, v117, v117 row_half_mirror row_mask:0xf bank_mask:0xa
    v_add_f32_dpp v120, v121, v121 row_half_mirror row_mask:0xf bank_mask:0xa
    v_add_f32_dpp v112, v112, v112 quad_perm:[1,0,3,2] row_mask:0xf bank_mask:0xf
    v_add_f32_dpp v116, v116, v116 quad_perm:[1,0,3,2] row_mask:0xf bank_mask:0xf
    v_add_f32_dpp v120, v120, v120 quad_perm:[1,0,3,2] row_mask:0xf bank_mask:0xf
    v_add_f32_dpp v124, v112, v112 quad_perm:[2,3,0,1] row_mask:0xf bank_mask:0xf
    v_add_f32_dpp v125, v116, v116 quad_perm:[2,3,0,1] row_mask:0xf bank_mask:0xf
    v_add_f32_dpp v126, v120, v120 quad_perm:[2,3,0,1] row_mask:0xf bank_mask:0xf
    buffer_store_dwordx4 v[124:127], v15, s[36:39], s69 offen sc1
    buffer_store_dwordx4 v[96:99], v11, s[36:39], s70 offen sc1
    s_add_u32 s70, s70, 5120
    s_barrier
    s_nop 0
    buffer_store_dwordx4 v[100:103], v11, s[36:39], s70 offen sc1
    s_add_u32 s70, s70, 5120
    buffer_store_dwordx4 v[104:107], v11, s[36:39], s70 offen sc1
    s_add_u32 s70, s70, 5120
    buffer_store_dwordx4 v[108:111], v11, s[36:39], s70 offen sc1
    s_lshl_b32 s70, s96, 7
    s_lshl_b32 s71, s97, 2
    s_add_u32 s70, s70, s71
    s_add_u32 s70, s70, 36864
    s_cmp_eq_u32 s52, 0
    s_cselect_b32 s70, s70, 1073741824
    s_lshl_b32 s88, s96, 7
    s_add_u32 s88, s88, 159744
    s_or_b32 s71, s71, s52
    s_cmp_eq_u32 s71, 1
    s_cselect_b32 s88, s88, 1073741824
    s_waitcnt vmcnt(0)
    buffer_load_dwordx4 v[128:131], v16, s[36:39], s68 offen sc1
    buffer_load_dwordx4 v[136:139], v17, s[36:39], s68 offen sc1
    s_barrier
    buffer_store_dword v4, v3, s[36:39], s70 offen sc1
    s_waitcnt vmcnt(2)
    v_cmp_ne_u32 vcc, s57, v131
    s_waitcnt vmcnt(1)
    v_cmp_ne_u32 s[76:77], s57, v139
    s_or_b64 vcc, vcc, s[76:77]
    s_cbranch_vccnz spin_st_34003
ok_st_34004:
    v_add_f32_dpp v128, v128, v128 quad_perm:[1,0,3,2] row_mask:0xf bank_mask:0xf
    v_add_f32_dpp v129, v129, v129 quad_perm:[1,0,3,2] row_mask:0xf bank_mask:0xf
    v_add_f32_dpp v130, v130, v130 quad_perm:[1,0,3,2] row_mask:0xf bank_mask:0xf
    v_add_f32_dpp v128, v128, v128 quad_perm:[2,3,0,1] row_mask:0xf bank_mask:0xf
    v_add_f32_dpp v129, v129, v129 quad_perm:[2,3,0,1] row_mask:0xf bank_mask:0xf
    v_add_f32_dpp v130, v130, v130 quad_perm:[2,3,0,1] row_mask:0xf bank_mask:0xf
    v_pk_add_f32 v[128:129], v[128:129], v[136:137]
    v_add_f32_e64 v130, v130, v138
    v_mul_f32 v128, 0x3acccccd, v128
    v_mul_f32 v129, 0x3acccccd, v129
    v_fma_f32 v129, -v128, v128, v129
    v_max_f32_e64 v129, 0, v129
    v_cvt_pk_bf16_f32 v129, 0, v129
    v_add_f32 v129, 0x3727c5ac, v129
    v_cvt_pk_bf16_f32 v129, 0, v129
    v_sqrt_f32_e64 v129, v129
    v_cvt_pk_bf16_f32 v128, 0, v128
    v_cvt_pk_bf16_f32 v129, 0, v129
    v_rcp_f32_e64 v133, v129
    v_xor_b32 v137, 0x80000000, v128
    v_mov_b32 v129, v133
    v_mov_b32 v131, s57
    v_mov_b32_dpp v140, v137 row_newbcast:0 row_mask:0xf bank_mask:0xf
    v_mov_b32_dpp v144, v133 row_newbcast:0 row_mask:0xf bank_mask:0xf
    v_mov_b32_dpp v141, v137 row_newbcast:4 row_mask:0xf bank_mask:0xf
    v_mov_b32_dpp v146, v133 row_newbcast:4 row_mask:0xf bank_mask:0xf
    v_mov_b32_dpp v142, v137 row_newbcast:8 row_mask:0xf bank_mask:0xf
    v_mov_b32_dpp v148, v133 row_newbcast:8 row_mask:0xf bank_mask:0xf
    v_mov_b32_dpp v143, v137 row_newbcast:12 row_mask:0xf bank_mask:0xf
    v_mov_b32_dpp v150, v133 row_newbcast:12 row_mask:0xf bank_mask:0xf
    v_dot2_f32_bf16 v64, v96, s90, v140
    v_dot2_f32_bf16 v65, v96, s91, v140
    v_dot2_f32_bf16 v66, v97, s90, v140
    v_dot2_f32_bf16 v67, v97, s91, v140
    v_dot2_f32_bf16 v68, v98, s90, v140
    v_dot2_f32_bf16 v69, v98, s91, v140
    v_dot2_f32_bf16 v70, v99, s90, v140
    v_dot2_f32_bf16 v71, v99, s91, v140
    v_cvt_pk_bf16_f32 v64, 0, v64
    v_cvt_pk_bf16_f32 v65, 0, v65
    v_cvt_pk_bf16_f32 v66, 0, v66
    v_cvt_pk_bf16_f32 v67, 0, v67
    v_cvt_pk_bf16_f32 v68, 0, v68
    v_cvt_pk_bf16_f32 v69, 0, v69
    v_cvt_pk_bf16_f32 v70, 0, v70
    v_cvt_pk_bf16_f32 v71, 0, v71
    v_pk_mul_f32 v[64:65], v[64:65], v[144:145] op_sel_hi:[1,0]
    v_pk_mul_f32 v[66:67], v[66:67], v[144:145] op_sel_hi:[1,0]
    v_pk_mul_f32 v[68:69], v[68:69], v[144:145] op_sel_hi:[1,0]
    v_pk_mul_f32 v[70:71], v[70:71], v[144:145] op_sel_hi:[1,0]
    v_cvt_pk_bf16_f32 v32, v64, v65
    v_cvt_pk_bf16_f32 v33, v66, v67
    v_cvt_pk_bf16_f32 v34, v68, v69
    v_cvt_pk_bf16_f32 v35, v70, v71
    v_dot2_f32_bf16 v72, v100, s90, v141
    v_dot2_f32_bf16 v73, v100, s91, v141
    v_dot2_f32_bf16 v74, v101, s90, v141
    v_dot2_f32_bf16 v75, v101, s91, v141
    v_dot2_f32_bf16 v76, v102, s90, v141
    v_dot2_f32_bf16 v77, v102, s91, v141
    v_dot2_f32_bf16 v78, v103, s90, v141
    v_dot2_f32_bf16 v79, v103, s91, v141
    v_cvt_pk_bf16_f32 v72, 0, v72
    v_cvt_pk_bf16_f32 v73, 0, v73
    v_cvt_pk_bf16_f32 v74, 0, v74
    v_cvt_pk_bf16_f32 v75, 0, v75
    v_cvt_pk_bf16_f32 v76, 0, v76
    v_cvt_pk_bf16_f32 v77, 0, v77
    v_cvt_pk_bf16_f32 v78, 0, v78
    v_cvt_pk_bf16_f32 v79, 0, v79
    v_pk_mul_f32 v[72:73], v[72:73], v[146:147] op_sel_hi:[1,0]
    v_pk_mul_f32 v[74:75], v[74:75], v[146:147] op_sel_hi:[1,0]
    v_pk_mul_f32 v[76:77], v[76:77], v[146:147] op_sel_hi:[1,0]
    v_pk_mul_f32 v[78:79], v[78:79], v[146:147] op_sel_hi:[1,0]
    v_cvt_pk_bf16_f32 v36, v72, v73
    v_cvt_pk_bf16_f32 v37, v74, v75
    v_cvt_pk_bf16_f32 v38, v76, v77
    v_cvt_pk_bf16_f32 v39, v78, v79
    v_dot2_f32_bf16 v80, v104, s90, v142
    v_dot2_f32_bf16 v81, v104, s91, v142
    v_dot2_f32_bf16 v82, v105, s90, v142
    v_dot2_f32_bf16 v83, v105, s91, v142
    v_dot2_f32_bf16 v84, v106, s90, v142
    v_dot2_f32_bf16 v85, v106, s91, v142
    v_dot2_f32_bf16 v86, v107, s90, v142
    v_dot2_f32_bf16 v87, v107, s91, v142
    v_cvt_pk_bf16_f32 v80, 0, v80
    v_cvt_pk_bf16_f32 v81, 0, v81
    v_cvt_pk_bf16_f32 v82, 0, v82
    v_cvt_pk_bf16_f32 v83, 0, v83
    v_cvt_pk_bf16_f32 v84, 0, v84
    v_cvt_pk_bf16_f32 v85, 0, v85
    v_cvt_pk_bf16_f32 v86, 0, v86
    v_cvt_pk_bf16_f32 v87, 0, v87
    v_pk_mul_f32 v[80:81], v[80:81], v[148:149] op_sel_hi:[1,0]
    v_pk_mul_f32 v[82:83], v[82:83], v[148:149] op_sel_hi:[1,0]
    v_pk_mul_f32 v[84:85], v[84:85], v[148:149] op_sel_hi:[1,0]
    v_pk_mul_f32 v[86:87], v[86:87], v[148:149] op_sel_hi:[1,0]
    v_cvt_pk_bf16_f32 v40, v80, v81
    v_cvt_pk_bf16_f32 v41, v82, v83
    v_cvt_pk_bf16_f32 v42, v84, v85
    v_cvt_pk_bf16_f32 v43, v86, v87
    v_dot2_f32_bf16 v88, v108, s90, v143
    v_dot2_f32_bf16 v89, v108, s91, v143
    v_dot2_f32_bf16 v90, v109, s90, v143
    v_dot2_f32_bf16 v91, v109, s91, v143
    v_dot2_f32_bf16 v92, v110, s90, v143
    v_dot2_f32_bf16 v93, v110, s91, v143
    v_dot2_f32_bf16 v94, v111, s90, v143
    v_dot2_f32_bf16 v95, v111, s91, v143
    v_cvt_pk_bf16_f32 v88, 0, v88
    v_cvt_pk_bf16_f32 v89, 0, v89
    v_cvt_pk_bf16_f32 v90, 0, v90
    v_cvt_pk_bf16_f32 v91, 0, v91
    v_cvt_pk_bf16_f32 v92, 0, v92
    v_cvt_pk_bf16_f32 v93, 0, v93
    v_cvt_pk_bf16_f32 v94, 0, v94
    v_cvt_pk_bf16_f32 v95, 0, v95
    v_pk_mul_f32 v[88:89], v[88:89], v[150:151] op_sel_hi:[1,0]
    v_pk_mul_f32 v[90:91], v[90:91], v[150:151] op_sel_hi:[1,0]
    v_pk_mul_f32 v[92:93], v[92:93], v[150:151] op_sel_hi:[1,0]
    v_pk_mul_f32 v[94:95], v[94:95], v[150:151] op_sel_hi:[1,0]
    v_cvt_pk_bf16_f32 v44, v88, v89
    v_cvt_pk_bf16_f32 v45, v90, v91
    v_cvt_pk_bf16_f32 v46, v92, v93
    v_cvt_pk_bf16_f32 v47, v94, v95
    v_dot2_f32_bf16 v112, v32, v28, 0
    v_dot2_f32_bf16 v113, v36, v28, 0
    v_dot2_f32_bf16 v114, v40, v28, 0
    v_dot2_f32_bf16 v115, v44, v28, 0
    v_dot2_f32_bf16 v112, v33, v29, v112
    v_dot2_f32_bf16 v113, v37, v29, v113
    v_dot2_f32_bf16 v114, v41, v29, v114
    v_dot2_f32_bf16 v115, v45, v29, v115
    v_dot2_f32_bf16 v112, v34, v30, v112
    v_dot2_f32_bf16 v113, v38, v30, v113
    v_dot2_f32_bf16 v114, v42, v30, v114
    v_dot2_f32_bf16 v115, v46, v30, v115
    v_dot2_f32_bf16 v112, v35, v31, v112
    v_dot2_f32_bf16 v113, v39, v31, v113
    v_dot2_f32_bf16 v114, v43, v31, v114
    v_dot2_f32_bf16 v115, v47, v31, v115
    s_lshl_b32 s68, s89, 11
    s_lshl_b32 s69, s97, 4
    s_add_u32 s68, s68, s69
    s_add_u32 s68, s68, 466944
    s_mov_b32 s69, s98
    v_add_f32_dpp v112, v112, v112 row_ror:8 row_mask:0xf bank_mask:0x3
    v_add_f32_dpp v113, v113, v113 row_ror:8 row_mask:0xf bank_mask:0x3
    s_nop 0
    v_add_f32_dpp v112, v114, v114 row_ror:8 row_mask:0xf bank_mask:0xc
    v_add_f32_dpp v113, v115, v115 row_ror:8 row_mask:0xf bank_mask:0xc
    s_nop 0
    v_add_f32_dpp v112, v112, v112 row_half_mirror row_mask:0xf bank_mask:0x5
    s_nop 1
    v_add_f32_dpp v112, v113, v113 row_half_mirror row_mask:0xf bank_mask:0xa
    s_nop 1
    v_add_f32_dpp v112, v112, v112 quad_perm:[1,0,3,2] row_mask:0xf bank_mask:0xf
    s_nop 1
    v_add_f32_dpp v130, v112, v112 quad_perm:[2,3,0,1] row_mask:0xf bank_mask:0xf
    buffer_store_dwordx4 v[128:131], v20, s[36:39], s68 offen sc1
    v_lshlrev_b32 v64, 16, v96
    v_and_b32 v65, s79, v96
    v_lshlrev_b32 v66, 16, v97
    v_and_b32 v67, s79, v97
    v_lshlrev_b32 v68, 16, v98
    v_and_b32 v69, s79, v98
    v_lshlrev_b32 v70, 16, v99
    v_and_b32_e64 v71, s79, v99
    v_dot2_f32_bf16 v64, v32, s90, v64
    v_dot2_f32_bf16 v65, v32, s91, v65
    v_dot2_f32_bf16 v66, v33, s90, v66
    v_dot2_f32_bf16 v67, v33, s91, v67
    v_dot2_f32_bf16 v68, v34, s90, v68
    v_dot2_f32_bf16 v69, v34, s91, v69
    v_dot2_f32_bf16 v70, v35, s90, v70
    v_dot2_f32_bf16 v71, v35, s91, v71
    v_cvt_pk_bf16_f32 v96, v64, v65
    v_cvt_pk_bf16_f32 v97, v66, v67
    v_cvt_pk_bf16_f32 v98, v68, v69
    v_cvt_pk_bf16_f32 v99, v70, v71
    buffer_store_dwordx4 v[96:99], v11, s[48:51], s69 offen sc1
    s_add_u32 s69, s69, 5120
    v_lshlrev_b32 v72, 16, v100
    v_and_b32 v73, s79, v100
    v_lshlrev_b32 v74, 16, v101
    v_and_b32 v75, s79, v101
    v_lshlrev_b32 v76, 16, v102
    v_and_b32 v77, s79, v102
    v_lshlrev_b32 v78, 16, v103
    v_and_b32 v79, s79, v103
    v_dot2_f32_bf16 v72, v36, s90, v72
    v_dot2_f32_bf16 v73, v36, s91, v73
    v_dot2_f32_bf16 v74, v37, s90, v74
    v_dot2_f32_bf16 v75, v37, s91, v75
    v_dot2_f32_bf16 v76, v38, s90, v76
    v_dot2_f32_bf16 v77, v38, s91, v77
    v_dot2_f32_bf16 v78, v39, s90, v78
    v_dot2_f32_bf16 v79, v39, s91, v79
    v_cvt_pk_bf16_f32 v100, v72, v73
    v_cvt_pk_bf16_f32 v101, v74, v75
    v_cvt_pk_bf16_f32 v102, v76, v77
    v_cvt_pk_bf16_f32 v103, v78, v79
    buffer_store_dwordx4 v[100:103], v11, s[48:51], s69 offen sc1
    s_add_u32 s69, s69, 5120
    v_lshlrev_b32 v80, 16, v104
    v_and_b32 v81, s79, v104
    v_lshlrev_b32 v82, 16, v105
    v_and_b32 v83, s79, v105
    v_lshlrev_b32 v84, 16, v106
    v_and_b32 v85, s79, v106
    v_lshlrev_b32 v86, 16, v107
    v_and_b32 v87, s79, v107
    v_dot2_f32_bf16 v80, v40, s90, v80
    v_dot2_f32_bf16 v81, v40, s91, v81
    v_dot2_f32_bf16 v82, v41, s90, v82
    v_dot2_f32_bf16 v83, v41, s91, v83
    v_dot2_f32_bf16 v84, v42, s90, v84
    v_dot2_f32_bf16 v85, v42, s91, v85
    v_dot2_f32_bf16 v86, v43, s90, v86
    v_dot2_f32_bf16 v87, v43, s91, v87
    v_cvt_pk_bf16_f32 v104, v80, v81
    v_cvt_pk_bf16_f32 v105, v82, v83
    v_cvt_pk_bf16_f32 v106, v84, v85
    v_cvt_pk_bf16_f32 v107, v86, v87
    buffer_store_dwordx4 v[104:107], v11, s[48:51], s69 offen sc1
    s_add_u32 s69, s69, 5120
    v_lshlrev_b32 v88, 16, v108
    v_and_b32 v89, s79, v108
    v_lshlrev_b32 v90, 16, v109
    v_and_b32 v91, s79, v109
    v_lshlrev_b32 v92, 16, v110
    v_and_b32 v93, s79, v110
    v_lshlrev_b32 v94, 16, v111
    v_and_b32 v95, s79, v111
    v_dot2_f32_bf16 v88, v44, s90, v88
    v_dot2_f32_bf16 v89, v44, s91, v89
    v_dot2_f32_bf16 v90, v45, s90, v90
    v_dot2_f32_bf16 v91, v45, s91, v91
    v_dot2_f32_bf16 v92, v46, s90, v92
    v_dot2_f32_bf16 v93, v46, s91, v93
    v_dot2_f32_bf16 v94, v47, s90, v94
    v_dot2_f32_bf16 v95, v47, s91, v95
    v_cvt_pk_bf16_f32 v108, v88, v89
    v_cvt_pk_bf16_f32 v109, v90, v91
    v_cvt_pk_bf16_f32 v110, v92, v93
    v_cvt_pk_bf16_f32 v111, v94, v95
    buffer_store_dwordx4 v[108:111], v11, s[48:51], s69 offen sc1
    s_waitcnt vmcnt(0)
    buffer_store_dword v4, v23, s[36:39], s94 offen sc1
    s_branch L_fin
L_B:
    s_setprio 2
    s_lshl_b32 s69, s87, 1
    s_add_u32 s69, s69, s52
    s_nop 0
    s_mul_i32 s89, s54, 160
    s_add_u32 s70, s89, 1280
    s_mul_i32 s71, s54, 204800
    s_add_u32 s71, s71, 11534336
    s_mul_i32 s72, s52, 5120
    s_lshl_b32 s73, s52, 10
    v_lshlrev_b32 v23, 4, v0
    v_mov_b32_e64 v36, 1073741824
    v_cmp_gt_u32 vcc, 200, v0
    s_mul_i32 s68, s54, 3200
    s_add_u32 m0, s73, 159744
    v_cndmask_b32_e64 v17, v36, v23, vcc
    s_waitcnt lgkmcnt(0)
    s_mov_b32 s40, s8
    s_and_b32 s41, s9, 0xffff
    s_mov_b32 s42, 25600
    s_mov_b32 s43, 0x20000
    buffer_load_dwordx4 v17, s[40:43], s68 offen lds
    s_load_dword s57, s[26:27], 0
    s_mov_b32 s36, s26
    s_and_b32 s37, s27, 0xffff
    s_mov_b32 s38, 268435456
    s_mov_b32 s39, 0x20000
    s_mov_b32 s32, s6
    s_and_b32 s33, s7, 0xffff
    s_mov_b32 s34, 2457600
    s_mov_b32 s35, 0x20000
    s_mov_b32 s48, s10
    s_and_b32 s49, s11, 0xffff
    s_mov_b32 s50, 819200
    s_mov_b32 s51, 0x20000
    s_cmp_ge_u32 s69, 20
    s_cselect_b32 s88, 20, 0
    s_sub_u32 s69, s69, s88
    s_mul_i32 s88, s69, 122880
    s_add_u32 s58, s88, s70
    s_mul_i32 s88, s69, 5120
    s_add_u32 s63, s88, s71
    s_add_u32 s69, s69, 4
    s_cmp_ge_u32 s69, 20
    s_cselect_b32 s88, 20, 0
    s_sub_u32 s69, s69, s88
    s_mul_i32 s88, s69, 122880
    s_add_u32 s59, s88, s70
    s_mul_i32 s88, s69, 5120
    s_add_u32 s64, s88, s71
    s_add_u32 s69, s69, 4
    s_cmp_ge_u32 s69, 20
    s_cselect_b32 s88, 20, 0
    s_sub_u32 s69, s69, s88
    s_mul_i32 s88, s69, 122880
    s_add_u32 s60, s88, s70
    s_mul_i32 s88, s69, 5120
    s_add_u32 s65, s88, s71
    s_add_u32 s69, s69, 4
    s_cmp_ge_u32 s69, 20
    s_cselect_b32 s88, 20, 0
    s_sub_u32 s69, s69, s88
    s_mul_i32 s88, s69, 122880
    s_add_u32 s61, s88, s70
    s_mul_i32 s88, s69, 5120
    s_add_u32 s66, s88, s71
    s_add_u32 s69, s69, 4
    s_cmp_ge_u32 s69, 20
    s_cselect_b32 s88, 20, 0
    s_sub_u32 s69, s69, s88
    s_mul_i32 s88, s69, 122880
    s_add_u32 s62, s88, s70
    s_mul_i32 s88, s69, 5120
    s_add_u32 s67, s88, s71
    s_add_u32 s69, s69, 4
    s_and_b32 s69, s53, 15
    s_mul_i32 s69, s69, 5
    s_add_u32 s70, s69, s52
    s_mul_i32 s88, s70, 30720
    s_add_u32 s89, s89, s88
    s_cmp_lt_u32 s53, 16
    s_cselect_b32 s88, 2560, 0
    s_add_u32 s94, s89, s88
    s_sub_u32 s88, 3, s52
    s_mul_i32 s88, s88, 30720
    s_mov_b32 s89, 3840
    v_add_u32_e64 v32, 0, v1
    v_mul_u32_u24 v33, 205, v32
    v_lshrrev_b32_e64 v33, 11, v33
    v_mad_i32_i24 v32, v33, -10, v1
    v_lshrrev_b32 v35, 1, v33
    v_xor_b32 v35, v35, v33
    v_bfe_i32 v35, v35, 2, 1
    v_lshlrev_b32_e64 v32, 4, v32
    v_bitop3_b32 v35, v35, 12, v33 bitop3:0x6a
    v_mad_u32_u24 v11, v35, s89, v32
    v_mad_u32_u24 v32, v33, s89, v32
    v_lshrrev_b32_e64 v34, 3, v33
    v_mad_u32_u24 v60, v34, s88, v32
    v_add_u32_e64 v32, 64, v1
    v_mul_u32_u24 v33, 205, v32
    v_lshrrev_b32_e64 v33, 11, v33
    v_mad_i32_i24 v32, v33, -10, v1
    v_lshrrev_b32 v35, 1, v33
    v_xor_b32 v35, v35, v33
    v_bfe_i32 v35, v35, 2, 1
    v_lshlrev_b32_e64 v32, 4, v32
    v_bitop3_b32 v35, v35, 12, v33 bitop3:0x6a
    v_mad_u32_u24 v12, v35, s89, v32
    v_mad_u32_u24 v32, v33, s89, v32
    v_lshrrev_b32_e64 v34, 3, v33
    v_mad_u32_u24 v61, v34, s88, v32
    v_add_u32 v32, 128, v1
    v_mul_u32_u24 v33, 205, v32
    v_lshrrev_b32_e64 v33, 11, v33
    v_mad_i32_i24 v32, v33, -10, v1
    v_lshrrev_b32 v35, 1, v33
    v_xor_b32 v35, v35, v33
    v_bfe_i32 v35, v35, 2, 1
    v_lshlrev_b32_e64 v32, 4, v32
    v_bitop3_b32 v35, v35, 12, v33 bitop3:0x6a
    v_mad_u32_u24 v13, v35, s89, v32
    v_mad_u32_u24 v32, v33, s89, v32
    v_lshrrev_b32_e64 v34, 3, v33
    v_mad_u32_u24 v62, v34, s88, v32
    v_add_u32 v32, 192, v1
    v_mul_u32_u24 v33, 205, v32
    v_lshrrev_b32_e64 v33, 11, v33
    v_mad_i32_i24 v32, v33, -10, v1
    v_lshrrev_b32 v35, 1, v33
    v_xor_b32 v35, v35, v33
    v_bfe_i32 v35, v35, 2, 1
    v_lshlrev_b32_e64 v32, 4, v32
    v_bitop3_b32 v35, v35, 12, v33 bitop3:0x6a
    v_mad_u32_u24 v14, v35, s89, v32
    v_add_u32 v32, 256, v1
    v_mul_u32_u24 v33, 205, v32
    v_lshrrev_b32_e64 v33, 11, v33
    v_mad_i32_i24 v32, v33, -10, v32
    v_lshrrev_b32 v35, 1, v33
    v_xor_b32 v35, v35, v33
    v_bfe_i32 v35, v35, 2, 1
    v_lshlrev_b32_e64 v32, 4, v32
    v_bitop3_b32 v35, v35, 12, v33 bitop3:0x6a
    v_mad_u32_u24 v15, v35, s89, v32
    v_lshrrev_b32_e64 v32, 5, v1
    v_lshl_or_b32 v62, v32, 30, v62
    s_lshl_b32 s69, s54, 5
    s_add_u32 s69, s69, s53
    s_mul_i32 s70, s69, 205
    s_lshr_b32 s70, s70, 13
    s_mul_i32 s88, s70, 40
    s_sub_u32 s88, s69, s88
    s_cmp_lt_u32 s69, 200
    s_cselect_b32 s91, 0, 1073741824
    s_lshl_b32 s88, s88, 1
    s_lshr_b32 s69, s52, 1
    s_add_u32 s99, s88, s69
    s_and_b32 s69, s52, 1
    s_lshl_b32 s70, s70, 1
    s_add_u32 s98, s70, s69
    s_mul_i32 s69, s99, 10240
    s_lshl_b32 s71, s98, 7
    s_add_u32 s69, s69, s71
    s_or_b32 s69, s69, s91
    v_lshrrev_b32 v32, 3, v1
    v_mul_u32_u24 v32, 1152, v32
    v_add3_u32 v67, v32, v2, s69
    s_mov_b32 s28, s14
    s_nop 0
    s_and_b32 s29, s15, 0xffff
    s_mov_b32 s30, 1280
    s_mov_b32 s31, 0x20000
    buffer_load_dwordx4 v[76:79], v2, s[28:31], 0 offen
    buffer_load_dwordx4 v[80:83], v2, s[28:31], 0 offen offset:1024
    s_and_b32 s69, s53, 15
    s_mul_i32 s69, s69, 5
    s_add_u32 s70, s69, s52
    s_cmp_lt_u32 s53, 16
    s_mov_b32 s90, 102400
    s_cselect_b32 s90, 0, s90
    v_lshrrev_b32 v40, 4, v1
    v_bfe_u32 v39, v1, 2, 2
    v_and_b32_e64 v33, 15, v1
    s_add_u32 s88, s72, 40960
    v_mad_u32_u24 v32, v33, 40, s88
    v_lshl_add_u32 v63, v40, 3, v32
    v_mov_b32 v41, s52
    v_cmp_eq_u32 vcc, 1, v40
    v_min_u32_e64 v42, 1, v40
    v_mul_u32_u24 v33, 1280, v42
    v_cndmask_b32_e64 v41, 4, v41, vcc
    v_lshl_add_u32 v33, v41, 3, v33
    v_add_u32 v64, v32, v33
    s_lshr_b32 s88, s70, 2
    s_lshl_b32 s88, s88, 12
    s_lshl_b32 s70, s70, 8
    s_add_u32 s70, s70, s88
    s_add_u32 s69, s69, 4
    s_lshr_b32 s88, s69, 2
    s_lshl_b32 s88, s88, 12
    s_lshl_b32 s69, s69, 8
    s_add_u32 s69, s69, s88
    s_sub_u32 s69, s69, s70
    s_add_u32 s70, s70, s90
    v_and_b32 v34, 0xf0, v2
    v_add_u32_e64 v32, s70, v34
    v_lshl_add_u32 v65, v40, 10, v32
    v_lshl_add_u32 v32, v41, 10, v32
    s_cmp_eq_u32 s52, 0
    s_cselect_b32 s88, 3, 2
    v_cmp_gt_u32_e64 vcc, s88, v40
    v_mad_u32_u24 v32, v42, s69, v32
    v_lshrrev_b32 v40, 5, v1
    v_cndmask_b32 v66, v36, v32, vcc
    v_lshl_add_u32 v37, v39, 1, v40
    v_and_b32_e64 v38, 0x30, v2
    v_lshl_add_u32 v37, v37, 6, v38
    v_bfe_u32 v41, v1, 4, 1
    v_lshl_add_u32 v37, v41, 3, v37
    s_add_u32 s69, s73, 155648
    v_add_u32_e64 v68, s69, v37
    s_mul_i32 s70, s98, 81920
    s_lshr_b32 s69, s99, 2
    s_lshl_b32 s69, s69, 10
    s_add_u32 s70, s70, s69
    s_lshl_b32 s69, s99, 8
    s_add_u32 s70, s70, s69
    s_add_u32 s70, s70, 13238272
    s_or_b32 s70, s70, s91
    v_mul_u32_u24 v37, 40960, v40
    v_lshl_add_u32 v37, v41, 10, v37
    v_add3_u32 v69, v37, v34, s70
    v_and_b32 v32, 31, v1
    v_lshlrev_b32 v18, 7, v32
    s_min_u32 s88, s52, 2
    s_lshl_b32 s88, s88, 10
    v_add_u32 v22, s88, v2
    s_mul_i32 s88, s56, 12
    s_max_u32 s88, s88, 68
    s_cmp_eq_u32 s56, 5
    s_cselect_b32 s88, 56, s88
    s_cselect_b32 s70, 32, 28
    s_add_u32 s88, s88, 136
    s_cmp_lt_u32 s55, s70
    s_cselect_b32 s88, s88, 224
    s_lshl_b32 s70, s56, 4
    s_add_u32 s70, s70, 80
    s_cmp_lt_u32 s55, 16
    s_cselect_b32 s88, s70, s88
    s_lshl_b32 s70, s56, 5
    s_cmp_lt_u32 s56, 5
    s_cselect_b32 s88, s70, s88
    s_add_u32 s12, s88, s55
    s_waitcnt lgkmcnt(0)
    s_add_u32 s57, s57, 2654435761
    s_lshl_b32 s88, s52, 2
    v_mov_b32 v31, 1073741824
    v_mov_b32 v3, s88
    v_cmp_eq_u32 vcc, 0, v1
    s_waitcnt vmcnt(3)
    v_mov_b32 v4, s57
    s_mov_b32 s79, 0xffff0000
    v_cndmask_b32_e64 v3, v31, v3, vcc
    s_mov_b32 s92, 0x3fb8aa3b
    s_mov_b32 s93, 0x3fb8aa3b
    s_mov_b32 s80, 0x3f803f80
    v_lshlrev_b32_e64 v6, 2, v1
    v_and_b32 v6, 0x7f, v6
    s_mul_i32 s96, s12, 205
    s_lshr_b32 s96, s96, 10
    s_mul_i32 s70, s96, 5
    s_sub_u32 s97, s12, s70
    s_lshl_b32 s88, s96, 2
    s_add_u32 s88, s88, s52
    s_lshl_b32 s88, s88, 7
    s_add_u32 s88, s88, 69632
    s_cmp_eq_u32 s97, 0
    s_cselect_b32 s88, s88, 1073741824
    s_sub_u32 s70, s12, 160
    s_lshl_b32 s71, s70, 2
    s_add_u32 s71, s71, s52
    s_lshl_b32 s71, s71, 7
    s_add_u32 s71, s71, 102400
    s_cmp_lt_u32 s70, 48
    s_cselect_b32 s95, s71, 1073741824
    s_cmp_lt_u32 s12, 160
    s_cselect_b32 s95, s88, s95
    v_mov_b32_e64 v37, -1
    buffer_store_dword v37, v6, s[36:39], s95 offen sc1
    s_lshl_b32 s69, s54, 5
    s_add_u32 s69, s69, s53
    s_lshl_b32 s70, s69, 7
    s_add_u32 s70, s70, 4096
    s_lshl_b32 s69, s69, 9
    s_add_u32 s69, s69, 172032
    s_mul_i32 s71, s96, 5
    s_add_u32 s71, s71, s97
    s_lshl_b32 s71, s71, 10
    s_add_u32 s71, s71, 303104
    s_cmp_eq_u32 s52, 1
    s_cselect_b32 s90, 7, 12
    s_lshl_b32 s88, s96, 13
    s_mul_i32 s91, s97, 1664
    s_add_u32 s88, s88, s91
    s_add_u32 s88, s88, 466944
    s_cmp_eq_u32 s52, 1
    s_cselect_b32 s71, s71, s88
    s_lshl_b32 s88, s96, 7
    s_add_u32 s88, s88, 36864
    s_cmp_eq_u32 s52, 3
    s_cselect_b32 s71, s88, s71
    s_cselect_b32 s90, 0, s90
    s_cmp_lt_u32 s12, 160
    s_cselect_b32 s71, s71, 1073741824
    s_cmp_eq_u32 s52, 0
    s_cselect_b32 s71, s69, s71
    s_cselect_b32 s90, 3, s90
    v_min_u32 v71, s90, v1
    v_lshl_add_u32 v71, v71, 7, s71
    v_writelane_b32 v71, s70, 63
    s_add_u32 s70, s70, 122880
    v_writelane_b32 v71, s70, 62
    s_add_u32 s70, s70, 1183744
    v_writelane_b32 v71, s70, 61
    s_mul_i32 s88, s97, 5120
    s_add_u32 s88, s88, 126976
    v_min_u32_e64 v39, 39, v1
    v_lshl_add_u32 v29, v39, 7, s88
    s_waitcnt vmcnt(3)
    s_barrier
    s_add_u32 m0, s72, 40960
    s_nop 0
    buffer_load_dwordx4 v60, s[32:35], s94 offen offset:0 lds
    buffer_load_dwordx4 v61, s[32:35], s94 offen offset:1024 lds
    buffer_load_dwordx4 v62, s[32:35], s94 offen offset:2048 lds
    buffer_load_dword v70, v71, s[36:39], 0 offen
    s_add_u32 m0, s72, 0
    s_nop 0
    s_nop 0
    buffer_load_dwordx4 v11, s[32:35], s58 offen offset:0 lds
    buffer_load_dwordx4 v12, s[32:35], s58 offen offset:1024 lds
    buffer_load_dwordx4 v13, s[32:35], s58 offen offset:2048 lds
    buffer_load_dwordx4 v14, s[32:35], s58 offen offset:3072 lds
    s_add_u32 m0, s72, 4096
    s_nop 0
    buffer_load_dwordx4 v15, s[32:35], s58 offen offset:0 lds
    s_barrier
    s_mul_i32 s68, s54, 204800
    s_add_u32 s68, s68, 11534336
    s_waitcnt vmcnt(6)
    ds_read_b64_tr_b16 v[40:41], v63 offset:0
    ds_read_b64_tr_b16 v[42:43], v63 offset:640
    ds_read_b64_tr_b16 v[44:45], v64 offset:0
    ds_read_b64_tr_b16 v[46:47], v64 offset:640
    s_waitcnt lgkmcnt(2)
    buffer_store_dwordx4 v[40:43], v65, s[36:39], s68 offen sc1
    s_waitcnt lgkmcnt(0)
    buffer_store_dwordx4 v[44:47], v66, s[36:39], s68 offen sc1
    s_add_u32 m0, s72, 20480
    s_nop 0
    buffer_load_dwordx4 v11, s[32:35], s59 offen offset:0 lds
    buffer_load_dwordx4 v12, s[32:35], s59 offen offset:1024 lds
    buffer_load_dwordx4 v13, s[32:35], s59 offen offset:2048 lds
    buffer_load_dwordx4 v14, s[32:35], s59 offen offset:3072 lds
    s_add_u32 m0, s72, 24576
    s_nop 0
    buffer_load_dwordx4 v15, s[32:35], s59 offen offset:0 lds
    s_add_u32 m0, s72, 40960
    s_nop 0
    buffer_load_dwordx4 v11, s[32:35], s60 offen offset:0 lds
    buffer_load_dwordx4 v12, s[32:35], s60 offen offset:1024 lds
    buffer_load_dwordx4 v13, s[32:35], s60 offen offset:2048 lds
    buffer_load_dwordx4 v14, s[32:35], s60 offen offset:3072 lds
    s_add_u32 m0, s72, 45056
    s_nop 0
    buffer_load_dwordx4 v15, s[32:35], s60 offen offset:0 lds
    s_waitcnt vmcnt(12)
    s_barrier
    s_lshl_b32 s68, s54, 5
    s_add_u32 s68, s68, s53
    s_lshl_b32 s68, s68, 7
    s_add_u32 s68, s68, 4096
    s_waitcnt vmcnt(10)
    buffer_store_dword v4, v3, s[36:39], s68 offen sc1
    s_add_u32 m0, s72, 61440
    s_nop 0
    buffer_load_dwordx4 v11, s[32:35], s61 offen offset:0 lds
    buffer_load_dwordx4 v12, s[32:35], s61 offen offset:1024 lds
    buffer_load_dwordx4 v13, s[32:35], s61 offen offset:2048 lds
    buffer_load_dwordx4 v14, s[32:35], s61 offen offset:3072 lds
    s_add_u32 m0, s72, 65536
    s_nop 0
    buffer_load_dwordx4 v15, s[32:35], s61 offen offset:0 lds
    s_waitcnt vmcnt(6)
    s_barrier
    s_add_u32 m0, s72, 81920
    s_nop 0
    buffer_load_dwordx4 v11, s[32:35], s62 offen offset:0 lds
    buffer_load_dwordx4 v12, s[32:35], s62 offen offset:1024 lds
    buffer_load_dwordx4 v13, s[32:35], s62 offen offset:2048 lds
    buffer_load_dwordx4 v14, s[32:35], s62 offen offset:3072 lds
    s_add_u32 m0, s72, 86016
    s_nop 0
    buffer_load_dwordx4 v15, s[32:35], s62 offen offset:0 lds
    s_lshl_b32 s68, s97, 2
    s_add_u32 s68, s68, s52
    s_mul_i32 s68, s68, 40960
    s_add_u32 s68, s68, 13238272
    s_cmp_lt_u32 s12, 160
    s_cselect_b32 s68, s68, 1073741824
    v_add_u32 v30, s68, v2
    s_and_b32 s98, s96, 3
    s_mul_i32 s98, s98, 10240
    s_cmp_ge_u32 s12, 208
    s_cbranch_scc1 L_pf2
    s_mov_b32 s40, s16
    s_and_b32 s41, s17, 0xffff
    s_mov_b32 s42, 1966080
    s_mov_b32 s43, 0x20000
    s_mov_b32 s44, s18
    s_and_b32 s45, s19, 0xffff
    s_mov_b32 s46, 1966080
    s_mov_b32 s47, 0x20000
    s_sub_u32 s68, s12, 160
    s_lshl_b32 s68, s68, 6
    s_mul_i32 s69, s52, 491520
    s_add_u32 s68, s68, s69
    v_lshrrev_b32 v32, 2, v1
    v_mul_u32_u24 v32, 3072, v32
    v_and_b32_e64 v33, 0x30, v2
    v_add3_u32 v28, v32, v33, s68
    s_mov_b32 s101, 49152
    s_and_b32 s94, s12, 1
    s_mul_i32 s94, s94, 5
    s_branch L_pf3
L_pf2:
    s_mov_b32 s40, s20
    s_and_b32 s41, s21, 0xffff
    s_mov_b32 s42, 1966080
    s_mov_b32 s43, 0x20000
    s_mov_b32 s44, s20
    s_and_b32 s45, s21, 0xffff
    s_mov_b32 s46, 0
    s_mov_b32 s47, 0x20000
    s_sub_u32 s96, s12, 208
    s_lshl_b32 s97, s96, 5
    s_mul_i32 s69, s52, 491520
    s_add_u32 s68, s97, s69
    v_lshrrev_b32_e64 v32, 1, v1
    v_mul_u32_u24 v32, 1280, v32
    v_and_b32_e64 v33, 0x10, v2
    v_add3_u32 v28, v32, v33, s68
    s_mov_b32 s101, 40960
    s_and_b32 s94, s96, 3
    s_mul_i32 s94, s94, 3
L_pf3:
    s_mul_i32 s81, s94, s101
    s_sub_u32 s100, s12, 160
    s_cmp_lt_u32 s100, 88
    s_cselect_b32 s42, s42, 0
    s_cselect_b32 s46, s46, 0
    s_lshl_b32 s90, s53, 2
    s_add_u32 s90, s90, s52
    s_min_u32 s90, s90, 119
    s_mul_i32 s68, s90, 171
    s_lshr_b32 s68, s68, 9
    s_mul_i32 s69, s68, 3
    s_sub_u32 s69, s90, s69
    s_lshl_b32 s69, s69, 3
    v_lshrrev_b32 v32, 3, v1
    v_mul_u32_u24 v32, 15360, v32
    v_add_u32 v20, v32, v2
    v_lshrrev_b32 v32, 3, v1
    v_min_u32_e64 v32, 1, v32
    v_lshl_or_b32 v21, v32, 30, v2
    v_add_u32 v32, s69, v1
    s_mul_i32 s88, s68, 52
    s_lshr_b32 s88, s88, 8
    s_mul_i32 s69, s88, 5
    s_sub_u32 s68, s68, s69
    s_and_b32 s89, s88, 2
    s_lshl_b32 s89, s89, 1
    v_subrev_u32 v33, s89, v32
    v_add_u32 v34, 20, v33
    v_min_u32 v33, v33, v34
    v_cmp_gt_u32 vcc, 20, v32
    s_and_b32 s89, s88, 1
    s_lshr_b32 s88, s88, 1
    v_cndmask_b32 v33, v32, v33, vcc
    s_mul_i32 s88, s88, 5
    s_and_b32 s69, s68, 1
    s_lshl1_add_u32 s69, s89, s69
    s_lshr_b32 s91, s68, 1
    s_cmp_lt_u32 s68, 4
    s_cselect_b32 s69, s69, 4
    s_cselect_b32 s89, s91, s89
    s_add_u32 s88, s88, s69
    s_mul_i32 s88, s88, 336
    s_lshl3_add_u32 s88, s89, s88
    s_add_u32 s88, s88, 147456
    v_cmp_gt_u32 vcc, 21, v32
    v_lshl_add_u32 v33, v33, 4, s88
    v_mov_b32 v34, 156160
    v_cndmask_b32 v24, v34, v33, vcc
    s_lshl_b32 s90, s90, 7
    s_mul_i32 s88, s54, 495616
    s_add_u32 s88, s88, s90
    s_add_u32 s58, s88, 2097152
    s_add_u32 s59, s88, 2221056
    s_add_u32 s60, s88, 2344960
    s_add_u32 s61, s88, 2468864
    s_lshl_b32 s91, s54, 14
    s_add_u32 s91, s91, 172032
    s_add_u32 s90, s90, s91
    s_mov_b32 s88, 0x0c0c0400
    s_mov_b32 s89, 0x05040100
    s_mov_b32 s69, 0x07060500
    s_waitcnt vmcnt(5)
    s_barrier
    s_lshl_b32 s70, s54, 12
    s_add_u32 s70, s70, 4096
    buffer_load_dwordx4 v[40:43], v18, s[36:39], s70 offen sc1
    s_waitcnt vmcnt(1)
    s_barrier
    s_waitcnt vmcnt(0)
    v_xor_b32 v32, v4, v40
    v_xor_b32 v33, v4, v41
    v_xor_b32 v34, v4, v42
    v_or3_b32 v32, v32, v33, v34
    v_xor_b32 v33, v4, v43
    v_or_b32 v32, v32, v33
    v_cmp_ne_u32 vcc, 0, v32
    s_cbranch_vccnz spin_pk_36005
ok_pk_36006:
    s_add_u32 m0, s72, 102400
    s_add_u32 s71, s63, 0
    s_nop 0
    buffer_load_dwordx4 v2, s[36:39], s71 offen offset:0 sc1 lds
    buffer_load_dwordx4 v2, s[36:39], s71 offen offset:1024 sc1 lds
    buffer_load_dwordx4 v2, s[36:39], s71 offen offset:2048 sc1 lds
    buffer_load_dwordx4 v2, s[36:39], s71 offen offset:3072 sc1 lds
    s_add_u32 m0, s72, 106496
    s_add_u32 s71, s63, 4096
    buffer_load_dwordx4 v2, s[36:39], s71 offen offset:0 sc1 lds
    s_barrier
    s_add_u32 m0, s72, 0
    s_add_u32 s71, s64, 0
    s_nop 0
    buffer_load_dwordx4 v2, s[36:39], s71 offen offset:0 sc1 lds
    buffer_load_dwordx4 v2, s[36:39], s71 offen offset:1024 sc1 lds
    buffer_load_dwordx4 v2, s[36:39], s71 offen offset:2048 sc1 lds
    buffer_load_dwordx4 v2, s[36:39], s71 offen offset:3072 sc1 lds
    s_add_u32 m0, s72, 4096
    s_add_u32 s71, s64, 4096
    buffer_load_dwordx4 v2, s[36:39], s71 offen offset:0 sc1 lds
    s_add_u32 m0, s72, 20480
    s_add_u32 s71, s65, 0
    s_nop 0
    buffer_load_dwordx4 v2, s[36:39], s71 offen offset:0 sc1 lds
    buffer_load_dwordx4 v2, s[36:39], s71 offen offset:1024 sc1 lds
    buffer_load_dwordx4 v2, s[36:39], s71 offen offset:2048 sc1 lds
    buffer_load_dwordx4 v2, s[36:39], s71 offen offset:3072 sc1 lds
    s_add_u32 m0, s72, 24576
    s_add_u32 s71, s65, 4096
    buffer_load_dwordx4 v2, s[36:39], s71 offen offset:0 sc1 lds
    s_add_u32 m0, s72, 40960
    s_add_u32 s71, s66, 0
    s_nop 0
    buffer_load_dwordx4 v2, s[36:39], s71 offen offset:0 sc1 lds
    buffer_load_dwordx4 v2, s[36:39], s71 offen offset:1024 sc1 lds
    buffer_load_dwordx4 v2, s[36:39], s71 offen offset:2048 sc1 lds
    buffer_load_dwordx4 v2, s[36:39], s71 offen offset:3072 sc1 lds
    s_add_u32 m0, s72, 45056
    s_add_u32 s71, s66, 4096
    buffer_load_dwordx4 v2, s[36:39], s71 offen offset:0 sc1 lds
    s_add_u32 m0, s73, 155648
    s_nop 0
    buffer_load_dwordx4 v67, s[48:51], 0 offen lds
    s_waitcnt vmcnt(6)
    s_barrier
    s_add_u32 m0, s72, 61440
    s_add_u32 s71, s67, 0
    buffer_load_dwordx4 v2, s[36:39], s71 offen offset:0 sc1 lds
    buffer_load_dwordx4 v2, s[36:39], s71 offen offset:1024 sc1 lds
    buffer_load_dwordx4 v2, s[36:39], s71 offen offset:2048 sc1 lds
    buffer_load_dwordx4 v2, s[36:39], s71 offen offset:3072 sc1 lds
    s_add_u32 m0, s72, 65536
    s_add_u32 s71, s67, 4096
    buffer_load_dwordx4 v2, s[36:39], s71 offen offset:0 sc1 lds
    s_add_u32 m0, s72, 81920
    s_add_u32 s71, s63, 102400
    buffer_load_dwordx4 v2, s[36:39], s71 offen offset:0 sc1 lds
    buffer_load_dwordx4 v2, s[36:39], s71 offen offset:1024 sc1 lds
    buffer_load_dwordx4 v2, s[36:39], s71 offen offset:2048 sc1 lds
    buffer_load_dwordx4 v2, s[36:39], s71 offen offset:3072 sc1 lds
    s_add_u32 m0, s72, 86016
    s_add_u32 s71, s63, 106496
    buffer_load_dwordx4 v2, s[36:39], s71 offen offset:0 sc1 lds
    s_waitcnt vmcnt(10)
    ds_read_b64_tr_b16 v[48:49], v68 offset:0
    ds_read_b64_tr_b16 v[50:51], v68 offset:512
    s_waitcnt lgkmcnt(0)
    buffer_store_dwordx4 v[48:51], v69, s[36:39], 0 offen sc1
    s_barrier
    s_nop 0
    s_add_u32 m0, s72, 102400
    s_add_u32 s71, s64, 102400
    buffer_load_dwordx4 v2, s[36:39], s71 offen offset:0 sc1 lds
    buffer_load_dwordx4 v2, s[36:39], s71 offen offset:1024 sc1 lds
    buffer_load_dwordx4 v2, s[36:39], s71 offen offset:2048 sc1 lds
    buffer_load_dwordx4 v2, s[36:39], s71 offen offset:3072 sc1 lds
    s_add_u32 m0, s72, 106496
    s_add_u32 s71, s64, 106496
    buffer_load_dwordx4 v2, s[36:39], s71 offen offset:0 sc1 lds
    s_add_u32 m0, s72, 0
    s_nop 0
    s_add_u32 s71, s65, 102400
    buffer_load_dwordx4 v2, s[36:39], s71 offen offset:0 sc1 lds
    buffer_load_dwordx4 v2, s[36:39], s71 offen offset:1024 sc1 lds
    buffer_load_dwordx4 v2, s[36:39], s71 offen offset:2048 sc1 lds
    buffer_load_dwordx4 v2, s[36:39], s71 offen offset:3072 sc1 lds
    s_add_u32 m0, s72, 4096
    s_add_u32 s71, s65, 106496
    buffer_load_dwordx4 v2, s[36:39], s71 offen offset:0 sc1 lds
    s_waitcnt vmcnt(16)
    s_barrier
    s_add_u32 m0, s72, 20480
    s_add_u32 s71, s66, 102400
    buffer_load_dwordx4 v2, s[36:39], s71 offen offset:0 sc1 lds
    buffer_load_dwordx4 v2, s[36:39], s71 offen offset:1024 sc1 lds
    buffer_load_dwordx4 v2, s[36:39], s71 offen offset:2048 sc1 lds
    buffer_load_dwordx4 v2, s[36:39], s71 offen offset:3072 sc1 lds
    s_add_u32 m0, s72, 24576
    s_add_u32 s71, s66, 106496
    buffer_load_dwordx4 v2, s[36:39], s71 offen offset:0 sc1 lds
    s_lshl_b32 s68, s54, 5
    s_add_u32 s68, s68, s53
    s_lshl_b32 s68, s68, 7
    s_add_u32 s68, s68, 126976
    s_waitcnt vmcnt(15)
    buffer_store_dword v4, v3, s[36:39], s68 offen sc1
    s_lshl2_add_u32 s68, s53, s52
    s_lshl3_add_u32 s68, s68, s54
    s_lshl_b32 s71, s68, 7
    s_add_u32 s71, s71, 1048576
    s_mul_i32 s68, s68, 2560
    s_add_u32 s68, s68, 6291456
    v_not_b32 v32, v4
    buffer_store_dword v32, v6, s[36:39], s71 offen sc1
    v_mov_b32 v72, -1
    v_mov_b32 v73, -1
    v_mov_b32 v74, -1
    v_mov_b32 v75, -1
    buffer_store_dwordx4 v[72:75], v2, s[36:39], s68 offen offset:0 sc1
    buffer_store_dwordx4 v[72:75], v2, s[36:39], s68 offen offset:1024 sc1
    buffer_store_dwordx4 v[72:75], v2, s[36:39], s68 offen offset:1536 sc1
    s_waitcnt vmcnt(10)
    s_barrier
    s_add_u32 m0, s72, 40960
    s_add_u32 s71, s67, 102400
    buffer_load_dwordx4 v2, s[36:39], s71 offen offset:0 sc1 lds
    buffer_load_dwordx4 v2, s[36:39], s71 offen offset:1024 sc1 lds
    buffer_load_dwordx4 v2, s[36:39], s71 offen offset:2048 sc1 lds
    buffer_load_dwordx4 v2, s[36:39], s71 offen offset:3072 sc1 lds
    s_add_u32 m0, s72, 45056
    s_add_u32 s71, s67, 106496
    buffer_load_dwordx4 v2, s[36:39], s71 offen offset:0 sc1 lds
    s_waitcnt vmcnt(0)
    s_barrier
    s_add_u32 s63, s91, 0
    s_add_u32 s64, s91, 4096
    s_add_u32 s65, s91, 8192
    s_add_u32 s66, s91, 12288
    s_setprio 2
    s_lshl_b32 s71, s54, 12
    s_add_u32 s71, s71, 1310720
    s_lshl_b32 s70, s53, 7
    s_add_u32 s70, s70, s71
    s_cmp_eq_u32 s52, 0
    s_cselect_b32 s70, s70, 1073741824
    buffer_load_dwordx4 v[40:43], v20, s[36:39], s58 offen sc1
    buffer_load_dwordx4 v[44:47], v20, s[36:39], s59 offen sc1
    buffer_load_dwordx4 v[48:51], v20, s[36:39], s60 offen sc1
    buffer_load_dwordx4 v[52:55], v20, s[36:39], s61 offen sc1
    s_waitcnt vmcnt(3)
    v_perm_b32 v32, v41, v40, s88
    v_perm_b32 v33, v43, v42, s88
    v_perm_b32 v32, v33, v32, s89
    v_cmp_ne_u32 s[76:77], s57, v32
    s_waitcnt vmcnt(2)
    v_perm_b32 v32, v45, v44, s88
    v_perm_b32 v33, v47, v46, s88
    v_perm_b32 v32, v33, v32, s89
    v_cmp_ne_u32 s[74:75], s57, v32
    s_waitcnt vmcnt(1)
    v_perm_b32 v32, v49, v48, s88
    v_perm_b32 v33, v51, v50, s88
    v_perm_b32 v32, v33, v32, s89
    v_cmp_ne_u32 s[24:25], s57, v32
    s_waitcnt vmcnt(0)
    v_perm_b32 v32, v53, v52, s88
    v_perm_b32 v33, v55, v54, s88
    v_perm_b32 v32, v33, v32, s89
    v_cmp_ne_u32 s[8:9], s57, v32
    s_or_b64 vcc, s[76:77], s[74:75]
    s_or_b64 vcc, vcc, s[24:25]
    s_or_b64 vcc, vcc, s[8:9]
    s_cbranch_vccnz spin_red_38007
ok_red_38008:
    s_nop 0
    buffer_store_dword v4, v6, s[36:39], s70 offen sc1
    v_mov_b32 v32, 0x80
    v_perm_b32 v40, v40, v32, s69
    v_perm_b32 v41, v41, v32, s69
    v_perm_b32 v42, v42, v32, s69
    v_perm_b32 v43, v43, v32, s69
    v_perm_b32 v44, v44, v32, s69
    v_perm_b32 v45, v45, v32, s69
    v_perm_b32 v46, v46, v32, s69
    v_perm_b32 v47, v47, v32, s69
    v_perm_b32 v48, v48, v32, s69
    v_perm_b32 v49, v49, v32, s69
    v_perm_b32 v50, v50, v32, s69
    v_perm_b32 v51, v51, v32, s69
    v_perm_b32 v52, v52, v32, s69
    v_perm_b32 v53, v53, v32, s69
    v_perm_b32 v54, v54, v32, s69
    v_perm_b32 v55, v55, v32, s69
    v_add_f32 v40, v40, v44
    v_add_f32 v41, v41, v45
    v_add_f32 v42, v42, v46
    v_add_f32 v43, v43, v47
    v_add_f32 v48, v48, v52
    v_add_f32 v49, v49, v53
    v_add_f32 v50, v50, v54
    v_add_f32 v51, v51, v55
    v_add_f32 v40, v40, v48
    v_add_f32 v41, v41, v49
    v_add_f32 v42, v42, v50
    v_add_f32 v43, v43, v51
    v_add_f32_dpp v40, v40, v40 row_ror:8 row_mask:0xf bank_mask:0xf
    v_add_f32_dpp v41, v41, v41 row_ror:8 row_mask:0xf bank_mask:0xf
    v_add_f32_dpp v42, v42, v42 row_ror:8 row_mask:0xf bank_mask:0xf
    v_add_f32_dpp v43, v43, v43 row_ror:8 row_mask:0xf bank_mask:0xf
    v_mov_b32 v44, v40
    v_mov_b32 v45, v41
    v_mov_b32 v46, v42
    v_mov_b32 v47, v43
    v_permlane16_swap_b32 v44, v40
    v_permlane16_swap_b32 v45, v41
    v_permlane16_swap_b32 v46, v42
    v_permlane16_swap_b32 v47, v43
    v_add_f32 v40, v40, v44
    v_add_f32 v41, v41, v45
    v_add_f32 v42, v42, v46
    v_add_f32 v43, v43, v47
    v_mov_b32 v44, v40
    v_mov_b32 v45, v41
    v_mov_b32 v46, v42
    v_mov_b32 v47, v43
    v_permlane32_swap_b32 v44, v40
    v_permlane32_swap_b32 v45, v41
    v_permlane32_swap_b32 v46, v42
    v_permlane32_swap_b32 v47, v43
    v_add_f32 v40, v40, v44
    v_add_f32 v41, v41, v45
    v_add_f32 v42, v42, v46
    v_add_f32 v43, v43, v47
    v_cvt_pk_bf16_f32 v56, v40, v41
    v_cvt_pk_bf16_f32 v57, v42, v43
    v_mov_b32 v58, s57
    v_mov_b32 v59, v24
    buffer_store_dwordx4 v[56:59], v21, s[36:39], s90 offen sc1
    s_setprio 2
    v_mov_b32 v32, 0
    v_mov_b32 v33, 0
    v_lshrrev_b32 v34, 1, v23
    v_min_u32 v34, 1752, v34
    v_add_u32 v34, 154176, v34
    ds_write_b64 v34, v[32:33]
    buffer_load_dwordx4 v[44:47], v29, s[36:39], 0 offen sc1
    s_waitcnt vmcnt(0)
    v_xor_b32 v32, v4, v44
    v_xor_b32 v33, v4, v45
    v_xor_b32 v34, v4, v46
    v_or3_b32 v32, v32, v33, v34
    v_xor_b32 v33, v4, v47
    v_or_b32 v32, v32, v33
    v_cmp_ne_u32 vcc, 0, v32
    s_cbranch_vccnz spin_wo_40009
ok_wo_40010:
    s_cmp_lt_u32 s100, 88
    s_cbranch_scc0 hf_42011
    s_branch hg_42012
hf_42011:
    buffer_load_dwordx4 v[96:99], v30, s[36:39], s98 offen offset:0 sc1
    buffer_load_dwordx4 v[100:103], v30, s[36:39], s98 offen offset:1024 sc1
    buffer_load_dwordx4 v[104:107], v30, s[36:39], s98 offen offset:2048 sc1
    buffer_load_dwordx4 v[108:111], v30, s[36:39], s98 offen offset:3072 sc1
    s_add_u32 s98, s98, 4096
    buffer_load_dwordx4 v[112:115], v30, s[36:39], s98 offen offset:0 sc1
    buffer_load_dwordx4 v[116:119], v30, s[36:39], s98 offen offset:1024 sc1
    buffer_load_dwordx4 v[120:123], v30, s[36:39], s98 offen offset:2048 sc1
    buffer_load_dwordx4 v[124:127], v30, s[36:39], s98 offen offset:3072 sc1
hg_42012:
    v_bfe_u32 v34, v1, 1, 2
    v_and_b32_e64 v35, 1, v1
    v_lshl_add_u32 v34, v34, 3, v35
    s_lshl_b32 s68, s52, 1
    v_add_u32 v34, s68, v34
    v_min_u32 v34, 29, v34
    v_lshlrev_b32_e64 v34, 7, v34
    s_mov_b64 vcc, -1
    s_mov_b32 s78, 0
tw_42013:
    s_mov_b64 exec, vcc
    buffer_load_dword v35, v34, s[36:39], s71 offen sc1
    s_add_u32 s78, s78, 1
    s_waitcnt vmcnt(0)
    v_cmp_ne_u32 vcc, s57, v35
    s_cbranch_vccz td_42014
    s_cmp_lt_u32 s78, 2097152
    s_cbranch_scc1 tw_42013
td_42014:
    s_mov_b64 exec, -1
    s_setprio 2
    buffer_load_dwordx4 v[40:43], v23, s[36:39], s63 offen sc1
    buffer_load_dwordx4 v[44:47], v23, s[36:39], s64 offen sc1
    buffer_load_dwordx4 v[48:51], v23, s[36:39], s65 offen sc1
    buffer_load_dwordx4 v[52:55], v22, s[36:39], s66 offen sc1
    s_waitcnt vmcnt(3)
    v_cmp_ne_u32 s[76:77], s57, v42
    s_waitcnt vmcnt(2)
    v_cmp_ne_u32 s[74:75], s57, v46
    s_waitcnt vmcnt(1)
    v_cmp_ne_u32 s[24:25], s57, v50
    s_waitcnt vmcnt(0)
    v_cmp_ne_u32 s[8:9], s57, v54
    s_or_b64 vcc, s[76:77], s[74:75]
    s_or_b64 vcc, vcc, s[24:25]
    s_or_b64 vcc, vcc, s[8:9]
    s_cbranch_vccnz spin_gat_42015
ok_gat_42016:
    ds_write_b64 v43, v[40:41]
    ds_write_b64 v47, v[44:45]
    ds_write_b64 v51, v[48:49]
    ds_write_b64 v55, v[52:53]
    s_waitcnt lgkmcnt(0)
    s_barrier
    s_setprio 0
    s_cmp_ge_u32 s12, 160
    s_cbranch_scc1 L_ffn
    s_nop 0
    s_add_u32 s98, s98, 4096
    buffer_load_dwordx4 v[128:131], v30, s[36:39], s98 offen offset:0 sc1
    buffer_load_dwordx4 v[132:135], v30, s[36:39], s98 offen offset:1024 sc1
    s_add_u32 s98, s98, 2048
    s_cmp_eq_u32 s98, 40960
    s_cselect_b32 s98, 0, s98
    buffer_load_dwordx4 v[136:139], v30, s[36:39], s98 offen offset:0 sc1
    buffer_load_dwordx4 v[140:143], v30, s[36:39], s98 offen offset:1024 sc1
    buffer_load_dwordx4 v[144:147], v30, s[36:39], s98 offen offset:2048 sc1
    buffer_load_dwordx4 v[148:151], v30, s[36:39], s98 offen offset:3072 sc1
    v_lshrrev_b32 v32, 4, v1
    v_add_u32 v14, 106496, v2
    v_add_u32 v16, 65536, v2
    s_lshl_b32 s68, s52, 2
    v_add_u32 v34, s68, v32
    v_and_b32 v35, 7, v1
    v_xor_b32 v34, v34, v35
    v_lshlrev_b32 v34, 4, v34
    v_and_b32 v33, 15, v1
    v_lshl_add_u32 v34, v33, 8, v34
    v_add_u32 v15, 0, v34
    s_barrier
    s_add_u32 s98, s98, 4096
    buffer_load_dwordx4 v[152:155], v30, s[36:39], s98 offen offset:0 sc1
    buffer_load_dwordx4 v[156:159], v30, s[36:39], s98 offen offset:1024 sc1
    buffer_load_dwordx4 v[160:163], v30, s[36:39], s98 offen offset:2048 sc1
    buffer_load_dwordx4 v[164:167], v30, s[36:39], s98 offen offset:3072 sc1
    s_add_u32 s98, s98, 4096
    buffer_load_dwordx4 v[168:171], v30, s[36:39], s98 offen offset:0 sc1
    buffer_load_dwordx4 v[172:175], v30, s[36:39], s98 offen offset:1024 sc1
    s_add_u32 s98, s98, 2048
    s_cmp_eq_u32 s98, 40960
    s_cselect_b32 s98, 0, s98
    s_nop 0
    buffer_load_dwordx4 v[176:179], v30, s[36:39], s98 offen offset:0 sc1
    buffer_load_dwordx4 v[180:183], v30, s[36:39], s98 offen offset:1024 sc1
    buffer_load_dwordx4 v[184:187], v30, s[36:39], s98 offen offset:2048 sc1
    buffer_load_dwordx4 v[188:191], v30, s[36:39], s98 offen offset:3072 sc1
    s_add_u32 s98, s98, 4096
    buffer_load_dwordx4 v[192:195], v30, s[36:39], s98 offen offset:0 sc1
    buffer_load_dwordx4 v[196:199], v30, s[36:39], s98 offen offset:1024 sc1
    buffer_load_dwordx4 v[200:203], v30, s[36:39], s98 offen offset:2048 sc1
    buffer_load_dwordx4 v[204:207], v30, s[36:39], s98 offen offset:3072 sc1
    s_add_u32 s98, s98, 4096
    buffer_load_dwordx4 v[208:211], v30, s[36:39], s98 offen offset:0 sc1
    buffer_load_dwordx4 v[212:215], v30, s[36:39], s98 offen offset:1024 sc1
    s_add_u32 s98, s98, 2048
    s_cmp_eq_u32 s98, 40960
    s_cselect_b32 s98, 0, s98
    s_nop 0
    buffer_load_dwordx4 v[216:219], v30, s[36:39], s98 offen offset:0 sc1
    buffer_load_dwordx4 v[220:223], v30, s[36:39], s98 offen offset:1024 sc1
    buffer_load_dwordx4 v[224:227], v30, s[36:39], s98 offen offset:2048 sc1
    buffer_load_dwordx4 v[228:231], v30, s[36:39], s98 offen offset:3072 sc1
    s_add_u32 s98, s98, 4096
    buffer_load_dwordx4 v[232:235], v30, s[36:39], s98 offen offset:0 sc1
    buffer_load_dwordx4 v[236:239], v30, s[36:39], s98 offen offset:1024 sc1
    buffer_load_dwordx4 v[240:243], v30, s[36:39], s98 offen offset:2048 sc1
    buffer_load_dwordx4 v[244:247], v30, s[36:39], s98 offen offset:3072 sc1
    s_add_u32 s98, s98, 4096
    buffer_load_dwordx4 v[248:251], v30, s[36:39], s98 offen offset:0 sc1
    buffer_load_dwordx4 v[252:255], v30, s[36:39], s98 offen offset:1024 sc1
    v_bfe_u32 v34, v1, 2, 2
    v_lshl_add_u32 v34, v34, 2, v32
    v_and_b32 v35, 3, v1
    v_lshlrev_b32 v33, 4, v34
    v_lshl_add_u32 v17, v35, 10, v33
    v_add_u32 v18, 0x1000, v33
    v_min_u32 v35, 1, v35
    v_lshlrev_b32 v33, 2, v34
    v_lshl_or_b32 v20, v35, 30, v33
    s_lshl2_add_u32 s89, s96, s52
    s_lshl_b32 s69, s89, 4
    s_sub_u32 s69, 2047, s69
    v_sub_u32_e64 v19, s69, v34
    s_mul_i32 s90, s96, 5120
    s_lshl_b32 s69, s52, 8
    s_add_u32 s90, s90, s69
    s_add_u32 s90, s90, 303104
    s_lshl_b32 s88, s96, 7
    s_add_u32 s88, s88, 159744
    s_cmp_eq_u32 s52, 1
    s_cselect_b32 s88, s88, 1073741824
    s_nop 0
    v_dot2_f32_bf16 v21, v76, s80, 0
    v_dot2_f32_bf16 v21, v77, s80, v21
    v_dot2_f32_bf16 v21, v78, s80, v21
    v_dot2_f32_bf16 v21, v79, s80, v21
    v_dot2_f32_bf16 v21, v80, s80, v21
    v_dot2_f32_bf16 v21, v81, s80, v21
    v_dot2_f32_bf16 v21, v82, s80, v21
    v_dot2_f32_bf16 v21, v83, s80, v21
    s_nop 2
    v_add_f32_dpp v21, v21, v21 row_ror:1 row_mask:0xf bank_mask:0xf
    s_nop 1
    v_add_f32_dpp v21, v21, v21 row_ror:2 row_mask:0xf bank_mask:0xf
    s_nop 1
    v_add_f32_dpp v21, v21, v21 row_ror:4 row_mask:0xf bank_mask:0xf
    s_nop 1
    v_add_f32_dpp v21, v21, v21 row_ror:8 row_mask:0xf bank_mask:0xf
    v_mov_b32 v34, v21
    s_nop 1
    v_permlane16_swap_b32 v34, v21
    v_add_f32 v21, v21, v34
    v_mov_b32 v34, v21
    s_nop 1
    v_permlane32_swap_b32 v34, v21
    v_add_f32 v21, v21, v34
    s_setprio 2
    s_barrier
    ds_read_b128 v[32:35], v16 offset:0
    ds_read_b128 v[36:39], v16 offset:20480
    ds_read_b128 v[40:43], v14 offset:0
    ds_read_b128 v[44:47], v14 offset:20480
    s_barrier
    ds_read_b128 v[48:51], v16 offset:1024
    s_waitcnt lgkmcnt(4)
    v_mfma_f32_16x16x32_bf16 v[64:67], v[96:99], v[32:35], 0
    ds_read_b128 v[52:55], v16 offset:21504
    v_mfma_f32_16x16x32_bf16 v[68:71], v[100:103], v[32:35], 0
    s_waitcnt lgkmcnt(4)
    v_mfma_f32_16x16x32_bf16 v[72:75], v[96:99], v[36:39], 0
    ds_read_b128 v[56:59], v14 offset:1024
    v_mfma_f32_16x16x32_bf16 v[76:79], v[100:103], v[36:39], 0
    s_waitcnt lgkmcnt(4)
    v_mfma_f32_16x16x32_bf16 v[80:83], v[96:99], v[40:43], 0
    ds_read_b128 v[60:63], v14 offset:21504
    v_mfma_f32_16x16x32_bf16 v[84:87], v[100:103], v[40:43], 0
    s_waitcnt lgkmcnt(4)
    v_mfma_f32_16x16x32_bf16 v[88:91], v[96:99], v[44:47], 0
    ds_read_b128 v[32:35], v16 offset:2048
    v_mfma_f32_16x16x32_bf16 v[92:95], v[100:103], v[44:47], 0
    s_waitcnt lgkmcnt(4)
    v_mfma_f32_16x16x32_bf16 v[64:67], v[104:107], v[48:51], v[64:67]
    ds_read_b128 v[36:39], v16 offset:22528
    v_mfma_f32_16x16x32_bf16 v[68:71], v[108:111], v[48:51], v[68:71]
    s_waitcnt lgkmcnt(4)
    v_mfma_f32_16x16x32_bf16 v[72:75], v[104:107], v[52:55], v[72:75]
    ds_read_b128 v[40:43], v14 offset:2048
    v_mfma_f32_16x16x32_bf16 v[76:79], v[108:111], v[52:55], v[76:79]
    s_waitcnt lgkmcnt(4)
    v_mfma_f32_16x16x32_bf16 v[80:83], v[104:107], v[56:59], v[80:83]
    ds_read_b128 v[44:47], v14 offset:22528
    v_mfma_f32_16x16x32_bf16 v[84:87], v[108:111], v[56:59], v[84:87]
    s_waitcnt lgkmcnt(4)
    v_mfma_f32_16x16x32_bf16 v[88:91], v[104:107], v[60:63], v[88:91]
    s_barrier
    ds_read_b128 v[48:51], v16 offset:3072
    v_mfma_f32_16x16x32_bf16 v[92:95], v[108:111], v[60:63], v[92:95]
    s_waitcnt lgkmcnt(4)
    v_mfma_f32_16x16x32_bf16 v[64:67], v[112:115], v[32:35], v[64:67]
    ds_read_b128 v[52:55], v16 offset:23552
    v_mfma_f32_16x16x32_bf16 v[68:71], v[116:119], v[32:35], v[68:71]
    s_waitcnt lgkmcnt(4)
    v_mfma_f32_16x16x32_bf16 v[72:75], v[112:115], v[36:39], v[72:75]
    ds_read_b128 v[56:59], v14 offset:3072
    v_mfma_f32_16x16x32_bf16 v[76:79], v[116:119], v[36:39], v[76:79]
    s_waitcnt lgkmcnt(4)
    v_mfma_f32_16x16x32_bf16 v[80:83], v[112:115], v[40:43], v[80:83]
    ds_read_b128 v[60:63], v14 offset:23552
    v_mfma_f32_16x16x32_bf16 v[84:87], v[116:119], v[40:43], v[84:87]
    s_waitcnt lgkmcnt(4)
    v_mfma_f32_16x16x32_bf16 v[88:91], v[112:115], v[44:47], v[88:91]
    ds_read_b128 v[32:35], v16 offset:4096
    v_mfma_f32_16x16x32_bf16 v[92:95], v[116:119], v[44:47], v[92:95]
    s_waitcnt lgkmcnt(4)
    v_mfma_f32_16x16x32_bf16 v[64:67], v[120:123], v[48:51], v[64:67]
    ds_read_b128 v[36:39], v16 offset:24576
    v_mfma_f32_16x16x32_bf16 v[68:71], v[124:127], v[48:51], v[68:71]
    s_waitcnt lgkmcnt(4)
    v_mfma_f32_16x16x32_bf16 v[72:75], v[120:123], v[52:55], v[72:75]
    ds_read_b128 v[40:43], v14 offset:4096
    v_mfma_f32_16x16x32_bf16 v[76:79], v[124:127], v[52:55], v[76:79]
    s_waitcnt lgkmcnt(4)
    v_mfma_f32_16x16x32_bf16 v[80:83], v[120:123], v[56:59], v[80:83]
    ds_read_b128 v[44:47], v14 offset:24576
    v_mfma_f32_16x16x32_bf16 v[84:87], v[124:127], v[56:59], v[84:87]
    s_waitcnt lgkmcnt(4)
    v_mfma_f32_16x16x32_bf16 v[88:91], v[120:123], v[60:63], v[88:91]
    ds_read_b128 v[48:51], v16 offset:5120
    v_mfma_f32_16x16x32_bf16 v[92:95], v[124:127], v[60:63], v[92:95]
    s_waitcnt vmcnt(31) lgkmcnt(4)
    v_mfma_f32_16x16x32_bf16 v[64:67], v[128:131], v[32:35], v[64:67]
    ds_read_b128 v[52:55], v16 offset:25600
    s_waitcnt vmcnt(30)
    v_mfma_f32_16x16x32_bf16 v[68:71], v[132:135], v[32:35], v[68:71]
    s_waitcnt lgkmcnt(4)
    v_mfma_f32_16x16x32_bf16 v[72:75], v[128:131], v[36:39], v[72:75]
    ds_read_b128 v[56:59], v14 offset:5120
    v_mfma_f32_16x16x32_bf16 v[76:79], v[132:135], v[36:39], v[76:79]
    s_waitcnt lgkmcnt(4)
    v_mfma_f32_16x16x32_bf16 v[80:83], v[128:131], v[40:43], v[80:83]
    ds_read_b128 v[60:63], v14 offset:25600
    v_mfma_f32_16x16x32_bf16 v[84:87], v[132:135], v[40:43], v[84:87]
    s_waitcnt lgkmcnt(4)
    v_mfma_f32_16x16x32_bf16 v[88:91], v[128:131], v[44:47], v[88:91]
    s_barrier
    ds_read_b128 v[32:35], v16 offset:6144
    v_mfma_f32_16x16x32_bf16 v[92:95], v[132:135], v[44:47], v[92:95]
    s_waitcnt vmcnt(29) lgkmcnt(4)
    v_mfma_f32_16x16x32_bf16 v[64:67], v[136:139], v[48:51], v[64:67]
    ds_read_b128 v[36:39], v16 offset:26624
    s_waitcnt vmcnt(28)
    v_mfma_f32_16x16x32_bf16 v[68:71], v[140:143], v[48:51], v[68:71]
    s_waitcnt lgkmcnt(4)
    v_mfma_f32_16x16x32_bf16 v[72:75], v[136:139], v[52:55], v[72:75]
    ds_read_b128 v[40:43], v14 offset:6144
    v_mfma_f32_16x16x32_bf16 v[76:79], v[140:143], v[52:55], v[76:79]
    s_waitcnt lgkmcnt(4)
    v_mfma_f32_16x16x32_bf16 v[80:83], v[136:139], v[56:59], v[80:83]
    ds_read_b128 v[44:47], v14 offset:26624
    v_mfma_f32_16x16x32_bf16 v[84:87], v[140:143], v[56:59], v[84:87]
    s_waitcnt lgkmcnt(4)
    v_mfma_f32_16x16x32_bf16 v[88:91], v[136:139], v[60:63], v[88:91]
    ds_read_b128 v[48:51], v16 offset:7168
    v_mfma_f32_16x16x32_bf16 v[92:95], v[140:143], v[60:63], v[92:95]
    s_waitcnt vmcnt(27) lgkmcnt(4)
    v_mfma_f32_16x16x32_bf16 v[64:67], v[144:147], v[32:35], v[64:67]
    ds_read_b128 v[52:55], v16 offset:27648
    s_waitcnt vmcnt(26)
    v_mfma_f32_16x16x32_bf16 v[68:71], v[148:151], v[32:35], v[68:71]
    s_waitcnt lgkmcnt(4)
    v_mfma_f32_16x16x32_bf16 v[72:75], v[144:147], v[36:39], v[72:75]
    ds_read_b128 v[56:59], v14 offset:7168
    v_mfma_f32_16x16x32_bf16 v[76:79], v[148:151], v[36:39], v[76:79]
    s_waitcnt lgkmcnt(4)
    v_mfma_f32_16x16x32_bf16 v[80:83], v[144:147], v[40:43], v[80:83]
    ds_read_b128 v[60:63], v14 offset:27648
    v_mfma_f32_16x16x32_bf16 v[84:87], v[148:151], v[40:43], v[84:87]
    s_waitcnt lgkmcnt(4)
    v_mfma_f32_16x16x32_bf16 v[88:91], v[144:147], v[44:47], v[88:91]
    ds_read_b128 v[32:35], v16 offset:8192
    v_mfma_f32_16x16x32_bf16 v[92:95], v[148:151], v[44:47], v[92:95]
    s_waitcnt vmcnt(25) lgkmcnt(4)
    v_mfma_f32_16x16x32_bf16 v[64:67], v[152:155], v[48:51], v[64:67]
    ds_read_b128 v[36:39], v16 offset:28672
    s_waitcnt vmcnt(24)
    v_mfma_f32_16x16x32_bf16 v[68:71], v[156:159], v[48:51], v[68:71]
    s_waitcnt lgkmcnt(4)
    v_mfma_f32_16x16x32_bf16 v[72:75], v[152:155], v[52:55], v[72:75]
    ds_read_b128 v[40:43], v14 offset:8192
    v_mfma_f32_16x16x32_bf16 v[76:79], v[156:159], v[52:55], v[76:79]
    s_waitcnt lgkmcnt(4)
    v_mfma_f32_16x16x32_bf16 v[80:83], v[152:155], v[56:59], v[80:83]
    ds_read_b128 v[44:47], v14 offset:28672
    v_mfma_f32_16x16x32_bf16 v[84:87], v[156:159], v[56:59], v[84:87]
    s_waitcnt lgkmcnt(4)
    v_mfma_f32_16x16x32_bf16 v[88:91], v[152:155], v[60:63], v[88:91]
    ds_read_b128 v[48:51], v16 offset:9216
    v_mfma_f32_16x16x32_bf16 v[92:95], v[156:159], v[60:63], v[92:95]
    s_waitcnt vmcnt(23) lgkmcnt(4)
    v_mfma_f32_16x16x32_bf16 v[64:67], v[160:163], v[32:35], v[64:67]
    ds_read_b128 v[52:55], v16 offset:29696
    s_waitcnt vmcnt(22)
    v_mfma_f32_16x16x32_bf16 v[68:71], v[164:167], v[32:35], v[68:71]
    s_waitcnt lgkmcnt(4)
    v_mfma_f32_16x16x32_bf16 v[72:75], v[160:163], v[36:39], v[72:75]
    ds_read_b128 v[56:59], v14 offset:9216
    v_mfma_f32_16x16x32_bf16 v[76:79], v[164:167], v[36:39], v[76:79]
    s_waitcnt lgkmcnt(4)
    v_mfma_f32_16x16x32_bf16 v[80:83], v[160:163], v[40:43], v[80:83]
    ds_read_b128 v[60:63], v14 offset:29696
    v_mfma_f32_16x16x32_bf16 v[84:87], v[164:167], v[40:43], v[84:87]
    s_waitcnt lgkmcnt(4)
    v_mfma_f32_16x16x32_bf16 v[88:91], v[160:163], v[44:47], v[88:91]
    s_barrier
    ds_read_b128 v[32:35], v16 offset:10240
    v_mfma_f32_16x16x32_bf16 v[92:95], v[164:167], v[44:47], v[92:95]
    s_waitcnt vmcnt(21) lgkmcnt(4)
    v_mfma_f32_16x16x32_bf16 v[64:67], v[168:171], v[48:51], v[64:67]
    ds_read_b128 v[36:39], v16 offset:30720
    s_waitcnt vmcnt(20)
    v_mfma_f32_16x16x32_bf16 v[68:71], v[172:175], v[48:51], v[68:71]
    s_waitcnt lgkmcnt(4)
    v_mfma_f32_16x16x32_bf16 v[72:75], v[168:171], v[52:55], v[72:75]
    ds_read_b128 v[40:43], v14 offset:10240
    v_mfma_f32_16x16x32_bf16 v[76:79], v[172:175], v[52:55], v[76:79]
    s_waitcnt lgkmcnt(4)
    v_mfma_f32_16x16x32_bf16 v[80:83], v[168:171], v[56:59], v[80:83]
    ds_read_b128 v[44:47], v14 offset:30720
    v_mfma_f32_16x16x32_bf16 v[84:87], v[172:175], v[56:59], v[84:87]
    s_waitcnt lgkmcnt(4)
    v_mfma_f32_16x16x32_bf16 v[88:91], v[168:171], v[60:63], v[88:91]
    ds_read_b128 v[48:51], v16 offset:11264
    v_mfma_f32_16x16x32_bf16 v[92:95], v[172:175], v[60:63], v[92:95]
    s_waitcnt vmcnt(19) lgkmcnt(4)
    v_mfma_f32_16x16x32_bf16 v[64:67], v[176:179], v[32:35], v[64:67]
    ds_read_b128 v[52:55], v16 offset:31744
    s_waitcnt vmcnt(18)
    v_mfma_f32_16x16x32_bf16 v[68:71], v[180:183], v[32:35], v[68:71]
    s_waitcnt lgkmcnt(4)
    v_mfma_f32_16x16x32_bf16 v[72:75], v[176:179], v[36:39], v[72:75]
    ds_read_b128 v[56:59], v14 offset:11264
    v_mfma_f32_16x16x32_bf16 v[76:79], v[180:183], v[36:39], v[76:79]
    s_waitcnt lgkmcnt(4)
    v_mfma_f32_16x16x32_bf16 v[80:83], v[176:179], v[40:43], v[80:83]
    ds_read_b128 v[60:63], v14 offset:31744
    v_mfma_f32_16x16x32_bf16 v[84:87], v[180:183], v[40:43], v[84:87]
    s_waitcnt lgkmcnt(4)
    v_mfma_f32_16x16x32_bf16 v[88:91], v[176:179], v[44:47], v[88:91]
    ds_read_b128 v[32:35], v16 offset:12288
    v_mfma_f32_16x16x32_bf16 v[92:95], v[180:183], v[44:47], v[92:95]
    s_waitcnt vmcnt(17) lgkmcnt(4)
    v_mfma_f32_16x16x32_bf16 v[64:67], v[184:187], v[48:51], v[64:67]
    ds_read_b128 v[36:39], v16 offset:32768
    s_waitcnt vmcnt(16)
    v_mfma_f32_16x16x32_bf16 v[68:71], v[188:191], v[48:51], v[68:71]
    s_waitcnt lgkmcnt(4)
    v_mfma_f32_16x16x32_bf16 v[72:75], v[184:187], v[52:55], v[72:75]
    ds_read_b128 v[40:43], v14 offset:12288
    v_mfma_f32_16x16x32_bf16 v[76:79], v[188:191], v[52:55], v[76:79]
    s_waitcnt lgkmcnt(4)
    v_mfma_f32_16x16x32_bf16 v[80:83], v[184:187], v[56:59], v[80:83]
    ds_read_b128 v[44:47], v14 offset:32768
    v_mfma_f32_16x16x32_bf16 v[84:87], v[188:191], v[56:59], v[84:87]
    s_waitcnt lgkmcnt(4)
    v_mfma_f32_16x16x32_bf16 v[88:91], v[184:187], v[60:63], v[88:91]
    ds_read_b128 v[48:51], v16 offset:13312
    v_mfma_f32_16x16x32_bf16 v[92:95], v[188:191], v[60:63], v[92:95]
    s_waitcnt vmcnt(15) lgkmcnt(4)
    v_mfma_f32_16x16x32_bf16 v[64:67], v[192:195], v[32:35], v[64:67]
    ds_read_b128 v[52:55], v16 offset:33792
    s_waitcnt vmcnt(14)
    v_mfma_f32_16x16x32_bf16 v[68:71], v[196:199], v[32:35], v[68:71]
    s_waitcnt lgkmcnt(4)
    v_mfma_f32_16x16x32_bf16 v[72:75], v[192:195], v[36:39], v[72:75]
    ds_read_b128 v[56:59], v14 offset:13312
    v_mfma_f32_16x16x32_bf16 v[76:79], v[196:199], v[36:39], v[76:79]
    s_waitcnt lgkmcnt(4)
    v_mfma_f32_16x16x32_bf16 v[80:83], v[192:195], v[40:43], v[80:83]
    ds_read_b128 v[60:63], v14 offset:33792
    v_mfma_f32_16x16x32_bf16 v[84:87], v[196:199], v[40:43], v[84:87]
    s_waitcnt lgkmcnt(4)
    v_mfma_f32_16x16x32_bf16 v[88:91], v[192:195], v[44:47], v[88:91]
    ds_read_b128 v[32:35], v16 offset:14336
    v_mfma_f32_16x16x32_bf16 v[92:95], v[196:199], v[44:47], v[92:95]
    s_waitcnt vmcnt(13) lgkmcnt(4)
    v_mfma_f32_16x16x32_bf16 v[64:67], v[200:203], v[48:51], v[64:67]
    ds_read_b128 v[36:39], v16 offset:34816
    s_waitcnt vmcnt(12)
    v_mfma_f32_16x16x32_bf16 v[68:71], v[204:207], v[48:51], v[68:71]
    s_waitcnt lgkmcnt(4)
    v_mfma_f32_16x16x32_bf16 v[72:75], v[200:203], v[52:55], v[72:75]
    ds_read_b128 v[40:43], v14 offset:14336
    v_mfma_f32_16x16x32_bf16 v[76:79], v[204:207], v[52:55], v[76:79]
    s_waitcnt lgkmcnt(4)
    v_mfma_f32_16x16x32_bf16 v[80:83], v[200:203], v[56:59], v[80:83]
    ds_read_b128 v[44:47], v14 offset:34816
    v_mfma_f32_16x16x32_bf16 v[84:87], v[204:207], v[56:59], v[84:87]
    s_waitcnt lgkmcnt(4)
    v_mfma_f32_16x16x32_bf16 v[88:91], v[200:203], v[60:63], v[88:91]
    s_barrier
    ds_read_b128 v[48:51], v16 offset:15360
    v_mfma_f32_16x16x32_bf16 v[92:95], v[204:207], v[60:63], v[92:95]
    s_waitcnt vmcnt(11) lgkmcnt(4)
    v_mfma_f32_16x16x32_bf16 v[64:67], v[208:211], v[32:35], v[64:67]
    ds_read_b128 v[52:55], v16 offset:35840
    s_waitcnt vmcnt(10)
    v_mfma_f32_16x16x32_bf16 v[68:71], v[212:215], v[32:35], v[68:71]
    s_waitcnt lgkmcnt(4)
    v_mfma_f32_16x16x32_bf16 v[72:75], v[208:211], v[36:39], v[72:75]
    ds_read_b128 v[56:59], v14 offset:15360
    v_mfma_f32_16x16x32_bf16 v[76:79], v[212:215], v[36:39], v[76:79]
    s_waitcnt lgkmcnt(4)
    v_mfma_f32_16x16x32_bf16 v[80:83], v[208:211], v[40:43], v[80:83]
    ds_read_b128 v[60:63], v14 offset:35840
    v_mfma_f32_16x16x32_bf16 v[84:87], v[212:215], v[40:43], v[84:87]
    s_waitcnt lgkmcnt(4)
    v_mfma_f32_16x16x32_bf16 v[88:91], v[208:211], v[44:47], v[88:91]
    ds_read_b128 v[32:35], v16 offset:16384
    v_mfma_f32_16x16x32_bf16 v[92:95], v[212:215], v[44:47], v[92:95]
    s_waitcnt vmcnt(9) lgkmcnt(4)
    v_mfma_f32_16x16x32_bf16 v[64:67], v[216:219], v[48:51], v[64:67]
    ds_read_b128 v[36:39], v16 offset:36864
    s_waitcnt vmcnt(8)
    v_mfma_f32_16x16x32_bf16 v[68:71], v[220:223], v[48:51], v[68:71]
    s_waitcnt lgkmcnt(4)
    v_mfma_f32_16x16x32_bf16 v[72:75], v[216:219], v[52:55], v[72:75]
    ds_read_b128 v[40:43], v14 offset:16384
    v_mfma_f32_16x16x32_bf16 v[76:79], v[220:223], v[52:55], v[76:79]
    s_waitcnt lgkmcnt(4)
    v_mfma_f32_16x16x32_bf16 v[80:83], v[216:219], v[56:59], v[80:83]
    ds_read_b128 v[44:47], v14 offset:36864
    v_mfma_f32_16x16x32_bf16 v[84:87], v[220:223], v[56:59], v[84:87]
    s_waitcnt lgkmcnt(4)
    v_mfma_f32_16x16x32_bf16 v[88:91], v[216:219], v[60:63], v[88:91]
    ds_read_b128 v[48:51], v16 offset:17408
    v_mfma_f32_16x16x32_bf16 v[92:95], v[220:223], v[60:63], v[92:95]
    s_waitcnt vmcnt(7) lgkmcnt(4)
    v_mfma_f32_16x16x32_bf16 v[64:67], v[224:227], v[32:35], v[64:67]
    ds_read_b128 v[52:55], v16 offset:37888
    s_waitcnt vmcnt(6)
    v_mfma_f32_16x16x32_bf16 v[68:71], v[228:231], v[32:35], v[68:71]
    s_waitcnt lgkmcnt(4)
    v_mfma_f32_16x16x32_bf16 v[72:75], v[224:227], v[36:39], v[72:75]
    ds_read_b128 v[56:59], v14 offset:17408
    v_mfma_f32_16x16x32_bf16 v[76:79], v[228:231], v[36:39], v[76:79]
    s_waitcnt lgkmcnt(4)
    v_mfma_f32_16x16x32_bf16 v[80:83], v[224:227], v[40:43], v[80:83]
    ds_read_b128 v[60:63], v14 offset:37888
    v_mfma_f32_16x16x32_bf16 v[84:87], v[228:231], v[40:43], v[84:87]
    s_waitcnt lgkmcnt(4)
    v_mfma_f32_16x16x32_bf16 v[88:91], v[224:227], v[44:47], v[88:91]
    ds_read_b128 v[32:35], v16 offset:18432
    v_mfma_f32_16x16x32_bf16 v[92:95], v[228:231], v[44:47], v[92:95]
    s_waitcnt vmcnt(5) lgkmcnt(4)
    v_mfma_f32_16x16x32_bf16 v[64:67], v[232:235], v[48:51], v[64:67]
    ds_read_b128 v[36:39], v16 offset:19456
    s_waitcnt vmcnt(4)
    v_mfma_f32_16x16x32_bf16 v[68:71], v[236:239], v[48:51], v[68:71]
    s_waitcnt lgkmcnt(4)
    v_mfma_f32_16x16x32_bf16 v[72:75], v[232:235], v[52:55], v[72:75]
    ds_read_b128 v[40:43], v16 offset:38912
    v_mfma_f32_16x16x32_bf16 v[76:79], v[236:239], v[52:55], v[76:79]
    s_waitcnt lgkmcnt(4)
    v_mfma_f32_16x16x32_bf16 v[80:83], v[232:235], v[56:59], v[80:83]
    ds_read_b128 v[44:47], v16 offset:39936
    v_mfma_f32_16x16x32_bf16 v[84:87], v[236:239], v[56:59], v[84:87]
    s_waitcnt lgkmcnt(4)
    v_mfma_f32_16x16x32_bf16 v[88:91], v[232:235], v[60:63], v[88:91]
    ds_read_b128 v[48:51], v14 offset:18432
    v_mfma_f32_16x16x32_bf16 v[92:95], v[236:239], v[60:63], v[92:95]
    s_waitcnt vmcnt(3) lgkmcnt(4)
    v_mfma_f32_16x16x32_bf16 v[64:67], v[240:243], v[32:35], v[64:67]
    ds_read_b128 v[52:55], v14 offset:19456
    s_waitcnt vmcnt(2)
    v_mfma_f32_16x16x32_bf16 v[68:71], v[244:247], v[32:35], v[68:71]
    s_waitcnt vmcnt(1) lgkmcnt(4)
    v_mfma_f32_16x16x32_bf16 v[64:67], v[248:251], v[36:39], v[64:67]
    ds_read_b128 v[56:59], v14 offset:38912
    s_waitcnt vmcnt(0)
    v_mfma_f32_16x16x32_bf16 v[68:71], v[252:255], v[36:39], v[68:71]
    s_waitcnt lgkmcnt(4)
    v_mfma_f32_16x16x32_bf16 v[72:75], v[240:243], v[40:43], v[72:75]
    ds_read_b128 v[60:63], v14 offset:39936
    v_mfma_f32_16x16x32_bf16 v[76:79], v[244:247], v[40:43], v[76:79]
    s_waitcnt lgkmcnt(4)
    v_mfma_f32_16x16x32_bf16 v[72:75], v[248:251], v[44:47], v[72:75]
    v_cvt_pk_bf16_f32 v64, v64, v65
    v_cvt_pk_bf16_f32 v65, v66, v67
    v_mfma_f32_16x16x32_bf16 v[76:79], v[252:255], v[44:47], v[76:79]
    v_cvt_pk_bf16_f32 v66, v68, v69
    v_cvt_pk_bf16_f32 v67, v70, v71
    s_waitcnt lgkmcnt(3)
    v_mfma_f32_16x16x32_bf16 v[80:83], v[240:243], v[48:51], v[80:83]
    ds_write_b128 v15, v[64:67] offset:0
    v_mfma_f32_16x16x32_bf16 v[84:87], v[244:247], v[48:51], v[84:87]
    s_waitcnt lgkmcnt(3)
    v_mfma_f32_16x16x32_bf16 v[80:83], v[248:251], v[52:55], v[80:83]
    v_cvt_pk_bf16_f32 v72, v72, v73
    v_cvt_pk_bf16_f32 v73, v74, v75
    v_mfma_f32_16x16x32_bf16 v[84:87], v[252:255], v[52:55], v[84:87]
    v_cvt_pk_bf16_f32 v74, v76, v77
    v_cvt_pk_bf16_f32 v75, v78, v79
    s_waitcnt lgkmcnt(2)
    v_mfma_f32_16x16x32_bf16 v[88:91], v[240:243], v[56:59], v[88:91]
    ds_write_b128 v15, v[72:75] offset:4096
    v_mfma_f32_16x16x32_bf16 v[92:95], v[244:247], v[56:59], v[92:95]
    s_waitcnt lgkmcnt(2)
    v_mfma_f32_16x16x32_bf16 v[88:91], v[248:251], v[60:63], v[88:91]
    v_cvt_pk_bf16_f32 v80, v80, v81
    v_cvt_pk_bf16_f32 v81, v82, v83
    v_mfma_f32_16x16x32_bf16 v[92:95], v[252:255], v[60:63], v[92:95]
    v_cvt_pk_bf16_f32 v82, v84, v85
    v_cvt_pk_bf16_f32 v83, v86, v87
    ds_write_b128 v15, v[80:83] offset:8192
    s_nop 1
    v_cvt_pk_bf16_f32 v88, v88, v89
    v_cvt_pk_bf16_f32 v89, v90, v91
    s_nop 0
    v_cvt_pk_bf16_f32 v90, v92, v93
    v_cvt_pk_bf16_f32 v91, v94, v95
    ds_write_b128 v15, v[88:91] offset:12288
    v_cmp_u_f32 vcc, v71, v79
    v_cmp_u_f32 s[76:77], v87, v95
    s_or_b64 vcc, vcc, s[76:77]
    s_cbranch_vccnz L_redo
L_redone:
    s_waitcnt lgkmcnt(0)
    s_barrier
    s_cmp_lg_u32 s97, 0
    s_cbranch_scc1 L_fin
    s_barrier
    buffer_load_dwordx4 v[32:35], v17, s[36:39], s90 offen sc1
    buffer_load_dwordx4 v[40:43], v18, s[36:39], s90 offen sc1
    buffer_store_dword v4, v6, s[36:39], s88 offen sc1
    s_waitcnt vmcnt(2)
    v_cmp_ne_u32 vcc, s57, v35
    s_waitcnt vmcnt(1)
    v_cmp_ne_u32 s[76:77], s57, v43
    s_or_b64 vcc, vcc, s[76:77]
    s_cbranch_vccnz spin_sb_52017
ok_sb_52018:
    v_add_f32_dpp v32, v32, v32 quad_perm:[1,0,3,2] row_mask:0xf bank_mask:0xf
    v_add_f32_dpp v33, v33, v33 quad_perm:[1,0,3,2] row_mask:0xf bank_mask:0xf
    v_add_f32_dpp v34, v34, v34 quad_perm:[1,0,3,2] row_mask:0xf bank_mask:0xf
    v_add_f32_dpp v32, v32, v32 quad_perm:[2,3,0,1] row_mask:0xf bank_mask:0xf
    v_add_f32_dpp v33, v33, v33 quad_perm:[2,3,0,1] row_mask:0xf bank_mask:0xf
    v_add_f32_dpp v34, v34, v34 quad_perm:[2,3,0,1] row_mask:0xf bank_mask:0xf
    v_pk_add_f32 v[32:33], v[32:33], v[40:41]
    v_add_f32_e64 v34, v34, v42
    v_mul_f32 v32, 0x3acccccd, v32
    v_mul_f32 v33, 0x3acccccd, v33
    v_fma_f32 v33, -v32, v32, v33
    v_max_f32_e64 v33, 0, v33
    v_cvt_pk_bf16_f32 v33, 0, v33
    v_add_f32 v33, 0x3727c5ac, v33
    v_cvt_pk_bf16_f32 v33, 0, v33
    v_sqrt_f32_e64 v33, v33
    v_cvt_pk_bf16_f32 v32, 0, v32
    v_cvt_pk_bf16_f32 v33, 0, v33
    v_rcp_f32_e64 v37, v33
    v_fma_f32 v34, -v32, v21, v34
    v_mul_f32 v34, v34, v37
    v_ashrrev_i32 v40, 31, v34
    v_or_b32 v40, 0x80000000, v40
    v_xor_b32_e64 v40, v40, v34
    v_min_u32 v40, 0xfffff000, v40
    v_and_b32 v40, 0xfffff800, v40
    v_or_b32_e64 v40, v40, v19
    buffer_store_dword v40, v20, s[36:39], s95 offen sc1
    s_barrier
    s_branch L_fin
L_ffn:
    s_waitcnt vmcnt(0) lgkmcnt(0)
    s_barrier
    s_waitcnt vmcnt(0) lgkmcnt(0)
    s_mov_b32 s32, s16
    s_and_b32 s33, s17, 0xffff
    s_mov_b32 s34, 1966080
    s_mov_b32 s35, 0x20000
    s_mov_b32 s28, s18
    s_and_b32 s29, s19, 0xffff
    s_mov_b32 s30, 1966080
    s_mov_b32 s31, 0x20000
    s_sub_u32 s68, s56, 5
    s_lshl_b32 s68, s68, 10
    s_lshl2_add_u32 s69, s55, s52
    s_mul_i32 s69, s69, 15360
    s_add_u32 s68, s68, s69
    v_min_u32 v32, 39, v1
    v_lshrrev_b32_e64 v33, 3, v32
    v_mul_u32_u24 v33, 2048, v33
    v_lshl_add_u32 v32, v32, 7, v33
    buffer_load_dword v34, v32, s[32:35], s68 offen
    buffer_load_dword v35, v32, s[28:31], s68 offen
    s_cmp_ge_u32 s12, 208
    s_cbranch_scc1 L_ffn2
    s_add_u32 s70, s73, 65536
    s_mul_i32 s68, s94, 8192
    s_add_u32 s68, s68, s70
    s_add_u32 m0, s68, 0
    s_nop 0
    buffer_load_dwordx4 v28, s[40:43], s81 offen lds
    s_add_u32 m0, s68, 4096
    s_nop 0
    buffer_load_dwordx4 v28, s[44:47], s81 offen lds
    s_add_u32 s81, s81, s101
    s_cmp_eq_u32 s81, 491520
    s_cselect_b32 s81, 0, s81
    s_add_u32 s94, s94, 1
    s_cmp_eq_u32 s94, 10
    s_cselect_b32 s94, 0, s94
    s_mul_i32 s68, s94, 8192
    s_add_u32 s68, s68, s70
    s_add_u32 m0, s68, 0
    s_nop 0
    buffer_load_dwordx4 v28, s[40:43], s81 offen lds
    s_add_u32 m0, s68, 4096
    s_nop 0
    buffer_load_dwordx4 v28, s[44:47], s81 offen lds
    s_add_u32 s81, s81, s101
    s_cmp_eq_u32 s81, 491520
    s_cselect_b32 s81, 0, s81
    s_add_u32 s94, s94, 1
    s_cmp_eq_u32 s94, 10
    s_cselect_b32 s94, 0, s94
    s_mul_i32 s68, s94, 8192
    s_add_u32 s68, s68, s70
    s_add_u32 m0, s68, 0
    s_nop 0
    buffer_load_dwordx4 v28, s[40:43], s81 offen lds
    s_add_u32 m0, s68, 4096
    s_nop 0
    buffer_load_dwordx4 v28, s[44:47], s81 offen lds
    s_add_u32 s81, s81, s101
    s_cmp_eq_u32 s81, 491520
    s_cselect_b32 s81, 0, s81
    s_add_u32 s94, s94, 1
    s_cmp_eq_u32 s94, 10
    s_cselect_b32 s94, 0, s94
    s_mul_i32 s68, s94, 8192
    s_add_u32 s68, s68, s70
    s_add_u32 m0, s68, 0
    s_nop 0
    buffer_load_dwordx4 v28, s[40:43], s81 offen lds
    s_add_u32 m0, s68, 4096
    s_nop 0
    buffer_load_dwordx4 v28, s[44:47], s81 offen lds
    s_add_u32 s81, s81, s101
    s_cmp_eq_u32 s81, 491520
    s_cselect_b32 s81, 0, s81
    s_add_u32 s94, s94, 1
    s_cmp_eq_u32 s94, 10
    s_cselect_b32 s94, 0, s94
    s_mul_i32 s68, s94, 8192
    s_add_u32 s68, s68, s70
    s_add_u32 m0, s68, 0
    s_nop 0
    buffer_load_dwordx4 v28, s[40:43], s81 offen lds
    s_add_u32 m0, s68, 4096
    s_nop 0
    buffer_load_dwordx4 v28, s[44:47], s81 offen lds
    s_add_u32 s81, s81, s101
    s_cmp_eq_u32 s81, 491520
    s_cselect_b32 s81, 0, s81
    s_add_u32 s94, s94, 1
    s_cmp_eq_u32 s94, 10
    s_cselect_b32 s94, 0, s94
    s_mul_i32 s68, s94, 8192
    s_add_u32 s68, s68, s70
    s_add_u32 m0, s68, 0
    s_nop 0
    buffer_load_dwordx4 v28, s[40:43], s81 offen lds
    s_add_u32 m0, s68, 4096
    s_nop 0
    buffer_load_dwordx4 v28, s[44:47], s81 offen lds
    s_add_u32 s81, s81, s101
    s_cmp_eq_u32 s81, 491520
    s_cselect_b32 s81, 0, s81
    s_add_u32 s94, s94, 1
    s_cmp_eq_u32 s94, 10
    s_cselect_b32 s94, 0, s94
    s_mul_i32 s68, s94, 8192
    s_add_u32 s68, s68, s70
    s_add_u32 m0, s68, 0
    s_nop 0
    buffer_load_dwordx4 v28, s[40:43], s81 offen lds
    s_add_u32 m0, s68, 4096
    s_nop 0
    buffer_load_dwordx4 v28, s[44:47], s81 offen lds
    s_add_u32 s81, s81, s101
    s_cmp_eq_u32 s81, 491520
    s_cselect_b32 s81, 0, s81
    s_add_u32 s94, s94, 1
    s_cmp_eq_u32 s94, 10
    s_cselect_b32 s94, 0, s94
    s_mul_i32 s68, s94, 8192
    s_add_u32 s68, s68, s70
    s_add_u32 m0, s68, 0
    s_nop 0
    buffer_load_dwordx4 v28, s[40:43], s81 offen lds
    s_add_u32 m0, s68, 4096
    s_nop 0
    buffer_load_dwordx4 v28, s[44:47], s81 offen lds
    s_add_u32 s81, s81, s101
    s_cmp_eq_u32 s81, 491520
    s_cselect_b32 s81, 0, s81
    s_add_u32 s94, s94, 1
    s_cmp_eq_u32 s94, 10
    s_cselect_b32 s94, 0, s94
    s_mul_i32 s68, s94, 8192
    s_add_u32 s68, s68, s70
    s_add_u32 m0, s68, 0
    s_nop 0
    buffer_load_dwordx4 v28, s[40:43], s81 offen lds
    s_add_u32 m0, s68, 4096
    s_nop 0
    buffer_load_dwordx4 v28, s[44:47], s81 offen lds
    s_add_u32 s81, s81, s101
    s_cmp_eq_u32 s81, 491520
    s_cselect_b32 s81, 0, s81
    s_add_u32 s94, s94, 1
    s_cmp_eq_u32 s94, 10
    s_cselect_b32 s94, 0, s94
    s_mul_i32 s68, s94, 8192
    s_add_u32 s68, s68, s70
    s_add_u32 m0, s68, 0
    s_nop 0
    buffer_load_dwordx4 v28, s[40:43], s81 offen lds
    s_add_u32 m0, s68, 4096
    s_nop 0
    buffer_load_dwordx4 v28, s[44:47], s81 offen lds
    s_add_u32 s81, s81, s101
    s_cmp_eq_u32 s81, 491520
    s_cselect_b32 s81, 0, s81
    s_add_u32 s94, s94, 1
    s_cmp_eq_u32 s94, 10
    s_cselect_b32 s94, 0, s94
    s_nop 0
    v_dot2_f32_bf16 v94, v76, v76, 0
    v_dot2_f32_bf16 v94, v77, v77, v94
    v_dot2_f32_bf16 v94, v78, v78, v94
    v_dot2_f32_bf16 v94, v79, v79, v94
    v_dot2_f32_bf16 v94, v80, v80, v94
    v_dot2_f32_bf16 v94, v81, v81, v94
    v_dot2_f32_bf16 v94, v82, v82, v94
    v_dot2_f32_bf16 v94, v83, v83, v94
    s_nop 2
    v_add_f32_dpp v94, v94, v94 row_ror:1 row_mask:0xf bank_mask:0xf
    s_nop 1
    v_add_f32_dpp v94, v94, v94 row_ror:2 row_mask:0xf bank_mask:0xf
    s_nop 1
    v_add_f32_dpp v94, v94, v94 row_ror:4 row_mask:0xf bank_mask:0xf
    s_nop 1
    v_add_f32_dpp v94, v94, v94 row_ror:8 row_mask:0xf bank_mask:0xf
    v_mov_b32 v95, v94
    s_nop 1
    v_permlane16_swap_b32 v95, v94
    v_add_f32 v94, v94, v95
    v_mov_b32 v95, v94
    s_nop 1
    v_permlane32_swap_b32 v95, v94
    v_add_f32 v94, v94, v95
    v_sqrt_f32 v94, v94
    s_nop 0
    v_mul_f32 v94, 0x3c800000, v94
    v_mov_b32 v11, 32768
    v_lshl_add_u32 v13, v1, 2, v11
    v_mov_b32_e64 v14, 0
    ds_write_b32 v13, v14
    v_and_b32 v12, 0x30, v2
    v_lshrrev_b32 v92, 2, v0
    v_lshl_add_u32 v92, v92, 7, v12
    v_and_b32 v93, 7, v0
    v_min_u32 v93, 4, v93
    v_lshrrev_b32 v15, 3, v0
    v_lshlrev_b32 v15, 7, v15
    v_lshl_add_u32 v93, v93, 2, v15
    v_add_u32 v12, v11, v12
    v_and_b32 v14, 0x3c, v1
    v_add_u32 v14, v11, v14
    v_add_u32 v13, v6, v11
    v_lshrrev_b32_e64 v7, 1, v1
    v_lshl_add_u32 v7, v7, 2, v11
    v_and_b32_e64 v8, 1, v1
    v_lshl_add_u32 v8, v8, 6, v11
    v_mov_b32 v15, 1
    v_bfrev_b32 v91, 1
    v_lshrrev_b32_e64 v36, 4, v1
    v_bfe_u32 v38, v1, 2, 2
    v_bfe_u32 v39, v1, 4, 1
    v_lshl_add_u32 v38, v39, 3, v38
    s_lshl_b32 s68, s52, 4
    s_add_u32 s68, s68, 65536
    v_lshl_add_u32 v38, v38, 6, s68
    v_lshrrev_b32 v39, 5, v1
    v_lshl_add_u32 v38, v39, 13, v38
    v_and_b32_e64 v39, 1, v1
    v_lshl_add_u32 v38, v39, 12, v38
    v_and_b32_e64 v39, 2, v1
    v_lshl_add_u32 v84, v39, 2, v38
    v_add_u32 v85, 0x10000, v84
    s_lshl_b32 s68, s52, 2
    v_add_u32 v38, s68, v36
    v_lshl_add_u32 v117, v38, 2, v11
    v_lshl_add_u32 v118, v38, 3, v11
    v_and_b32 v39, 15, v1
    v_xor_b32 v38, v38, v39
    v_lshlrev_b32 v86, 4, v38
    v_min_u32 v38, 4, v39
    v_lshlrev_b32 v119, 4, v38
    v_cmp_gt_u32 vcc, 5, v39
    v_lshl_add_u32 v120, v39, 3, v11
    v_lshl_add_u32 v89, v39, 2, v11
    v_cndmask_b32 v121, 0, 1.0, vcc
    v_lshl_add_u32 v90, v36, 4, v11
    v_lshrrev_b32 v38, 2, v39
    v_lshlrev_b32 v38, 12, v38
    v_lshl_add_u32 v38, v39, 8, v38
    v_xor_b32_e64 v39, v39, v36
    v_lshl_add_u32 v112, v39, 4, v38
    v_xor_b32_e64 v113, 64, v112
    v_xor_b32 v114, 128, v112
    v_xor_b32 v115, 192, v112
    v_mov_b32 v122, 1073741824
    v_lshlrev_b32 v88, 2, v36
    v_mov_b32 v40, s80
    v_mov_b32 v41, s80
    v_mov_b32 v42, s80
    v_mov_b32 v43, s80
    s_waitcnt vmcnt(0) lgkmcnt(0)
    s_barrier
    ds_read_b64_tr_b16 v[176:177], v84 offset:0
    ds_read_b64_tr_b16 v[178:179], v84 offset:256
    ds_read_b64_tr_b16 v[180:181], v84 offset:16384
    ds_read_b64_tr_b16 v[182:183], v84 offset:16640
    ds_read_b64_tr_b16 v[184:185], v84 offset:32768
    ds_read_b64_tr_b16 v[186:187], v84 offset:33024
    ds_read_b64_tr_b16 v[188:189], v84 offset:49152
    ds_read_b64_tr_b16 v[190:191], v84 offset:49408
    ds_read_b64_tr_b16 v[192:193], v85 offset:0
    ds_read_b64_tr_b16 v[194:195], v85 offset:256
    ds_read_b64_tr_b16 v[196:197], v84 offset:1024
    ds_read_b64_tr_b16 v[198:199], v84 offset:1280
    ds_read_b64_tr_b16 v[200:201], v84 offset:17408
    ds_read_b64_tr_b16 v[202:203], v84 offset:17664
    ds_read_b64_tr_b16 v[204:205], v84 offset:33792
    ds_read_b64_tr_b16 v[206:207], v84 offset:34048
    ds_read_b64_tr_b16 v[208:209], v84 offset:50176
    ds_read_b64_tr_b16 v[210:211], v84 offset:50432
    ds_read_b64_tr_b16 v[212:213], v85 offset:1024
    ds_read_b64_tr_b16 v[214:215], v85 offset:1280
    ds_read_b64_tr_b16 v[216:217], v84 offset:2048
    ds_read_b64_tr_b16 v[218:219], v84 offset:2304
    ds_read_b64_tr_b16 v[220:221], v84 offset:18432
    ds_read_b64_tr_b16 v[222:223], v84 offset:18688
    ds_read_b64_tr_b16 v[224:225], v84 offset:34816
    ds_read_b64_tr_b16 v[226:227], v84 offset:35072
    ds_read_b64_tr_b16 v[228:229], v84 offset:51200
    ds_read_b64_tr_b16 v[230:231], v84 offset:51456
    ds_read_b64_tr_b16 v[232:233], v85 offset:2048
    ds_read_b64_tr_b16 v[234:235], v85 offset:2304
    ds_read_b64_tr_b16 v[236:237], v84 offset:3072
    ds_read_b64_tr_b16 v[238:239], v84 offset:3328
    ds_read_b64_tr_b16 v[240:241], v84 offset:19456
    ds_read_b64_tr_b16 v[242:243], v84 offset:19712
    ds_read_b64_tr_b16 v[244:245], v84 offset:35840
    ds_read_b64_tr_b16 v[246:247], v84 offset:36096
    ds_read_b64_tr_b16 v[248:249], v84 offset:52224
    ds_read_b64_tr_b16 v[250:251], v84 offset:52480
    ds_read_b64_tr_b16 v[252:253], v85 offset:3072
    ds_read_b64_tr_b16 v[254:255], v85 offset:3328
    s_waitcnt lgkmcnt(15)
    v_mfma_f32_16x16x32_bf16 v[16:19], v[176:179], v[40:43], 0
    v_mfma_f32_16x16x32_bf16 v[16:19], v[180:183], v[40:43], v[16:19]
    v_mfma_f32_16x16x32_bf16 v[16:19], v[184:187], v[40:43], v[16:19]
    v_mfma_f32_16x16x32_bf16 v[16:19], v[188:191], v[40:43], v[16:19]
    v_mfma_f32_16x16x32_bf16 v[16:19], v[192:195], v[40:43], v[16:19]
    v_mfma_f32_16x16x32_bf16 v[16:19], v[196:199], v[40:43], v[16:19]
    v_mfma_f32_16x16x32_bf16 v[16:19], v[200:203], v[40:43], v[16:19]
    v_mfma_f32_16x16x32_bf16 v[16:19], v[204:207], v[40:43], v[16:19]
    v_mfma_f32_16x16x32_bf16 v[16:19], v[208:211], v[40:43], v[16:19]
    v_mfma_f32_16x16x32_bf16 v[16:19], v[212:215], v[40:43], v[16:19]
    v_mfma_f32_16x16x32_bf16 v[16:19], v[216:219], v[40:43], v[16:19]
    v_mfma_f32_16x16x32_bf16 v[16:19], v[220:223], v[40:43], v[16:19]
    s_waitcnt lgkmcnt(14)
    v_mfma_f32_16x16x32_bf16 v[16:19], v[224:227], v[40:43], v[16:19]
    s_waitcnt lgkmcnt(12)
    v_mfma_f32_16x16x32_bf16 v[16:19], v[228:231], v[40:43], v[16:19]
    s_waitcnt lgkmcnt(10)
    v_mfma_f32_16x16x32_bf16 v[16:19], v[232:235], v[40:43], v[16:19]
    s_waitcnt lgkmcnt(8)
    v_mfma_f32_16x16x32_bf16 v[16:19], v[236:239], v[40:43], v[16:19]
    s_waitcnt lgkmcnt(6)
    v_mfma_f32_16x16x32_bf16 v[16:19], v[240:243], v[40:43], v[16:19]
    s_waitcnt lgkmcnt(4)
    v_mfma_f32_16x16x32_bf16 v[16:19], v[244:247], v[40:43], v[16:19]
    s_waitcnt lgkmcnt(2)
    v_mfma_f32_16x16x32_bf16 v[16:19], v[248:251], v[40:43], v[16:19]
    s_waitcnt lgkmcnt(0)
    v_mfma_f32_16x16x32_bf16 v[16:19], v[252:255], v[40:43], v[16:19]
    s_nop 7
    v_permlane16_swap_b32 v16, v18
    v_permlane16_swap_b32 v17, v19
    s_sub_u32 s70, s95, 102400
    s_lshr_b32 s70, s70, 2
    s_add_u32 s70, s70, 163840
    s_cmp_eq_u32 s52, 0
    s_cselect_b32 s70, s70, 1073741824
    s_mov_b32 s71, 8912896
    s_mov_b32 s69, 466944
    s_mov_b32 s91, 1280
    s_mov_b32 m0, s72
    v_mov_b32 v123, 0x7ff
    v_not_b32_e64 v32, v4
    buffer_store_dword v32, v6, s[36:39], s70 offen sc1
    s_mov_b32 s88, 69632
    s_mov_b32 s89, 77824
    s_mov_b32 s90, 36864
    v_and_b32 v24, 3, v1
    v_and_b32 v25, 4, v1
    v_lshl_add_u32 v24, v25, 2, v24
    v_lshlrev_b32 v24, 7, v24
    s_lshl_b32 s68, s52, 9
    s_add_u32 s68, s68, 159744
    s_waitcnt vmcnt(0) lgkmcnt(0)
    s_mov_b64 vcc, -1
    s_mov_b32 s78, 0
tw_56019:
    s_mov_b64 exec, vcc
    buffer_load_dword v25, v24, s[36:39], s68 offen sc1
    s_add_u32 s78, s78, 1
    s_waitcnt vmcnt(0)
    v_cmp_ne_u32_e64 vcc, s57, v25
    s_cbranch_vccz td_56020
    s_sleep 1
    s_cmp_lt_u32 s78, 2097152
    s_cbranch_scc1 tw_56019
td_56020:
    s_mov_b64 exec, -1
    s_waitcnt vmcnt(0) lgkmcnt(0)
    s_mov_b64 s[76:77], -1
    s_mov_b64 s[74:75], -1
    s_mov_b32 s78, 0
kpa_56021:
    s_or_b64 exec, s[76:77], 1
    buffer_load_dwordx4 v[96:99], v92, s[36:39], s88 offen sc1
    s_or_b64 exec, s[74:75], 1
    buffer_load_dwordx4 v[100:103], v92, s[36:39], s89 offen sc1
    s_mov_b64 exec, -1
    s_add_u32 s78, s78, 1
    s_waitcnt vmcnt(1)
    v_max3_u32 v26, v96, v97, v98
    v_max_u32 v26, v26, v99
    v_cmp_eq_u32 s[76:77], -1, v26
    s_waitcnt vmcnt(0)
    v_max3_u32 v24, v100, v101, v102
    v_max_u32 v24, v24, v103
    v_cmp_eq_u32 s[74:75], -1, v24
    s_cmp_ge_u32 s78, 2097152
    s_cbranch_scc1 kda_56022
    s_or_b64 vcc, s[76:77], s[74:75]
    s_cbranch_scc1 kpa_56021
kda_56022:
    v_max_u32 v26, v26, v24
    ds_max_u32 v13, v26
    buffer_load_dword v104, v93, s[36:39], s90 offen sc1
    s_waitcnt lgkmcnt(0)
    s_barrier
    ds_read_b32 v25, v7
    ds_read_b128 v[144:147], v8 offset:0
    ds_read_b128 v[148:151], v8 offset:16
    ds_read_b128 v[152:155], v8 offset:32
    ds_read_b128 v[156:159], v8 offset:48
    v_max3_u32 v24, v96, v97, v98
    v_med3_u32 v27, v96, v97, v98
    v_min3_u32 v28, v96, v97, v98
    v_med3_u32 v28, v27, v28, v99
    v_med3_u32 v27, v24, v27, v99
    v_max_u32_e64 v24, v24, v99
    v_med3_u32 v28, v27, v28, v100
    v_med3_u32 v27, v24, v27, v100
    v_max_u32_e64 v24, v24, v100
    v_med3_u32 v28, v27, v28, v101
    v_med3_u32 v27, v24, v27, v101
    v_max_u32_e64 v24, v24, v101
    v_med3_u32 v28, v27, v28, v102
    v_med3_u32 v27, v24, v27, v102
    v_max_u32_e64 v24, v24, v102
    v_med3_u32 v28, v27, v28, v103
    v_med3_u32 v27, v24, v27, v103
    s_waitcnt lgkmcnt(3)
    v_cmp_gt_u32 s[76:77], v144, v25
    v_cmp_gt_u32 s[74:75], v145, v25
    v_cmp_gt_u32 s[100:101], v146, v25
    v_cmp_gt_u32 vcc, v147, v25
    v_addc_co_u32 v24, s[76:77], 0, 0, s[76:77]
    v_addc_co_u32 v24, s[74:75], 0, v24, s[74:75]
    v_addc_co_u32 v24, s[100:101], 0, v24, s[100:101]
    v_addc_co_u32 v24, vcc, 0, v24, vcc
    v_ashrrev_i32 v32, 31, v25
    v_bitop3_b32 v32, v32, v91, v25 bitop3:0x65
    v_sub_f32 v32, v32, v94
    v_ashrrev_i32_e64 v33, 31, v32
    s_waitcnt lgkmcnt(2)
    v_cmp_gt_u32 s[76:77], v148, v25
    v_cmp_gt_u32 s[74:75], v149, v25
    v_cmp_gt_u32 s[100:101], v150, v25
    v_cmp_gt_u32_e64 vcc, v151, v25
    v_addc_co_u32 v24, s[76:77], 0, v24, s[76:77]
    v_addc_co_u32 v24, s[74:75], 0, v24, s[74:75]
    v_addc_co_u32 v24, s[100:101], 0, v24, s[100:101]
    v_addc_co_u32 v24, vcc, 0, v24, vcc
    s_waitcnt lgkmcnt(1)
    v_cmp_gt_u32 s[76:77], v152, v25
    v_cmp_gt_u32 s[74:75], v153, v25
    v_cmp_gt_u32 s[100:101], v154, v25
    v_cmp_gt_u32_e64 vcc, v155, v25
    v_addc_co_u32 v24, s[76:77], 0, v24, s[76:77]
    v_addc_co_u32 v24, s[74:75], 0, v24, s[74:75]
    v_addc_co_u32 v24, s[100:101], 0, v24, s[100:101]
    v_addc_co_u32 v24, vcc, 0, v24, vcc
    s_waitcnt lgkmcnt(0)
    v_cmp_gt_u32 s[76:77], v156, v25
    v_cmp_gt_u32 s[74:75], v157, v25
    v_cmp_gt_u32 s[100:101], v158, v25
    v_cmp_gt_u32_e64 vcc, v159, v25
    v_addc_co_u32 v24, s[76:77], 0, v24, s[76:77]
    v_addc_co_u32 v24, s[74:75], 0, v24, s[74:75]
    v_addc_co_u32 v24, s[100:101], 0, v24, s[100:101]
    v_addc_co_u32_e64 v24, vcc, 0, v24, vcc
    v_bitop3_b32 v32, v33, v91, v32 bitop3:0x56
    v_med3_u32 v32, v32, 1, v25
    v_add_u32_dpp v24, v24, v24 quad_perm:[1,0,3,2] row_mask:0xf bank_mask:0xf
    v_cmp_eq_u32 vcc, 7, v24
    s_ff1_i32_b64 s68, vcc
    v_readlane_b32 s99, v32, s68
    s_nop 1
    v_cmp_le_u32 s[74:75], s99, v27
    v_cmp_le_u32 vcc, s99, v26
    v_cmp_le_u32 s[76:77], s99, v28
    v_addc_co_u32 v33, s[100:101], 0, v15, s[74:75]
    s_mov_b64 exec, vcc
    ds_add_rtn_u32 v24, v11, v33 offset:224
    s_waitcnt lgkmcnt(0)
    v_min_u32_e64 v24, 16, v24
    v_lshl_add_u32 v24, v24, 2, v11
    ds_write_b32 v24, v26 offset:128
    s_mov_b64 exec, s[74:75]
    ds_write_b32 v24, v27 offset:132
    s_mov_b64 exec, -1
    s_cmp_lg_u64 s[76:77], 0
    s_cbranch_scc1 morea_56023
backa_56024:
    s_waitcnt vmcnt(0)
    v_cmp_ne_u32_e64 vcc, s57, v104
    s_cbranch_vccnz spin_fha_58025
ok_fha_58026:
    s_waitcnt lgkmcnt(0)
    s_barrier
    ds_read_b32 v25, v117 offset:128
    ds_read_b32 v32, v11 offset:224
    s_waitcnt lgkmcnt(1)
    s_nop 0
    v_bfi_b32 v38, v25, 0, v123
    v_cmp_ne_u32 s[74:75], 0, v25
    v_mad_u32_u24 v36, v38, s91, v86
    v_lshl_add_u32 v34, v38, 7, v119
    v_cndmask_b32 v36, v122, v36, s[74:75]
    s_waitcnt lgkmcnt(0)
    v_cmp_lt_u32_e64 vcc, 16, v32
    s_cbranch_vccnz slowa_60027
back2a_60028:
    buffer_load_dwordx4 v[28:31], v34, s[36:39], s69 offen sc1
    buffer_load_dwordx4 v36, s[36:39], s71 offen offset:0 sc1 lds
    s_add_u32 m0, m0, 768
    s_nop 0
    buffer_load_dwordx4 v36, s[36:39], s71 offen offset:256 sc1 lds
    s_add_u32 m0, m0, 768
    s_nop 0
    buffer_load_dwordx4 v36, s[36:39], s71 offen offset:512 sc1 lds
    s_add_u32 m0, m0, 768
    s_nop 0
    buffer_load_dwordx4 v36, s[36:39], s71 offen offset:768 sc1 lds
    s_add_u32 m0, m0, 768
    s_nop 0
    buffer_load_dwordx4 v36, s[36:39], s71 offen offset:1024 sc1 lds
    s_waitcnt vmcnt(5)
    v_cmp_ne_u32 vcc, s57, v31
    s_cbranch_vccnz spin_ms1_62029
ok_ms1_62030:
    v_mul_f32 v30, v30, v121
    v_and_b32 v33, v123, v25
    s_nop 0
    v_add_f32_dpp v30, v30, v30 quad_perm:[1,0,3,2] row_mask:0xf bank_mask:0xf
    ds_write_b64 v118, v[28:29] offset:256
    s_nop 0
    v_add_f32_dpp v30, v30, v30 quad_perm:[2,3,0,1] row_mask:0xf bank_mask:0xf
    s_nop 1
    v_add_f32_dpp v30, v30, v30 row_half_mirror row_mask:0xf bank_mask:0xf
    s_nop 1
    v_mov_b32_dpp v30, v30 row_newbcast:0 row_mask:0xf bank_mask:0xf
    v_ashrrev_i32 v32, 31, v30
    v_bitop3_b32 v32, v32, v91, v30 bitop3:0x56
    v_max_u32 v32, 0x800, v32
    v_bfi_b32 v32, v123, v33, v32
    v_cndmask_b32 v32, 0, v32, s[74:75]
    ds_write_b32 v117, v32
    s_waitcnt vmcnt(0)
    s_waitcnt lgkmcnt(0)
    buffer_store_dword v4, v6, s[36:39], s70 offen sc1
    s_barrier
    s_nop 0
    ds_read_b128 v[128:131], v112 offset:0
    ds_read_b128 v[132:135], v113 offset:0
    ds_read_b128 v[136:139], v114 offset:0
    ds_read_b128 v[140:143], v115 offset:0
    ds_read_b128 v[144:147], v112 offset:1024
    ds_read_b128 v[148:151], v113 offset:1024
    ds_read_b32 v24, v89
    ds_read_b128 v[28:31], v90
    ds_read_b64 v[20:21], v120 offset:256
    s_waitcnt lgkmcnt(8)
    v_mfma_f32_16x16x32_bf16 v[64:67], v[176:179], v[128:131], 0
    ds_read_b128 v[152:155], v114 offset:1024
    ds_read_b128 v[156:159], v115 offset:1024
    s_waitcnt lgkmcnt(9)
    v_mfma_f32_16x16x32_bf16 v[64:67], v[180:183], v[132:135], v[64:67]
    ds_read_b128 v[160:163], v112 offset:2048
    ds_read_b128 v[164:167], v113 offset:2048
    s_waitcnt lgkmcnt(10)
    v_mfma_f32_16x16x32_bf16 v[64:67], v[184:187], v[136:139], v[64:67]
    ds_read_b128 v[168:171], v114 offset:2048
    ds_read_b128 v[172:175], v115 offset:2048
    s_waitcnt lgkmcnt(11)
    v_mfma_f32_16x16x32_bf16 v[64:67], v[188:191], v[140:143], v[64:67]
    ds_read_b128 v[128:131], v112 offset:3072
    ds_read_b128 v[132:135], v113 offset:3072
    s_waitcnt lgkmcnt(12)
    v_mfma_f32_16x16x32_bf16 v[64:67], v[192:195], v[144:147], v[64:67]
    ds_read_b128 v[136:139], v114 offset:3072
    ds_read_b128 v[140:143], v115 offset:3072
    s_waitcnt lgkmcnt(13)
    v_mfma_f32_16x16x32_bf16 v[64:67], v[196:199], v[148:151], v[64:67]
    ds_read_b128 v[144:147], v112 offset:4096
    ds_read_b128 v[148:151], v113 offset:4096
    s_waitcnt lgkmcnt(11)
    v_mfma_f32_16x16x32_bf16 v[64:67], v[200:203], v[152:155], v[64:67]
    ds_read_b128 v[152:155], v114 offset:4096
    s_waitcnt lgkmcnt(11)
    v_mfma_f32_16x16x32_bf16 v[64:67], v[204:207], v[156:159], v[64:67]
    ds_read_b128 v[156:159], v115 offset:4096
    s_waitcnt lgkmcnt(11)
    v_mfma_f32_16x16x32_bf16 v[64:67], v[208:211], v[160:163], v[64:67]
    v_cmp_gt_u32 s[76:77], v28, v24
    s_waitcnt lgkmcnt(10)
    v_mfma_f32_16x16x32_bf16 v[64:67], v[212:215], v[164:167], v[64:67]
    v_cmp_gt_u32 s[74:75], v29, v24
    s_waitcnt lgkmcnt(9)
    v_mfma_f32_16x16x32_bf16 v[64:67], v[216:219], v[168:171], v[64:67]
    v_cmp_gt_u32 s[100:101], v30, v24
    s_waitcnt lgkmcnt(8)
    v_mfma_f32_16x16x32_bf16 v[64:67], v[220:223], v[172:175], v[64:67]
    v_cmp_gt_u32 vcc, v31, v24
    s_waitcnt lgkmcnt(7)
    v_mfma_f32_16x16x32_bf16 v[64:67], v[224:227], v[128:131], v[64:67]
    v_addc_co_u32 v33, s[76:77], 0, 0, s[76:77]
    s_waitcnt lgkmcnt(6)
    v_mfma_f32_16x16x32_bf16 v[64:67], v[228:231], v[132:135], v[64:67]
    v_addc_co_u32 v33, s[74:75], 0, v33, s[74:75]
    s_waitcnt lgkmcnt(5)
    v_mfma_f32_16x16x32_bf16 v[64:67], v[232:235], v[136:139], v[64:67]
    v_addc_co_u32 v33, s[100:101], 0, v33, s[100:101]
    s_waitcnt lgkmcnt(4)
    v_mfma_f32_16x16x32_bf16 v[64:67], v[236:239], v[140:143], v[64:67]
    v_addc_co_u32 v33, vcc, 0, v33, vcc
    v_mov_b32 v32, v33
    s_waitcnt lgkmcnt(3)
    v_mfma_f32_16x16x32_bf16 v[64:67], v[240:243], v[144:147], v[64:67]
    v_permlane16_swap_b32 v32, v33
    v_add_u32_e64 v33, v33, v32
    s_waitcnt lgkmcnt(2)
    v_mfma_f32_16x16x32_bf16 v[64:67], v[244:247], v[148:151], v[64:67]
    v_mov_b32 v32, v33
    s_nop 1
    v_permlane32_swap_b32 v32, v33
    s_waitcnt lgkmcnt(1)
    v_mfma_f32_16x16x32_bf16 v[64:67], v[248:251], v[152:155], v[64:67]
    v_add_u32 v33, v33, v32
    v_cmp_gt_u32_e64 vcc, 8, v33
    s_waitcnt lgkmcnt(0)
    v_mfma_f32_16x16x32_bf16 v[64:67], v[252:255], v[156:159], v[64:67]
    v_lshl_add_u32 v88, v33, 4, v88
    v_cndmask_b32 v88, v122, v88, vcc
    s_nop 5
    v_permlane16_swap_b32 v64, v66
    v_permlane16_swap_b32 v65, v67
    v_pk_fma_f32 v[64:65], v[16:17], v[20:21], v[64:65] op_sel_hi:[1,0,1] neg_lo:[1,0,0] neg_hi:[1,0,0]
    v_pk_fma_f32 v[66:67], v[18:19], v[20:21], v[66:67] op_sel_hi:[1,0,1] neg_lo:[1,0,0] neg_hi:[1,0,0]
    v_pk_mul_f32 v[64:65], v[64:65], v[20:21] op_sel:[0,1] op_sel_hi:[1,1]
    v_pk_mul_f32 v[66:67], v[66:67], v[20:21] op_sel:[0,1] op_sel_hi:[1,1]
    v_pk_mul_f32 v[38:39], v[64:65], s[92:93] neg_lo:[1,0] neg_hi:[1,0]
    v_exp_f32 v38, v38
    v_exp_f32 v39, v39
    v_pk_mul_f32 v[64:65], v[64:65], v[66:67]
    v_add_f32 v38, 1.0, v38
    v_add_f32 v39, 1.0, v39
    v_rcp_f32 v38, v38
    v_rcp_f32_e64 v39, v39
    s_nop 0
    v_pk_mul_f32 v[64:65], v[64:65], v[38:39]
    v_cvt_pk_bf16_f32 v64, v64, v65
    buffer_store_dword v64, v88, s[36:39], s95 offen sc1
    s_branch L_fin
L_ffn2:
    s_cmp_ge_u32 s12, 248
    s_cbranch_scc1 L_fin
    s_add_u32 s70, s73, 65536
    s_mul_i32 s68, s94, 4096
    s_add_u32 s68, s68, s70
    s_add_u32 m0, s68, 0
    s_nop 0
    buffer_load_dwordx4 v28, s[40:43], s81 offen lds
    s_add_u32 s81, s81, s101
    s_cmp_eq_u32 s81, 491520
    s_cselect_b32 s81, 0, s81
    s_add_u32 s94, s94, 1
    s_cmp_eq_u32 s94, 12
    s_cselect_b32 s94, 0, s94
    s_mul_i32 s68, s94, 4096
    s_add_u32 s68, s68, s70
    s_add_u32 m0, s68, 0
    s_nop 0
    buffer_load_dwordx4 v28, s[40:43], s81 offen lds
    s_add_u32 s81, s81, s101
    s_cmp_eq_u32 s81, 491520
    s_cselect_b32 s81, 0, s81
    s_add_u32 s94, s94, 1
    s_cmp_eq_u32 s94, 12
    s_cselect_b32 s94, 0, s94
    s_mul_i32 s68, s94, 4096
    s_add_u32 s68, s68, s70
    s_add_u32 m0, s68, 0
    s_nop 0
    buffer_load_dwordx4 v28, s[40:43], s81 offen lds
    s_add_u32 s81, s81, s101
    s_cmp_eq_u32 s81, 491520
    s_cselect_b32 s81, 0, s81
    s_add_u32 s94, s94, 1
    s_cmp_eq_u32 s94, 12
    s_cselect_b32 s94, 0, s94
    s_mul_i32 s68, s94, 4096
    s_add_u32 s68, s68, s70
    s_add_u32 m0, s68, 0
    s_nop 0
    buffer_load_dwordx4 v28, s[40:43], s81 offen lds
    s_add_u32 s81, s81, s101
    s_cmp_eq_u32 s81, 491520
    s_cselect_b32 s81, 0, s81
    s_add_u32 s94, s94, 1
    s_cmp_eq_u32 s94, 12
    s_cselect_b32 s94, 0, s94
    s_mul_i32 s68, s94, 4096
    s_add_u32 s68, s68, s70
    s_add_u32 m0, s68, 0
    s_nop 0
    buffer_load_dwordx4 v28, s[40:43], s81 offen lds
    s_add_u32 s81, s81, s101
    s_cmp_eq_u32 s81, 491520
    s_cselect_b32 s81, 0, s81
    s_add_u32 s94, s94, 1
    s_cmp_eq_u32 s94, 12
    s_cselect_b32 s94, 0, s94
    s_mul_i32 s68, s94, 4096
    s_add_u32 s68, s68, s70
    s_add_u32 m0, s68, 0
    s_nop 0
    buffer_load_dwordx4 v28, s[40:43], s81 offen lds
    s_add_u32 s81, s81, s101
    s_cmp_eq_u32 s81, 491520
    s_cselect_b32 s81, 0, s81
    s_add_u32 s94, s94, 1
    s_cmp_eq_u32 s94, 12
    s_cselect_b32 s94, 0, s94
    s_mul_i32 s68, s94, 4096
    s_add_u32 s68, s68, s70
    s_add_u32 m0, s68, 0
    s_nop 0
    buffer_load_dwordx4 v28, s[40:43], s81 offen lds
    s_add_u32 s81, s81, s101
    s_cmp_eq_u32 s81, 491520
    s_cselect_b32 s81, 0, s81
    s_add_u32 s94, s94, 1
    s_cmp_eq_u32 s94, 12
    s_cselect_b32 s94, 0, s94
    s_mul_i32 s68, s94, 4096
    s_add_u32 s68, s68, s70
    s_add_u32 m0, s68, 0
    s_nop 0
    buffer_load_dwordx4 v28, s[40:43], s81 offen lds
    s_add_u32 s81, s81, s101
    s_cmp_eq_u32 s81, 491520
    s_cselect_b32 s81, 0, s81
    s_add_u32 s94, s94, 1
    s_cmp_eq_u32 s94, 12
    s_cselect_b32 s94, 0, s94
    s_mul_i32 s68, s94, 4096
    s_add_u32 s68, s68, s70
    s_add_u32 m0, s68, 0
    s_nop 0
    buffer_load_dwordx4 v28, s[40:43], s81 offen lds
    s_add_u32 s81, s81, s101
    s_cmp_eq_u32 s81, 491520
    s_cselect_b32 s81, 0, s81
    s_add_u32 s94, s94, 1
    s_cmp_eq_u32 s94, 12
    s_cselect_b32 s94, 0, s94
    s_mul_i32 s68, s94, 4096
    s_add_u32 s68, s68, s70
    s_add_u32 m0, s68, 0
    s_nop 0
    buffer_load_dwordx4 v28, s[40:43], s81 offen lds
    s_add_u32 s81, s81, s101
    s_cmp_eq_u32 s81, 491520
    s_cselect_b32 s81, 0, s81
    s_add_u32 s94, s94, 1
    s_cmp_eq_u32 s94, 12
    s_cselect_b32 s94, 0, s94
    s_mul_i32 s68, s94, 4096
    s_add_u32 s68, s68, s70
    s_add_u32 m0, s68, 0
    s_nop 0
    buffer_load_dwordx4 v28, s[40:43], s81 offen lds
    s_add_u32 s81, s81, s101
    s_cmp_eq_u32 s81, 491520
    s_cselect_b32 s81, 0, s81
    s_add_u32 s94, s94, 1
    s_cmp_eq_u32 s94, 12
    s_cselect_b32 s94, 0, s94
    s_mul_i32 s68, s94, 4096
    s_add_u32 s68, s68, s70
    s_add_u32 m0, s68, 0
    s_nop 0
    buffer_load_dwordx4 v28, s[40:43], s81 offen lds
    s_add_u32 s81, s81, s101
    s_cmp_eq_u32 s81, 491520
    s_cselect_b32 s81, 0, s81
    s_add_u32 s94, s94, 1
    s_cmp_eq_u32 s94, 12
    s_cselect_b32 s94, 0, s94
    s_mov_b32 s48, s22
    s_nop 0
    s_and_b32 s49, s23, 0xffff
    s_mov_b32 s50, 2621440
    s_mov_b32 s51, 0x20000
    v_dot2_f32_bf16 v94, v76, v76, 0
    v_dot2_f32_bf16 v94, v77, v77, v94
    v_dot2_f32_bf16 v94, v78, v78, v94
    v_dot2_f32_bf16 v94, v79, v79, v94
    v_dot2_f32_bf16 v94, v80, v80, v94
    v_dot2_f32_bf16 v94, v81, v81, v94
    v_dot2_f32_bf16 v94, v82, v82, v94
    v_dot2_f32_bf16 v94, v83, v83, v94
    s_nop 2
    v_add_f32_dpp v94, v94, v94 row_ror:1 row_mask:0xf bank_mask:0xf
    s_nop 1
    v_add_f32_dpp v94, v94, v94 row_ror:2 row_mask:0xf bank_mask:0xf
    s_nop 1
    v_add_f32_dpp v94, v94, v94 row_ror:4 row_mask:0xf bank_mask:0xf
    s_nop 1
    v_add_f32_dpp v94, v94, v94 row_ror:8 row_mask:0xf bank_mask:0xf
    v_mov_b32 v95, v94
    s_nop 1
    v_permlane16_swap_b32 v95, v94
    v_add_f32 v94, v94, v95
    v_mov_b32 v95, v94
    s_nop 1
    v_permlane32_swap_b32 v95, v94
    v_add_f32 v94, v94, v95
    v_sqrt_f32 v94, v94
    s_nop 0
    v_mul_f32 v94, 0x3c800000, v94
    v_mov_b32 v11, 32768
    v_lshl_add_u32 v13, v1, 2, v11
    v_mov_b32_e64 v14, 0
    ds_write_b32 v13, v14
    v_and_b32 v12, 0x30, v2
    v_lshrrev_b32 v92, 2, v0
    v_lshl_add_u32 v92, v92, 7, v12
    v_and_b32 v93, 7, v0
    v_min_u32 v93, 4, v93
    v_lshrrev_b32 v15, 3, v0
    v_lshlrev_b32 v15, 7, v15
    v_lshl_add_u32 v93, v93, 2, v15
    v_add_u32 v12, v11, v12
    v_and_b32 v14, 0x3c, v1
    v_add_u32 v14, v11, v14
    v_add_u32 v13, v6, v11
    v_lshrrev_b32_e64 v7, 1, v1
    v_lshl_add_u32 v7, v7, 2, v11
    v_and_b32_e64 v8, 1, v1
    v_lshl_add_u32 v8, v8, 6, v11
    v_mov_b32 v15, 1
    v_bfrev_b32 v91, 1
    v_lshrrev_b32_e64 v36, 4, v1
    v_bfe_u32 v38, v1, 2, 2
    v_lshl_add_u32 v38, v36, 3, v38
    v_lshl_add_u32 v38, v38, 5, s73
    v_and_b32_e64 v37, 3, v1
    v_lshl_add_u32 v84, v37, 3, v38
    v_add_u32 v84, 65536, v84
    v_and_b32 v37, 0x70, v2
    v_lshl_add_u32 v85, v36, 7, v37
    v_and_b32_e64 v38, 8, v1
    v_lshl_add_u32 v85, v38, 6, v85
    v_min_u32 v46, 11, v1
    v_lshlrev_b32 v46, 7, v46
    v_lshl_add_u32 v86, v36, 3, s97
    v_add_u32 v88, 0, v2
    v_add_u32 v87, s73, v88
    v_add_u32 v89, v37, v11
    s_waitcnt vmcnt(0)
    ds_read_b64_tr_b16 v[176:177], v84 offset:0
    ds_read_b64_tr_b16 v[178:179], v84 offset:128
    ds_read_b64_tr_b16 v[180:181], v84 offset:4096
    ds_read_b64_tr_b16 v[182:183], v84 offset:4224
    ds_read_b64_tr_b16 v[184:185], v84 offset:8192
    ds_read_b64_tr_b16 v[186:187], v84 offset:8320
    ds_read_b64_tr_b16 v[188:189], v84 offset:12288
    ds_read_b64_tr_b16 v[190:191], v84 offset:12416
    ds_read_b64_tr_b16 v[192:193], v84 offset:16384
    ds_read_b64_tr_b16 v[194:195], v84 offset:16512
    ds_read_b64_tr_b16 v[196:197], v84 offset:20480
    ds_read_b64_tr_b16 v[198:199], v84 offset:20608
    ds_read_b64_tr_b16 v[200:201], v84 offset:24576
    ds_read_b64_tr_b16 v[202:203], v84 offset:24704
    ds_read_b64_tr_b16 v[204:205], v84 offset:28672
    ds_read_b64_tr_b16 v[206:207], v84 offset:28800
    ds_read_b64_tr_b16 v[208:209], v84 offset:32768
    ds_read_b64_tr_b16 v[210:211], v84 offset:32896
    ds_read_b64_tr_b16 v[212:213], v84 offset:36864
    ds_read_b64_tr_b16 v[214:215], v84 offset:36992
    ds_read_b64_tr_b16 v[216:217], v84 offset:40960
    ds_read_b64_tr_b16 v[218:219], v84 offset:41088
    ds_read_b64_tr_b16 v[220:221], v84 offset:45056
    ds_read_b64_tr_b16 v[222:223], v84 offset:45184
    s_waitcnt lgkmcnt(0)
    s_barrier
    s_mov_b32 s88, 69632
    s_mov_b32 s89, 77824
    s_mov_b32 s90, 36864
    v_and_b32 v24, 3, v1
    v_and_b32 v25, 4, v1
    v_lshl_add_u32 v24, v25, 2, v24
    v_lshlrev_b32 v24, 7, v24
    s_lshl_b32 s68, s52, 9
    s_add_u32 s68, s68, 159744
    s_waitcnt vmcnt(0) lgkmcnt(0)
    s_mov_b64 vcc, -1
    s_mov_b32 s78, 0
tw_66031:
    s_mov_b64 exec, vcc
    buffer_load_dword v25, v24, s[36:39], s68 offen sc1
    s_add_u32 s78, s78, 1
    s_waitcnt vmcnt(0)
    v_cmp_ne_u32_e64 vcc, s57, v25
    s_cbranch_vccz td_66032
    s_sleep 1
    s_cmp_lt_u32 s78, 2097152
    s_cbranch_scc1 tw_66031
td_66032:
    s_mov_b64 exec, -1
    s_waitcnt vmcnt(0) lgkmcnt(0)
    s_mov_b64 s[76:77], -1
    s_mov_b64 s[74:75], -1
    s_mov_b32 s78, 0
kpb_66033:
    s_or_b64 exec, s[76:77], 1
    buffer_load_dwordx4 v[96:99], v92, s[36:39], s88 offen sc1
    s_or_b64 exec, s[74:75], 1
    buffer_load_dwordx4 v[100:103], v92, s[36:39], s89 offen sc1
    s_mov_b64 exec, -1
    s_add_u32 s78, s78, 1
    s_waitcnt vmcnt(1)
    v_max3_u32 v26, v96, v97, v98
    v_max_u32 v26, v26, v99
    v_cmp_eq_u32 s[76:77], -1, v26
    s_waitcnt vmcnt(0)
    v_max3_u32 v24, v100, v101, v102
    v_max_u32 v24, v24, v103
    v_cmp_eq_u32 s[74:75], -1, v24
    s_cmp_ge_u32 s78, 2097152
    s_cbranch_scc1 kdb_66034
    s_or_b64 vcc, s[76:77], s[74:75]
    s_cbranch_scc1 kpb_66033
kdb_66034:
    v_max_u32 v26, v26, v24
    ds_max_u32 v13, v26
    buffer_load_dword v104, v93, s[36:39], s90 offen sc1
    s_waitcnt lgkmcnt(0)
    s_barrier
    ds_read_b32 v25, v7
    ds_read_b128 v[144:147], v8 offset:0
    ds_read_b128 v[148:151], v8 offset:16
    ds_read_b128 v[152:155], v8 offset:32
    ds_read_b128 v[156:159], v8 offset:48
    v_max3_u32 v24, v96, v97, v98
    v_med3_u32 v27, v96, v97, v98
    v_min3_u32 v28, v96, v97, v98
    v_med3_u32 v28, v27, v28, v99
    v_med3_u32 v27, v24, v27, v99
    v_max_u32_e64 v24, v24, v99
    v_med3_u32 v28, v27, v28, v100
    v_med3_u32 v27, v24, v27, v100
    v_max_u32_e64 v24, v24, v100
    v_med3_u32 v28, v27, v28, v101
    v_med3_u32 v27, v24, v27, v101
    v_max_u32_e64 v24, v24, v101
    v_med3_u32 v28, v27, v28, v102
    v_med3_u32 v27, v24, v27, v102
    v_max_u32_e64 v24, v24, v102
    v_med3_u32 v28, v27, v28, v103
    v_med3_u32 v27, v24, v27, v103
    s_waitcnt lgkmcnt(3)
    v_cmp_gt_u32 s[76:77], v144, v25
    v_cmp_gt_u32 s[74:75], v145, v25
    v_cmp_gt_u32 s[100:101], v146, v25
    v_cmp_gt_u32 vcc, v147, v25
    v_addc_co_u32 v24, s[76:77], 0, 0, s[76:77]
    v_addc_co_u32 v24, s[74:75], 0, v24, s[74:75]
    v_addc_co_u32 v24, s[100:101], 0, v24, s[100:101]
    v_addc_co_u32 v24, vcc, 0, v24, vcc
    v_ashrrev_i32 v32, 31, v25
    v_bitop3_b32 v32, v32, v91, v25 bitop3:0x65
    v_sub_f32 v32, v32, v94
    v_ashrrev_i32_e64 v33, 31, v32
    s_waitcnt lgkmcnt(2)
    v_cmp_gt_u32 s[76:77], v148, v25
    v_cmp_gt_u32 s[74:75], v149, v25
    v_cmp_gt_u32 s[100:101], v150, v25
    v_cmp_gt_u32_e64 vcc, v151, v25
    v_addc_co_u32 v24, s[76:77], 0, v24, s[76:77]
    v_addc_co_u32 v24, s[74:75], 0, v24, s[74:75]
    v_addc_co_u32 v24, s[100:101], 0, v24, s[100:101]
    v_addc_co_u32 v24, vcc, 0, v24, vcc
    s_waitcnt lgkmcnt(1)
    v_cmp_gt_u32 s[76:77], v152, v25
    v_cmp_gt_u32 s[74:75], v153, v25
    v_cmp_gt_u32 s[100:101], v154, v25
    v_cmp_gt_u32_e64 vcc, v155, v25
    v_addc_co_u32 v24, s[76:77], 0, v24, s[76:77]
    v_addc_co_u32 v24, s[74:75], 0, v24, s[74:75]
    v_addc_co_u32 v24, s[100:101], 0, v24, s[100:101]
    v_addc_co_u32 v24, vcc, 0, v24, vcc
    s_waitcnt lgkmcnt(0)
    v_cmp_gt_u32 s[76:77], v156, v25
    v_cmp_gt_u32 s[74:75], v157, v25
    v_cmp_gt_u32 s[100:101], v158, v25
    v_cmp_gt_u32_e64 vcc, v159, v25
    v_addc_co_u32 v24, s[76:77], 0, v24, s[76:77]
    v_addc_co_u32 v24, s[74:75], 0, v24, s[74:75]
    v_addc_co_u32 v24, s[100:101], 0, v24, s[100:101]
    v_addc_co_u32_e64 v24, vcc, 0, v24, vcc
    v_bitop3_b32 v32, v33, v91, v32 bitop3:0x56
    v_med3_u32 v32, v32, 1, v25
    v_add_u32_dpp v24, v24, v24 quad_perm:[1,0,3,2] row_mask:0xf bank_mask:0xf
    v_cmp_eq_u32 vcc, 7, v24
    s_ff1_i32_b64 s68, vcc
    v_readlane_b32 s99, v32, s68
    s_nop 1
    v_cmp_le_u32 s[74:75], s99, v27
    v_cmp_le_u32 vcc, s99, v26
    v_cmp_le_u32 s[76:77], s99, v28
    v_addc_co_u32 v33, s[100:101], 0, v15, s[74:75]
    s_mov_b64 exec, vcc
    ds_add_rtn_u32 v24, v11, v33 offset:224
    s_waitcnt lgkmcnt(0)
    v_min_u32_e64 v24, 16, v24
    v_lshl_add_u32 v24, v24, 2, v11
    ds_write_b32 v24, v26 offset:128
    s_mov_b64 exec, s[74:75]
    ds_write_b32 v24, v27 offset:132
    s_mov_b64 exec, -1
    s_cmp_lg_u64 s[76:77], 0
    s_cbranch_scc1 moreb_66035
backb_66036:
    s_waitcnt vmcnt(0)
    v_cmp_ne_u32_e64 vcc, s57, v104
    s_cbranch_vccnz spin_fhb_68037
ok_fhb_68038:
    s_waitcnt lgkmcnt(0)
    s_barrier
    ds_read_b32 v25, v14 offset:128
    ds_read_b32 v32, v11 offset:224
    s_waitcnt lgkmcnt(0)
    v_cmp_lt_u32_e64 vcc, 16, v32
    s_cbranch_vccnz slowb_70039
back2b_70040:
    v_and_b32 v38, 0x7ff, v25
    v_sub_u32 v38, 0x7ff, v38
    v_lshlrev_b32 v34, 7, v38
    v_and_b32 v35, 0x30, v2
    v_add_u32_e64 v35, v34, v35
    s_mov_b32 s69, 466944
    buffer_load_dwordx4 v[28:31], v35, s[36:39], s69 offen sc1
    buffer_load_dwordx4 v[20:23], v34, s[36:39], s69 offen offset:64 sc1
    s_mul_i32 s88, s52, 6144
    s_add_u32 s88, s88, 102400
    s_add_u32 s89, s88, 4096
    s_mul_i32 s90, s52, 1536
    s_add_u32 s90, s90, 163840
    s_waitcnt vmcnt(1)
    v_cmp_ne_u32_e64 vcc, s57, v31
    s_waitcnt vmcnt(0)
    v_cmp_ne_u32 s[76:77], s57, v23
    s_or_b64 vcc, vcc, s[76:77]
    s_cbranch_vccnz spin_ms2_72041
ok_ms2_72042:
    v_add_f32_dpp v30, v30, v30 quad_perm:[1,0,3,2] row_mask:0xf bank_mask:0xf
    v_and_b32 v29, 0x7ff, v25
    v_cmp_ne_u32_e64 vcc, 0, v25
    v_add_f32_dpp v30, v30, v30 quad_perm:[2,3,0,1] row_mask:0xf bank_mask:0xf
    v_add_f32 v22, v22, v30
    v_ashrrev_i32 v28, 31, v22
    v_or_b32 v28, 0x80000000, v28
    v_xor_b32_e64 v28, v28, v22
    v_max_u32 v28, 0x800, v28
    v_and_b32 v28, 0xfffff800, v28
    v_or_b32 v28, v28, v29
    v_cndmask_b32 v24, 0, v28, vcc
    ds_write_b32 v14, v24
    ds_read_b128 v[28:31], v12
    s_waitcnt lgkmcnt(0)
    v_cmp_gt_u32 s[76:77], v28, v24
    v_cmp_gt_u32 s[74:75], v29, v24
    v_cmp_gt_u32 s[100:101], v30, v24
    v_cmp_gt_u32 vcc, v31, v24
    v_addc_co_u32 v33, s[76:77], 0, 0, s[76:77]
    v_addc_co_u32 v33, s[74:75], 0, v33, s[74:75]
    v_addc_co_u32 v33, s[100:101], 0, v33, s[100:101]
    v_addc_co_u32 v33, vcc, 0, v33, vcc
    s_nop 1
    v_add_u32_dpp v33, v33, v33 quad_perm:[1,0,3,2] row_mask:0xf bank_mask:0xf
    s_nop 1
    v_add_u32_dpp v33, v33, v33 quad_perm:[2,3,0,1] row_mask:0xf bank_mask:0xf
    v_mov_b32 v23, v38
    v_min_u32_e64 v33, 15, v33
    v_lshl_add_u32 v33, v33, 4, v11
    ds_write_b128 v33, v[20:23] offset:256
    ds_read_b128 v[20:23], v89 offset:256
    s_waitcnt lgkmcnt(0)
    v_lshrrev_b32 v39, 6, v23
    v_mul_u32_u24 v39, 2560, v39
    v_bfe_u32 v36, v23, 4, 2
    v_lshl_add_u32 v39, v36, 7, v39
    v_mul_u32_u24 v36, 1280, v23
    v_add_u32_e64 v86, v36, v86
    s_mov_b32 s68, 8912896
    s_lshr_b32 s70, s96, 3
    s_lshl_b32 s70, s70, 9
    s_add_u32 s70, s70, 1179648
    buffer_load_dwordx2 v[18:19], v86, s[36:39], s68 offen sc1
    buffer_load_dword v17, v39, s[36:39], s70 offen sc1
    s_mov_b64 vcc, -1
    s_mov_b32 s78, 0
tw_74043:
    s_mov_b64 exec, vcc
    buffer_load_dword v47, v46, s[36:39], s90 offen sc1
    s_add_u32 s78, s78, 1
    s_waitcnt vmcnt(0)
    v_cmp_ne_u32_e64 vcc, s57, v47
    s_cbranch_vccz td_74044
    s_cmp_lt_u32 s78, 2097152
    s_cbranch_scc1 tw_74043
td_74044:
    s_mov_b64 exec, -1
    buffer_load_dwordx4 v[128:131], v85, s[36:39], s88 offen offset:0 sc1
    buffer_load_dwordx4 v[132:135], v85, s[36:39], s88 offen offset:1024 sc1
    buffer_load_dwordx4 v[136:139], v85, s[36:39], s88 offen offset:2048 sc1
    buffer_load_dwordx4 v[140:143], v85, s[36:39], s88 offen offset:3072 sc1
    buffer_load_dwordx4 v[144:147], v85, s[36:39], s89 offen offset:0 sc1
    buffer_load_dwordx4 v[148:151], v85, s[36:39], s89 offen offset:1024 sc1
    v_cmp_ne_u32 vcc, s57, v17
    s_cbranch_vccnz spin_f4_74045
ok_f4_74046:
    v_lshlrev_b32 v40, 16, v18
    v_and_b32 v41, s79, v18
    v_lshlrev_b32 v42, 16, v19
    v_and_b32 v43, s79, v19
    v_add_f32 v36, 1.0, v21
    v_mul_f32 v38, v20, v21
    v_mul_f32_e64 v44, s92, v22
    v_exp_f32 v44, -v44
    v_pk_fma_f32 v[40:41], v[40:41], v[36:37], v[38:39] op_sel_hi:[1,0,0] neg_lo:[0,0,1] neg_hi:[0,0,1]
    v_pk_fma_f32 v[42:43], v[42:43], v[36:37], v[38:39] op_sel_hi:[1,0,0] neg_lo:[0,0,1] neg_hi:[0,0,1]
    v_add_f32 v44, 1.0, v44
    v_rcp_f32 v44, v44
    s_cmp_eq_u32 s52, 0
    s_cselect_b32 s71, 8, 0
    v_and_b32 v36, 15, v1
    v_mov_b32 v37, 1073741824
    v_cmp_gt_u32 vcc, s71, v36
    s_nop 1
    v_cndmask_b32 v86, v37, v86, vcc
    s_waitcnt vmcnt(5)
    v_mfma_f32_16x16x32_bf16 v[64:67], v[176:179], v[128:131], 0
    v_max3_u32 v48, v128, v129, 0
    v_mfma_f32_16x16x32_bf16 v[68:71], v[180:183], v[128:131], 0
    v_max3_u32 v48, v130, v131, v48
    s_waitcnt vmcnt(4)
    v_mfma_f32_16x16x32_bf16 v[64:67], v[184:187], v[132:135], v[64:67]
    v_max3_u32 v48, v132, v133, v48
    v_mfma_f32_16x16x32_bf16 v[68:71], v[188:191], v[132:135], v[68:71]
    v_max3_u32 v48, v134, v135, v48
    s_waitcnt vmcnt(3)
    v_mfma_f32_16x16x32_bf16 v[64:67], v[192:195], v[136:139], v[64:67]
    v_max3_u32 v48, v136, v137, v48
    v_mfma_f32_16x16x32_bf16 v[68:71], v[196:199], v[136:139], v[68:71]
    v_max3_u32 v48, v138, v139, v48
    s_waitcnt vmcnt(2)
    v_mfma_f32_16x16x32_bf16 v[64:67], v[200:203], v[140:143], v[64:67]
    v_max3_u32 v48, v140, v141, v48
    v_mfma_f32_16x16x32_bf16 v[68:71], v[204:207], v[140:143], v[68:71]
    v_max3_u32 v48, v142, v143, v48
    s_waitcnt vmcnt(1)
    v_mfma_f32_16x16x32_bf16 v[64:67], v[208:211], v[144:147], v[64:67]
    v_max3_u32 v48, v144, v145, v48
    v_mfma_f32_16x16x32_bf16 v[68:71], v[212:215], v[144:147], v[68:71]
    v_max3_u32 v48, v146, v147, v48
    s_waitcnt vmcnt(0)
    v_mfma_f32_16x16x32_bf16 v[64:67], v[216:219], v[148:151], v[64:67]
    v_max3_u32 v48, v148, v149, v48
    v_mfma_f32_16x16x32_bf16 v[68:71], v[220:223], v[148:151], v[68:71]
    v_max3_u32 v48, v150, v151, v48
    v_cmp_eq_u32 vcc, -1, v48
    s_cbranch_vccnz spin_act_76047
ok_act_76048:
    s_nop 4
    v_add_f32_dpp v64, v68, v64 row_ror:8 row_mask:0xf bank_mask:0xf
    v_add_f32_dpp v65, v69, v65 row_ror:8 row_mask:0xf bank_mask:0xf
    v_add_f32_dpp v66, v70, v66 row_ror:8 row_mask:0xf bank_mask:0xf
    v_add_f32_dpp v67, v71, v67 row_ror:8 row_mask:0xf bank_mask:0xf
    ds_write_b128 v87, v[64:67]
    s_waitcnt lgkmcnt(0)
    s_barrier
    ds_read_b128 v[68:71], v88 offset:1024
    ds_read_b128 v[72:75], v88 offset:2048
    ds_read_b128 v[76:79], v88 offset:3072
    s_waitcnt lgkmcnt(2)
    v_pk_add_f32 v[64:65], v[64:65], v[68:69]
    s_waitcnt lgkmcnt(0)
    v_pk_add_f32 v[72:73], v[72:73], v[76:77]
    v_pk_add_f32 v[66:67], v[66:67], v[70:71]
    v_pk_add_f32 v[74:75], v[74:75], v[78:79]
    v_pk_add_f32 v[64:65], v[64:65], v[72:73]
    v_pk_fma_f32 v[64:65], v[64:65], v[44:45], v[40:41] op_sel_hi:[1,0,1]
    v_pk_add_f32 v[66:67], v[66:67], v[74:75]
    v_pk_fma_f32 v[66:67], v[66:67], v[44:45], v[42:43] op_sel_hi:[1,0,1]
    v_cvt_pk_bf16_f32 v64, v64, v65
    v_cvt_pk_bf16_f32 v65, v66, v67
    buffer_store_dwordx2 v[64:65], v86, s[48:51], 0 offen sc1
L_fin:
L_end:
    s_endpgm
spin_f3_32001:
    s_waitcnt vmcnt(0) lgkmcnt(0)
    s_mov_b32 s78, 0
lp_f3_33003:
    buffer_load_dword v24, v12, s[36:39], s68 offen sc1
    s_waitcnt vmcnt(0) lgkmcnt(0)
    v_cmp_ne_u32_e64 vcc, s57, v24
    s_cbranch_vccz dn_f3_33004
    s_add_u32 s78, s78, 1
    s_cmp_lt_u32 s78, 2097152
    s_cbranch_scc1 lp_f3_33003
dn_f3_33004:
    s_branch ok_f3_32002
spin_st_34003:
    s_waitcnt vmcnt(0) lgkmcnt(0)
    s_mov_b32 s78, 0
lp_st_35005:
    buffer_load_dwordx4 v[128:131], v16, s[36:39], s68 offen sc1
    buffer_load_dwordx4 v[136:139], v17, s[36:39], s68 offen sc1
    s_waitcnt vmcnt(0) lgkmcnt(0)
    v_cmp_ne_u32 vcc, s57, v131
    v_cmp_ne_u32 s[76:77], s57, v139
    s_or_b64 vcc, vcc, s[76:77]
    s_cbranch_vccz dn_st_35006
    s_add_u32 s78, s78, 1
    s_cmp_lt_u32 s78, 2097152
    s_cbranch_scc1 lp_st_35005
dn_st_35006:
    s_branch ok_st_34004
spin_pk_36005:
    s_waitcnt vmcnt(0) lgkmcnt(0)
    s_mov_b32 s78, 0
lp_pk_37007:
    buffer_load_dwordx4 v[40:43], v18, s[36:39], s70 offen sc1
    s_waitcnt vmcnt(0) lgkmcnt(0)
    v_xor_b32 v32, v4, v40
    v_xor_b32 v33, v4, v41
    v_xor_b32_e64 v34, v4, v42
    v_or3_b32 v32, v32, v33, v34
    v_xor_b32 v33, v4, v43
    v_or_b32 v32, v32, v33
    v_cmp_ne_u32_e64 vcc, 0, v32
    s_cbranch_vccz dn_pk_37008
    s_add_u32 s78, s78, 1
    s_cmp_lt_u32 s78, 2097152
    s_cbranch_scc1 lp_pk_37007
dn_pk_37008:
    s_branch ok_pk_36006
spin_red_38007:
    s_waitcnt vmcnt(0) lgkmcnt(0)
    s_mov_b32 s78, 0
lp_red_39009:
    s_or_b64 exec, s[76:77], 1
    buffer_load_dwordx4 v[40:43], v20, s[36:39], s58 offen sc1
    s_or_b64 exec, s[74:75], 1
    buffer_load_dwordx4 v[44:47], v20, s[36:39], s59 offen sc1
    s_or_b64 exec, s[24:25], 1
    buffer_load_dwordx4 v[48:51], v20, s[36:39], s60 offen sc1
    s_or_b64 exec, s[8:9], 1
    buffer_load_dwordx4 v[52:55], v20, s[36:39], s61 offen sc1
    s_mov_b64 exec, -1
    s_waitcnt vmcnt(0) lgkmcnt(0)
    v_perm_b32 v32, v41, v40, s88
    v_perm_b32 v33, v43, v42, s88
    v_perm_b32 v32, v33, v32, s89
    v_cmp_ne_u32 s[76:77], s57, v32
    v_perm_b32 v32, v45, v44, s88
    v_perm_b32 v33, v47, v46, s88
    v_perm_b32 v32, v33, v32, s89
    v_cmp_ne_u32 s[74:75], s57, v32
    v_perm_b32 v32, v49, v48, s88
    v_perm_b32 v33, v51, v50, s88
    v_perm_b32 v32, v33, v32, s89
    v_cmp_ne_u32 s[24:25], s57, v32
    v_perm_b32 v32, v53, v52, s88
    v_perm_b32 v33, v55, v54, s88
    v_perm_b32 v32, v33, v32, s89
    v_cmp_ne_u32 s[8:9], s57, v32
    s_or_b64 vcc, s[76:77], s[74:75]
    s_or_b64 vcc, vcc, s[24:25]
    s_or_b64 vcc, vcc, s[8:9]
    s_cbranch_vccz dn_red_39010
    s_add_u32 s78, s78, 1
    s_cmp_lt_u32 s78, 2097152
    s_cbranch_scc1 lp_red_39009
dn_red_39010:
    s_branch ok_red_38008
spin_wo_40009:
    s_waitcnt vmcnt(0) lgkmcnt(0)
    s_mov_b32 s78, 0
lp_wo_41011:
    buffer_load_dwordx4 v[44:47], v29, s[36:39], 0 offen sc1
    s_waitcnt vmcnt(0) lgkmcnt(0)
    v_xor_b32 v32, v4, v44
    v_xor_b32 v33, v4, v45
    v_xor_b32_e64 v34, v4, v46
    v_or3_b32 v32, v32, v33, v34
    v_xor_b32 v33, v4, v47
    v_or_b32 v32, v32, v33
    v_cmp_ne_u32_e64 vcc, 0, v32
    s_cbranch_vccz dn_wo_41012
    s_add_u32 s78, s78, 1
    s_cmp_lt_u32 s78, 2097152
    s_cbranch_scc1 lp_wo_41011
dn_wo_41012:
    s_branch ok_wo_40010
spin_gat_42015:
    s_waitcnt vmcnt(0) lgkmcnt(0)
    s_mov_b32 s78, 0
lp_gat_43017:
    s_or_b64 exec, s[76:77], 1
    buffer_load_dwordx4 v[40:43], v23, s[36:39], s63 offen sc1
    s_or_b64 exec, s[74:75], 1
    buffer_load_dwordx4 v[44:47], v23, s[36:39], s64 offen sc1
    s_or_b64 exec, s[24:25], 1
    buffer_load_dwordx4 v[48:51], v23, s[36:39], s65 offen sc1
    s_or_b64 exec, s[8:9], 1
    buffer_load_dwordx4 v[52:55], v22, s[36:39], s66 offen sc1
    s_mov_b64 exec, -1
    s_waitcnt vmcnt(0) lgkmcnt(0)
    v_cmp_ne_u32 s[76:77], s57, v42
    v_cmp_ne_u32 s[74:75], s57, v46
    v_cmp_ne_u32 s[24:25], s57, v50
    v_cmp_ne_u32 s[8:9], s57, v54
    s_or_b64 vcc, s[76:77], s[74:75]
    s_or_b64 vcc, vcc, s[24:25]
    s_or_b64 vcc, vcc, s[8:9]
    s_cbranch_vccz dn_gat_43018
    s_add_u32 s78, s78, 1
    s_cmp_lt_u32 s78, 2097152
    s_cbranch_scc1 lp_gat_43017
dn_gat_43018:
    s_branch ok_gat_42016
spin_sb_52017:
    s_waitcnt vmcnt(0) lgkmcnt(0)
    s_mov_b32 s78, 0
lp_sb_53019:
    buffer_load_dwordx4 v[32:35], v17, s[36:39], s90 offen sc1
    buffer_load_dwordx4 v[40:43], v18, s[36:39], s90 offen sc1
    s_waitcnt vmcnt(0) lgkmcnt(0)
    v_cmp_ne_u32_e64 vcc, s57, v35
    v_cmp_ne_u32 s[76:77], s57, v43
    s_or_b64 vcc, vcc, s[76:77]
    s_cbranch_vccz dn_sb_53020
    s_add_u32 s78, s78, 1
    s_cmp_lt_u32 s78, 2097152
    s_cbranch_scc1 lp_sb_53019
dn_sb_53020:
    s_branch ok_sb_52018
morea_56023:
    s_waitcnt vmcnt(0) lgkmcnt(0)
    v_cmp_le_u32_e64 vcc, s99, v96
    v_cmp_lt_u32 s[76:77], v96, v27
    s_and_b64 exec, vcc, s[76:77]
    ds_add_rtn_u32 v24, v11, v15 offset:224
    s_waitcnt lgkmcnt(0)
    v_min_u32_e64 v24, 16, v24
    v_lshl_add_u32 v24, v24, 2, v11
    ds_write_b32 v24, v96 offset:128
    s_mov_b64 exec, -1
    v_cmp_le_u32 vcc, s99, v97
    v_cmp_lt_u32 s[76:77], v97, v27
    s_and_b64 exec, vcc, s[76:77]
    ds_add_rtn_u32 v24, v11, v15 offset:224
    s_waitcnt lgkmcnt(0)
    v_min_u32_e64 v24, 16, v24
    v_lshl_add_u32 v24, v24, 2, v11
    ds_write_b32 v24, v97 offset:128
    s_mov_b64 exec, -1
    v_cmp_le_u32 vcc, s99, v98
    v_cmp_lt_u32 s[76:77], v98, v27
    s_and_b64 exec, vcc, s[76:77]
    ds_add_rtn_u32 v24, v11, v15 offset:224
    s_waitcnt lgkmcnt(0)
    v_min_u32_e64 v24, 16, v24
    v_lshl_add_u32 v24, v24, 2, v11
    ds_write_b32 v24, v98 offset:128
    s_mov_b64 exec, -1
    v_cmp_le_u32 vcc, s99, v99
    v_cmp_lt_u32 s[76:77], v99, v27
    s_and_b64 exec, vcc, s[76:77]
    ds_add_rtn_u32 v24, v11, v15 offset:224
    s_waitcnt lgkmcnt(0)
    v_min_u32_e64 v24, 16, v24
    v_lshl_add_u32 v24, v24, 2, v11
    ds_write_b32 v24, v99 offset:128
    s_mov_b64 exec, -1
    v_cmp_le_u32 vcc, s99, v100
    v_cmp_lt_u32 s[76:77], v100, v27
    s_and_b64 exec, vcc, s[76:77]
    ds_add_rtn_u32 v24, v11, v15 offset:224
    s_waitcnt lgkmcnt(0)
    v_min_u32_e64 v24, 16, v24
    v_lshl_add_u32 v24, v24, 2, v11
    ds_write_b32 v24, v100 offset:128
    s_mov_b64 exec, -1
    v_cmp_le_u32 vcc, s99, v101
    v_cmp_lt_u32 s[76:77], v101, v27
    s_and_b64 exec, vcc, s[76:77]
    ds_add_rtn_u32 v24, v11, v15 offset:224
    s_waitcnt lgkmcnt(0)
    v_min_u32_e64 v24, 16, v24
    v_lshl_add_u32 v24, v24, 2, v11
    ds_write_b32 v24, v101 offset:128
    s_mov_b64 exec, -1
    v_cmp_le_u32 vcc, s99, v102
    v_cmp_lt_u32 s[76:77], v102, v27
    s_and_b64 exec, vcc, s[76:77]
    ds_add_rtn_u32 v24, v11, v15 offset:224
    s_waitcnt lgkmcnt(0)
    v_min_u32_e64 v24, 16, v24
    v_lshl_add_u32 v24, v24, 2, v11
    ds_write_b32 v24, v102 offset:128
    s_mov_b64 exec, -1
    v_cmp_le_u32 vcc, s99, v103
    v_cmp_lt_u32 s[76:77], v103, v27
    s_and_b64 exec, vcc, s[76:77]
    ds_add_rtn_u32 v24, v11, v15 offset:224
    s_waitcnt lgkmcnt(0)
    v_min_u32_e64 v24, 16, v24
    v_lshl_add_u32 v24, v24, 2, v11
    ds_write_b32 v24, v103 offset:128
    s_mov_b64 exec, -1
    s_waitcnt vmcnt(0) lgkmcnt(0)
    s_branch backa_56024
spin_fha_58025:
    s_waitcnt vmcnt(0) lgkmcnt(0)
    s_mov_b32 s78, 0
lp_fha_59027:
    buffer_load_dword v104, v93, s[36:39], s90 offen sc1
    s_waitcnt vmcnt(0) lgkmcnt(0)
    v_cmp_ne_u32_e64 vcc, s57, v104
    s_cbranch_vccz dn_fha_59028
    s_add_u32 s78, s78, 1
    s_cmp_lt_u32 s78, 2097152
    s_cbranch_scc1 lp_fha_59027
dn_fha_59028:
    s_branch ok_fha_58026
slowa_60027:
    s_waitcnt vmcnt(0) lgkmcnt(0)
    s_barrier
    v_mov_b32_e64 v24, 0
    ds_write_b32 v14, v24 offset:128
    v_mov_b32 v33, v11
    v_mov_b32 v34, -1
    s_mov_b32 s68, 0
    s_waitcnt vmcnt(0) lgkmcnt(0)
    s_barrier
slp_61029:
    v_mov_b32 v24, 0
    v_cmp_le_u32 vcc, v96, v34
    s_nop 1
    v_cndmask_b32 v25, 0, v96, vcc
    v_max_u32 v24, v24, v25
    v_cmp_le_u32 vcc, v97, v34
    s_nop 1
    v_cndmask_b32 v25, 0, v97, vcc
    v_max_u32 v24, v24, v25
    v_cmp_le_u32 vcc, v98, v34
    s_nop 1
    v_cndmask_b32 v25, 0, v98, vcc
    v_max_u32 v24, v24, v25
    v_cmp_le_u32 vcc, v99, v34
    s_nop 1
    v_cndmask_b32 v25, 0, v99, vcc
    v_max_u32 v24, v24, v25
    v_cmp_le_u32 vcc, v100, v34
    s_nop 1
    v_cndmask_b32 v25, 0, v100, vcc
    v_max_u32 v24, v24, v25
    v_cmp_le_u32 vcc, v101, v34
    s_nop 1
    v_cndmask_b32 v25, 0, v101, vcc
    v_max_u32 v24, v24, v25
    v_cmp_le_u32 vcc, v102, v34
    s_nop 1
    v_cndmask_b32 v25, 0, v102, vcc
    v_max_u32 v24, v24, v25
    v_cmp_le_u32 vcc, v103, v34
    s_nop 1
    v_cndmask_b32 v25, 0, v103, vcc
    v_max_u32 v24, v24, v25
    ds_max_u32 v33, v24 offset:128
    s_waitcnt vmcnt(0) lgkmcnt(0)
    s_barrier
    ds_read_b32 v34, v33 offset:128
    v_add_u32 v33, 4, v33
    s_waitcnt lgkmcnt(0)
    v_add_u32 v34, -1, v34
    s_add_u32 s68, s68, 1
    s_cmp_lt_u32 s68, 16
    s_cbranch_scc1 slp_61029
    ds_read_b32 v25, v117 offset:128
    s_waitcnt lgkmcnt(0)
    s_nop 0
    v_bfi_b32 v38, v25, 0, v123
    v_cmp_ne_u32 s[74:75], 0, v25
    v_mad_u32_u24 v36, v38, s91, v86
    v_lshl_add_u32 v34, v38, 7, v119
    v_cndmask_b32 v36, v122, v36, s[74:75]
    s_waitcnt vmcnt(0) lgkmcnt(0)
    s_branch back2a_60028
spin_ms1_62029:
    s_waitcnt vmcnt(0) lgkmcnt(0)
    s_mov_b32 s78, 0
lp_ms1_63031:
    buffer_load_dwordx4 v[28:31], v34, s[36:39], s69 offen sc1
    s_waitcnt vmcnt(0) lgkmcnt(0)
    v_cmp_ne_u32 vcc, s57, v31
    s_cbranch_vccz dn_ms1_63032
    s_add_u32 s78, s78, 1
    s_cmp_lt_u32 s78, 2097152
    s_cbranch_scc1 lp_ms1_63031
dn_ms1_63032:
    s_branch ok_ms1_62030
moreb_66035:
    s_waitcnt vmcnt(0) lgkmcnt(0)
    v_cmp_le_u32 vcc, s99, v96
    v_cmp_lt_u32 s[76:77], v96, v27
    s_and_b64 exec, vcc, s[76:77]
    ds_add_rtn_u32 v24, v11, v15 offset:224
    s_waitcnt lgkmcnt(0)
    v_min_u32_e64 v24, 16, v24
    v_lshl_add_u32 v24, v24, 2, v11
    ds_write_b32 v24, v96 offset:128
    s_mov_b64 exec, -1
    v_cmp_le_u32 vcc, s99, v97
    v_cmp_lt_u32 s[76:77], v97, v27
    s_and_b64 exec, vcc, s[76:77]
    ds_add_rtn_u32 v24, v11, v15 offset:224
    s_waitcnt lgkmcnt(0)
    v_min_u32_e64 v24, 16, v24
    v_lshl_add_u32 v24, v24, 2, v11
    ds_write_b32 v24, v97 offset:128
    s_mov_b64 exec, -1
    v_cmp_le_u32 vcc, s99, v98
    v_cmp_lt_u32 s[76:77], v98, v27
    s_and_b64 exec, vcc, s[76:77]
    ds_add_rtn_u32 v24, v11, v15 offset:224
    s_waitcnt lgkmcnt(0)
    v_min_u32_e64 v24, 16, v24
    v_lshl_add_u32 v24, v24, 2, v11
    ds_write_b32 v24, v98 offset:128
    s_mov_b64 exec, -1
    v_cmp_le_u32 vcc, s99, v99
    v_cmp_lt_u32 s[76:77], v99, v27
    s_and_b64 exec, vcc, s[76:77]
    ds_add_rtn_u32 v24, v11, v15 offset:224
    s_waitcnt lgkmcnt(0)
    v_min_u32_e64 v24, 16, v24
    v_lshl_add_u32 v24, v24, 2, v11
    ds_write_b32 v24, v99 offset:128
    s_mov_b64 exec, -1
    v_cmp_le_u32 vcc, s99, v100
    v_cmp_lt_u32 s[76:77], v100, v27
    s_and_b64 exec, vcc, s[76:77]
    ds_add_rtn_u32 v24, v11, v15 offset:224
    s_waitcnt lgkmcnt(0)
    v_min_u32_e64 v24, 16, v24
    v_lshl_add_u32 v24, v24, 2, v11
    ds_write_b32 v24, v100 offset:128
    s_mov_b64 exec, -1
    v_cmp_le_u32 vcc, s99, v101
    v_cmp_lt_u32 s[76:77], v101, v27
    s_and_b64 exec, vcc, s[76:77]
    ds_add_rtn_u32 v24, v11, v15 offset:224
    s_waitcnt lgkmcnt(0)
    v_min_u32_e64 v24, 16, v24
    v_lshl_add_u32 v24, v24, 2, v11
    ds_write_b32 v24, v101 offset:128
    s_mov_b64 exec, -1
    v_cmp_le_u32 vcc, s99, v102
    v_cmp_lt_u32 s[76:77], v102, v27
    s_and_b64 exec, vcc, s[76:77]
    ds_add_rtn_u32 v24, v11, v15 offset:224
    s_waitcnt lgkmcnt(0)
    v_min_u32_e64 v24, 16, v24
    v_lshl_add_u32 v24, v24, 2, v11
    ds_write_b32 v24, v102 offset:128
    s_mov_b64 exec, -1
    v_cmp_le_u32 vcc, s99, v103
    v_cmp_lt_u32 s[76:77], v103, v27
    s_and_b64 exec, vcc, s[76:77]
    ds_add_rtn_u32 v24, v11, v15 offset:224
    s_waitcnt lgkmcnt(0)
    v_min_u32_e64 v24, 16, v24
    v_lshl_add_u32 v24, v24, 2, v11
    ds_write_b32 v24, v103 offset:128
    s_mov_b64 exec, -1
    s_waitcnt vmcnt(0) lgkmcnt(0)
    s_branch backb_66036
spin_fhb_68037:
    s_waitcnt vmcnt(0) lgkmcnt(0)
    s_mov_b32 s78, 0
lp_fhb_69039:
    buffer_load_dword v104, v93, s[36:39], s90 offen sc1
    s_waitcnt vmcnt(0) lgkmcnt(0)
    v_cmp_ne_u32_e64 vcc, s57, v104
    s_cbranch_vccz dn_fhb_69040
    s_add_u32 s78, s78, 1
    s_cmp_lt_u32 s78, 2097152
    s_cbranch_scc1 lp_fhb_69039
dn_fhb_69040:
    s_branch ok_fhb_68038
slowb_70039:
    s_waitcnt vmcnt(0) lgkmcnt(0)
    s_barrier
    v_mov_b32_e64 v24, 0
    ds_write_b32 v14, v24 offset:128
    v_mov_b32 v33, v11
    v_mov_b32 v34, -1
    s_mov_b32 s68, 0
    s_waitcnt vmcnt(0) lgkmcnt(0)
    s_barrier
slp_71041:
    v_mov_b32 v24, 0
    v_cmp_le_u32 vcc, v96, v34
    s_nop 1
    v_cndmask_b32 v25, 0, v96, vcc
    v_max_u32 v24, v24, v25
    v_cmp_le_u32 vcc, v97, v34
    s_nop 1
    v_cndmask_b32 v25, 0, v97, vcc
    v_max_u32 v24, v24, v25
    v_cmp_le_u32 vcc, v98, v34
    s_nop 1
    v_cndmask_b32 v25, 0, v98, vcc
    v_max_u32 v24, v24, v25
    v_cmp_le_u32 vcc, v99, v34
    s_nop 1
    v_cndmask_b32 v25, 0, v99, vcc
    v_max_u32 v24, v24, v25
    v_cmp_le_u32 vcc, v100, v34
    s_nop 1
    v_cndmask_b32 v25, 0, v100, vcc
    v_max_u32 v24, v24, v25
    v_cmp_le_u32 vcc, v101, v34
    s_nop 1
    v_cndmask_b32 v25, 0, v101, vcc
    v_max_u32 v24, v24, v25
    v_cmp_le_u32 vcc, v102, v34
    s_nop 1
    v_cndmask_b32 v25, 0, v102, vcc
    v_max_u32 v24, v24, v25
    v_cmp_le_u32 vcc, v103, v34
    s_nop 1
    v_cndmask_b32 v25, 0, v103, vcc
    v_max_u32 v24, v24, v25
    ds_max_u32 v33, v24 offset:128
    s_waitcnt vmcnt(0) lgkmcnt(0)
    s_barrier
    ds_read_b32 v34, v33 offset:128
    v_add_u32 v33, 4, v33
    s_waitcnt lgkmcnt(0)
    v_add_u32 v34, -1, v34
    s_add_u32 s68, s68, 1
    s_cmp_lt_u32 s68, 16
    s_cbranch_scc1 slp_71041
    ds_read_b32 v25, v14 offset:128
    s_waitcnt vmcnt(0) lgkmcnt(0)
    s_branch back2b_70040
spin_ms2_72041:
    s_waitcnt vmcnt(0) lgkmcnt(0)
    s_mov_b32 s78, 0
lp_ms2_73043:
    buffer_load_dwordx4 v[28:31], v35, s[36:39], s69 offen sc1
    buffer_load_dwordx4 v[20:23], v34, s[36:39], s69 offen offset:64 sc1
    s_waitcnt vmcnt(0) lgkmcnt(0)
    v_cmp_ne_u32 vcc, s57, v31
    v_cmp_ne_u32 s[76:77], s57, v23
    s_or_b64 vcc, vcc, s[76:77]
    s_cbranch_vccz dn_ms2_73044
    s_add_u32 s78, s78, 1
    s_cmp_lt_u32 s78, 2097152
    s_cbranch_scc1 lp_ms2_73043
dn_ms2_73044:
    s_branch ok_ms2_72042
spin_f4_74045:
    s_waitcnt vmcnt(0) lgkmcnt(0)
    s_mov_b32 s78, 0
lp_f4_75047:
    buffer_load_dword v17, v39, s[36:39], s70 offen sc1
    s_waitcnt vmcnt(0) lgkmcnt(0)
    v_cmp_ne_u32_e64 vcc, s57, v17
    s_cbranch_vccz dn_f4_75048
    s_add_u32 s78, s78, 1
    s_cmp_lt_u32 s78, 2097152
    s_cbranch_scc1 lp_f4_75047
dn_f4_75048:
    s_branch ok_f4_74046
spin_act_76047:
    s_mov_b32 s78, 0
lp_act_77049:
    s_nop 0
    buffer_load_dwordx4 v[128:131], v85, s[36:39], s88 offen offset:0 sc1
    buffer_load_dwordx4 v[132:135], v85, s[36:39], s88 offen offset:1024 sc1
    buffer_load_dwordx4 v[136:139], v85, s[36:39], s88 offen offset:2048 sc1
    buffer_load_dwordx4 v[140:143], v85, s[36:39], s88 offen offset:3072 sc1
    buffer_load_dwordx4 v[144:147], v85, s[36:39], s89 offen offset:0 sc1
    buffer_load_dwordx4 v[148:151], v85, s[36:39], s89 offen offset:1024 sc1
    s_waitcnt vmcnt(5)
    v_max_u32 v48, v128, v129
    v_max3_u32 v48, v48, v130, v131
    s_waitcnt vmcnt(4)
    v_max3_u32 v48, v48, v132, v133
    v_max3_u32 v48, v48, v134, v135
    s_waitcnt vmcnt(3)
    v_max3_u32 v48, v48, v136, v137
    v_max3_u32 v48, v48, v138, v139
    s_waitcnt vmcnt(2)
    v_max3_u32 v48, v48, v140, v141
    v_max3_u32 v48, v48, v142, v143
    s_waitcnt vmcnt(1)
    v_max3_u32 v48, v48, v144, v145
    v_max3_u32 v48, v48, v146, v147
    s_waitcnt vmcnt(0)
    v_max3_u32 v48, v48, v148, v149
    v_max3_u32 v48, v48, v150, v151
    v_cmp_eq_u32 vcc, -1, v48
    s_cbranch_vccz dn_act_77050
    s_add_u32 s78, s78, 1
    s_cmp_lt_u32 s78, 2097152
    s_cbranch_scc1 lp_act_77049
dn_act_77050:
    v_mfma_f32_16x16x32_bf16 v[64:67], v[176:179], v[128:131], 0
    v_mfma_f32_16x16x32_bf16 v[68:71], v[180:183], v[128:131], 0
    v_mfma_f32_16x16x32_bf16 v[64:67], v[184:187], v[132:135], v[64:67]
    v_mfma_f32_16x16x32_bf16 v[68:71], v[188:191], v[132:135], v[68:71]
    v_mfma_f32_16x16x32_bf16 v[64:67], v[192:195], v[136:139], v[64:67]
    v_mfma_f32_16x16x32_bf16 v[68:71], v[196:199], v[136:139], v[68:71]
    v_mfma_f32_16x16x32_bf16 v[64:67], v[200:203], v[140:143], v[64:67]
    v_mfma_f32_16x16x32_bf16 v[68:71], v[204:207], v[140:143], v[68:71]
    v_mfma_f32_16x16x32_bf16 v[64:67], v[208:211], v[144:147], v[64:67]
    v_mfma_f32_16x16x32_bf16 v[68:71], v[212:215], v[144:147], v[68:71]
    v_mfma_f32_16x16x32_bf16 v[64:67], v[216:219], v[148:151], v[64:67]
    v_mfma_f32_16x16x32_bf16 v[68:71], v[220:223], v[148:151], v[68:71]
    s_nop 7
    s_branch ok_act_76048
L_code_end:
L_redo:
    s_waitcnt vmcnt(0) lgkmcnt(0)
    s_mul_i32 s68, s96, 81920
    s_add_u32 s68, s68, 6291456
    s_and_b32 s69, s96, 3
    s_mul_i32 s69, s69, 5120
    v_add_u32 v48, 0, v2
    v_add_u32 v49, 20480, v2
    v_add_u32 v50, 40960, v2
    v_add_u32 v51, 61440, v2
    s_add_u32 s70, s68, s69
    s_mov_b32 s78, 0
rd_55019:
    buffer_load_dwordx4 v[32:35], v48, s[36:39], s70 offen sc1
    buffer_load_dwordx4 v[36:39], v49, s[36:39], s70 offen sc1
    buffer_load_dwordx4 v[40:43], v50, s[36:39], s70 offen sc1
    buffer_load_dwordx4 v[44:47], v51, s[36:39], s70 offen sc1
    s_waitcnt vmcnt(3)
    v_max_u32 v52, v32, v33
    v_max3_u32 v52, v52, v34, v35
    s_waitcnt vmcnt(2)
    v_max3_u32 v52, v52, v36, v37
    v_max3_u32 v52, v52, v38, v39
    s_waitcnt vmcnt(1)
    v_max3_u32 v52, v52, v40, v41
    v_max3_u32 v52, v52, v42, v43
    s_waitcnt vmcnt(0)
    v_max3_u32 v52, v52, v44, v45
    v_max3_u32 v52, v52, v46, v47
    v_cmp_eq_u32 vcc, -1, v52
    s_cbranch_vccz re_55020
    s_add_u32 s78, s78, 1
    s_cmp_lt_u32 s78, 131072
    s_cbranch_scc1 rd_55019
re_55020:
    v_mfma_f32_16x16x32_bf16 v[64:67], v[96:99], v[32:35], 0
    v_mfma_f32_16x16x32_bf16 v[68:71], v[100:103], v[32:35], 0
    v_mfma_f32_16x16x32_bf16 v[72:75], v[96:99], v[36:39], 0
    v_mfma_f32_16x16x32_bf16 v[76:79], v[100:103], v[36:39], 0
    v_mfma_f32_16x16x32_bf16 v[80:83], v[96:99], v[40:43], 0
    v_mfma_f32_16x16x32_bf16 v[84:87], v[100:103], v[40:43], 0
    v_mfma_f32_16x16x32_bf16 v[88:91], v[96:99], v[44:47], 0
    v_mfma_f32_16x16x32_bf16 v[92:95], v[100:103], v[44:47], 0
    s_add_u32 s69, s69, 1024
    s_cmp_eq_u32 s69, 20480
    s_cselect_b32 s69, 0, s69
    s_add_u32 s70, s68, s69
    s_mov_b32 s78, 0
rd_55021:
    buffer_load_dwordx4 v[32:35], v48, s[36:39], s70 offen sc1
    buffer_load_dwordx4 v[36:39], v49, s[36:39], s70 offen sc1
    buffer_load_dwordx4 v[40:43], v50, s[36:39], s70 offen sc1
    buffer_load_dwordx4 v[44:47], v51, s[36:39], s70 offen sc1
    s_waitcnt vmcnt(3)
    v_max_u32 v52, v32, v33
    v_max3_u32 v52, v52, v34, v35
    s_waitcnt vmcnt(2)
    v_max3_u32 v52, v52, v36, v37
    v_max3_u32 v52, v52, v38, v39
    s_waitcnt vmcnt(1)
    v_max3_u32 v52, v52, v40, v41
    v_max3_u32 v52, v52, v42, v43
    s_waitcnt vmcnt(0)
    v_max3_u32 v52, v52, v44, v45
    v_max3_u32 v52, v52, v46, v47
    v_cmp_eq_u32 vcc, -1, v52
    s_cbranch_vccz re_55022
    s_add_u32 s78, s78, 1
    s_cmp_lt_u32 s78, 131072
    s_cbranch_scc1 rd_55021
re_55022:
    v_mfma_f32_16x16x32_bf16 v[64:67], v[104:107], v[32:35], v[64:67]
    v_mfma_f32_16x16x32_bf16 v[68:71], v[108:111], v[32:35], v[68:71]
    v_mfma_f32_16x16x32_bf16 v[72:75], v[104:107], v[36:39], v[72:75]
    v_mfma_f32_16x16x32_bf16 v[76:79], v[108:111], v[36:39], v[76:79]
    v_mfma_f32_16x16x32_bf16 v[80:83], v[104:107], v[40:43], v[80:83]
    v_mfma_f32_16x16x32_bf16 v[84:87], v[108:111], v[40:43], v[84:87]
    v_mfma_f32_16x16x32_bf16 v[88:91], v[104:107], v[44:47], v[88:91]
    v_mfma_f32_16x16x32_bf16 v[92:95], v[108:111], v[44:47], v[92:95]
    s_add_u32 s69, s69, 1024
    s_cmp_eq_u32 s69, 20480
    s_cselect_b32 s69, 0, s69
    s_add_u32 s70, s68, s69
    s_mov_b32 s78, 0
rd_55023:
    buffer_load_dwordx4 v[32:35], v48, s[36:39], s70 offen sc1
    buffer_load_dwordx4 v[36:39], v49, s[36:39], s70 offen sc1
    buffer_load_dwordx4 v[40:43], v50, s[36:39], s70 offen sc1
    buffer_load_dwordx4 v[44:47], v51, s[36:39], s70 offen sc1
    s_waitcnt vmcnt(3)
    v_max_u32 v52, v32, v33
    v_max3_u32 v52, v52, v34, v35
    s_waitcnt vmcnt(2)
    v_max3_u32 v52, v52, v36, v37
    v_max3_u32 v52, v52, v38, v39
    s_waitcnt vmcnt(1)
    v_max3_u32 v52, v52, v40, v41
    v_max3_u32 v52, v52, v42, v43
    s_waitcnt vmcnt(0)
    v_max3_u32 v52, v52, v44, v45
    v_max3_u32 v52, v52, v46, v47
    v_cmp_eq_u32 vcc, -1, v52
    s_cbranch_vccz re_55024
    s_add_u32 s78, s78, 1
    s_cmp_lt_u32 s78, 131072
    s_cbranch_scc1 rd_55023
re_55024:
    v_mfma_f32_16x16x32_bf16 v[64:67], v[112:115], v[32:35], v[64:67]
    v_mfma_f32_16x16x32_bf16 v[68:71], v[116:119], v[32:35], v[68:71]
    v_mfma_f32_16x16x32_bf16 v[72:75], v[112:115], v[36:39], v[72:75]
    v_mfma_f32_16x16x32_bf16 v[76:79], v[116:119], v[36:39], v[76:79]
    v_mfma_f32_16x16x32_bf16 v[80:83], v[112:115], v[40:43], v[80:83]
    v_mfma_f32_16x16x32_bf16 v[84:87], v[116:119], v[40:43], v[84:87]
    v_mfma_f32_16x16x32_bf16 v[88:91], v[112:115], v[44:47], v[88:91]
    v_mfma_f32_16x16x32_bf16 v[92:95], v[116:119], v[44:47], v[92:95]
    s_add_u32 s69, s69, 1024
    s_cmp_eq_u32 s69, 20480
    s_cselect_b32 s69, 0, s69
    s_add_u32 s70, s68, s69
    s_mov_b32 s78, 0
rd_55025:
    buffer_load_dwordx4 v[32:35], v48, s[36:39], s70 offen sc1
    buffer_load_dwordx4 v[36:39], v49, s[36:39], s70 offen sc1
    buffer_load_dwordx4 v[40:43], v50, s[36:39], s70 offen sc1
    buffer_load_dwordx4 v[44:47], v51, s[36:39], s70 offen sc1
    s_waitcnt vmcnt(3)
    v_max_u32 v52, v32, v33
    v_max3_u32 v52, v52, v34, v35
    s_waitcnt vmcnt(2)
    v_max3_u32 v52, v52, v36, v37
    v_max3_u32 v52, v52, v38, v39
    s_waitcnt vmcnt(1)
    v_max3_u32 v52, v52, v40, v41
    v_max3_u32 v52, v52, v42, v43
    s_waitcnt vmcnt(0)
    v_max3_u32 v52, v52, v44, v45
    v_max3_u32 v52, v52, v46, v47
    v_cmp_eq_u32 vcc, -1, v52
    s_cbranch_vccz re_55026
    s_add_u32 s78, s78, 1
    s_cmp_lt_u32 s78, 131072
    s_cbranch_scc1 rd_55025
re_55026:
    v_mfma_f32_16x16x32_bf16 v[64:67], v[120:123], v[32:35], v[64:67]
    v_mfma_f32_16x16x32_bf16 v[68:71], v[124:127], v[32:35], v[68:71]
    v_mfma_f32_16x16x32_bf16 v[72:75], v[120:123], v[36:39], v[72:75]
    v_mfma_f32_16x16x32_bf16 v[76:79], v[124:127], v[36:39], v[76:79]
    v_mfma_f32_16x16x32_bf16 v[80:83], v[120:123], v[40:43], v[80:83]
    v_mfma_f32_16x16x32_bf16 v[84:87], v[124:127], v[40:43], v[84:87]
    v_mfma_f32_16x16x32_bf16 v[88:91], v[120:123], v[44:47], v[88:91]
    v_mfma_f32_16x16x32_bf16 v[92:95], v[124:127], v[44:47], v[92:95]
    s_add_u32 s69, s69, 1024
    s_cmp_eq_u32 s69, 20480
    s_cselect_b32 s69, 0, s69
    s_add_u32 s70, s68, s69
    s_mov_b32 s78, 0
rd_55027:
    buffer_load_dwordx4 v[32:35], v48, s[36:39], s70 offen sc1
    buffer_load_dwordx4 v[36:39], v49, s[36:39], s70 offen sc1
    buffer_load_dwordx4 v[40:43], v50, s[36:39], s70 offen sc1
    buffer_load_dwordx4 v[44:47], v51, s[36:39], s70 offen sc1
    s_waitcnt vmcnt(3)
    v_max_u32 v52, v32, v33
    v_max3_u32 v52, v52, v34, v35
    s_waitcnt vmcnt(2)
    v_max3_u32 v52, v52, v36, v37
    v_max3_u32 v52, v52, v38, v39
    s_waitcnt vmcnt(1)
    v_max3_u32 v52, v52, v40, v41
    v_max3_u32 v52, v52, v42, v43
    s_waitcnt vmcnt(0)
    v_max3_u32 v52, v52, v44, v45
    v_max3_u32 v52, v52, v46, v47
    v_cmp_eq_u32 vcc, -1, v52
    s_cbranch_vccz re_55028
    s_add_u32 s78, s78, 1
    s_cmp_lt_u32 s78, 131072
    s_cbranch_scc1 rd_55027
re_55028:
    v_mfma_f32_16x16x32_bf16 v[64:67], v[128:131], v[32:35], v[64:67]
    v_mfma_f32_16x16x32_bf16 v[68:71], v[132:135], v[32:35], v[68:71]
    v_mfma_f32_16x16x32_bf16 v[72:75], v[128:131], v[36:39], v[72:75]
    v_mfma_f32_16x16x32_bf16 v[76:79], v[132:135], v[36:39], v[76:79]
    v_mfma_f32_16x16x32_bf16 v[80:83], v[128:131], v[40:43], v[80:83]
    v_mfma_f32_16x16x32_bf16 v[84:87], v[132:135], v[40:43], v[84:87]
    v_mfma_f32_16x16x32_bf16 v[88:91], v[128:131], v[44:47], v[88:91]
    v_mfma_f32_16x16x32_bf16 v[92:95], v[132:135], v[44:47], v[92:95]
    s_add_u32 s69, s69, 1024
    s_cmp_eq_u32 s69, 20480
    s_cselect_b32 s69, 0, s69
    s_add_u32 s70, s68, s69
    s_mov_b32 s78, 0
rd_55029:
    buffer_load_dwordx4 v[32:35], v48, s[36:39], s70 offen sc1
    buffer_load_dwordx4 v[36:39], v49, s[36:39], s70 offen sc1
    buffer_load_dwordx4 v[40:43], v50, s[36:39], s70 offen sc1
    buffer_load_dwordx4 v[44:47], v51, s[36:39], s70 offen sc1
    s_waitcnt vmcnt(3)
    v_max_u32 v52, v32, v33
    v_max3_u32 v52, v52, v34, v35
    s_waitcnt vmcnt(2)
    v_max3_u32 v52, v52, v36, v37
    v_max3_u32 v52, v52, v38, v39
    s_waitcnt vmcnt(1)
    v_max3_u32 v52, v52, v40, v41
    v_max3_u32 v52, v52, v42, v43
    s_waitcnt vmcnt(0)
    v_max3_u32 v52, v52, v44, v45
    v_max3_u32 v52, v52, v46, v47
    v_cmp_eq_u32 vcc, -1, v52
    s_cbranch_vccz re_55030
    s_add_u32 s78, s78, 1
    s_cmp_lt_u32 s78, 131072
    s_cbranch_scc1 rd_55029
re_55030:
    v_mfma_f32_16x16x32_bf16 v[64:67], v[136:139], v[32:35], v[64:67]
    v_mfma_f32_16x16x32_bf16 v[68:71], v[140:143], v[32:35], v[68:71]
    v_mfma_f32_16x16x32_bf16 v[72:75], v[136:139], v[36:39], v[72:75]
    v_mfma_f32_16x16x32_bf16 v[76:79], v[140:143], v[36:39], v[76:79]
    v_mfma_f32_16x16x32_bf16 v[80:83], v[136:139], v[40:43], v[80:83]
    v_mfma_f32_16x16x32_bf16 v[84:87], v[140:143], v[40:43], v[84:87]
    v_mfma_f32_16x16x32_bf16 v[88:91], v[136:139], v[44:47], v[88:91]
    v_mfma_f32_16x16x32_bf16 v[92:95], v[140:143], v[44:47], v[92:95]
    s_add_u32 s69, s69, 1024
    s_cmp_eq_u32 s69, 20480
    s_cselect_b32 s69, 0, s69
    s_add_u32 s70, s68, s69
    s_mov_b32 s78, 0
rd_55031:
    buffer_load_dwordx4 v[32:35], v48, s[36:39], s70 offen sc1
    buffer_load_dwordx4 v[36:39], v49, s[36:39], s70 offen sc1
    buffer_load_dwordx4 v[40:43], v50, s[36:39], s70 offen sc1
    buffer_load_dwordx4 v[44:47], v51, s[36:39], s70 offen sc1
    s_waitcnt vmcnt(3)
    v_max_u32 v52, v32, v33
    v_max3_u32 v52, v52, v34, v35
    s_waitcnt vmcnt(2)
    v_max3_u32 v52, v52, v36, v37
    v_max3_u32 v52, v52, v38, v39
    s_waitcnt vmcnt(1)
    v_max3_u32 v52, v52, v40, v41
    v_max3_u32 v52, v52, v42, v43
    s_waitcnt vmcnt(0)
    v_max3_u32 v52, v52, v44, v45
    v_max3_u32 v52, v52, v46, v47
    v_cmp_eq_u32 vcc, -1, v52
    s_cbranch_vccz re_55032
    s_add_u32 s78, s78, 1
    s_cmp_lt_u32 s78, 131072
    s_cbranch_scc1 rd_55031
re_55032:
    v_mfma_f32_16x16x32_bf16 v[64:67], v[144:147], v[32:35], v[64:67]
    v_mfma_f32_16x16x32_bf16 v[68:71], v[148:151], v[32:35], v[68:71]
    v_mfma_f32_16x16x32_bf16 v[72:75], v[144:147], v[36:39], v[72:75]
    v_mfma_f32_16x16x32_bf16 v[76:79], v[148:151], v[36:39], v[76:79]
    v_mfma_f32_16x16x32_bf16 v[80:83], v[144:147], v[40:43], v[80:83]
    v_mfma_f32_16x16x32_bf16 v[84:87], v[148:151], v[40:43], v[84:87]
    v_mfma_f32_16x16x32_bf16 v[88:91], v[144:147], v[44:47], v[88:91]
    v_mfma_f32_16x16x32_bf16 v[92:95], v[148:151], v[44:47], v[92:95]
    s_add_u32 s69, s69, 1024
    s_cmp_eq_u32 s69, 20480
    s_cselect_b32 s69, 0, s69
    s_add_u32 s70, s68, s69
    s_mov_b32 s78, 0
rd_55033:
    buffer_load_dwordx4 v[32:35], v48, s[36:39], s70 offen sc1
    buffer_load_dwordx4 v[36:39], v49, s[36:39], s70 offen sc1
    buffer_load_dwordx4 v[40:43], v50, s[36:39], s70 offen sc1
    buffer_load_dwordx4 v[44:47], v51, s[36:39], s70 offen sc1
    s_waitcnt vmcnt(3)
    v_max_u32 v52, v32, v33
    v_max3_u32 v52, v52, v34, v35
    s_waitcnt vmcnt(2)
    v_max3_u32 v52, v52, v36, v37
    v_max3_u32 v52, v52, v38, v39
    s_waitcnt vmcnt(1)
    v_max3_u32 v52, v52, v40, v41
    v_max3_u32 v52, v52, v42, v43
    s_waitcnt vmcnt(0)
    v_max3_u32 v52, v52, v44, v45
    v_max3_u32 v52, v52, v46, v47
    v_cmp_eq_u32 vcc, -1, v52
    s_cbranch_vccz re_55034
    s_add_u32 s78, s78, 1
    s_cmp_lt_u32 s78, 131072
    s_cbranch_scc1 rd_55033
re_55034:
    v_mfma_f32_16x16x32_bf16 v[64:67], v[152:155], v[32:35], v[64:67]
    v_mfma_f32_16x16x32_bf16 v[68:71], v[156:159], v[32:35], v[68:71]
    v_mfma_f32_16x16x32_bf16 v[72:75], v[152:155], v[36:39], v[72:75]
    v_mfma_f32_16x16x32_bf16 v[76:79], v[156:159], v[36:39], v[76:79]
    v_mfma_f32_16x16x32_bf16 v[80:83], v[152:155], v[40:43], v[80:83]
    v_mfma_f32_16x16x32_bf16 v[84:87], v[156:159], v[40:43], v[84:87]
    v_mfma_f32_16x16x32_bf16 v[88:91], v[152:155], v[44:47], v[88:91]
    v_mfma_f32_16x16x32_bf16 v[92:95], v[156:159], v[44:47], v[92:95]
    s_add_u32 s69, s69, 1024
    s_cmp_eq_u32 s69, 20480
    s_cselect_b32 s69, 0, s69
    s_add_u32 s70, s68, s69
    s_mov_b32 s78, 0
rd_55035:
    buffer_load_dwordx4 v[32:35], v48, s[36:39], s70 offen sc1
    buffer_load_dwordx4 v[36:39], v49, s[36:39], s70 offen sc1
    buffer_load_dwordx4 v[40:43], v50, s[36:39], s70 offen sc1
    buffer_load_dwordx4 v[44:47], v51, s[36:39], s70 offen sc1
    s_waitcnt vmcnt(3)
    v_max_u32 v52, v32, v33
    v_max3_u32 v52, v52, v34, v35
    s_waitcnt vmcnt(2)
    v_max3_u32 v52, v52, v36, v37
    v_max3_u32 v52, v52, v38, v39
    s_waitcnt vmcnt(1)
    v_max3_u32 v52, v52, v40, v41
    v_max3_u32 v52, v52, v42, v43
    s_waitcnt vmcnt(0)
    v_max3_u32 v52, v52, v44, v45
    v_max3_u32 v52, v52, v46, v47
    v_cmp_eq_u32 vcc, -1, v52
    s_cbranch_vccz re_55036
    s_add_u32 s78, s78, 1
    s_cmp_lt_u32 s78, 131072
    s_cbranch_scc1 rd_55035
re_55036:
    v_mfma_f32_16x16x32_bf16 v[64:67], v[160:163], v[32:35], v[64:67]
    v_mfma_f32_16x16x32_bf16 v[68:71], v[164:167], v[32:35], v[68:71]
    v_mfma_f32_16x16x32_bf16 v[72:75], v[160:163], v[36:39], v[72:75]
    v_mfma_f32_16x16x32_bf16 v[76:79], v[164:167], v[36:39], v[76:79]
    v_mfma_f32_16x16x32_bf16 v[80:83], v[160:163], v[40:43], v[80:83]
    v_mfma_f32_16x16x32_bf16 v[84:87], v[164:167], v[40:43], v[84:87]
    v_mfma_f32_16x16x32_bf16 v[88:91], v[160:163], v[44:47], v[88:91]
    v_mfma_f32_16x16x32_bf16 v[92:95], v[164:167], v[44:47], v[92:95]
    s_add_u32 s69, s69, 1024
    s_cmp_eq_u32 s69, 20480
    s_cselect_b32 s69, 0, s69
    s_add_u32 s70, s68, s69
    s_mov_b32 s78, 0
rd_55037:
    buffer_load_dwordx4 v[32:35], v48, s[36:39], s70 offen sc1
    buffer_load_dwordx4 v[36:39], v49, s[36:39], s70 offen sc1
    buffer_load_dwordx4 v[40:43], v50, s[36:39], s70 offen sc1
    buffer_load_dwordx4 v[44:47], v51, s[36:39], s70 offen sc1
    s_waitcnt vmcnt(3)
    v_max_u32 v52, v32, v33
    v_max3_u32 v52, v52, v34, v35
    s_waitcnt vmcnt(2)
    v_max3_u32 v52, v52, v36, v37
    v_max3_u32 v52, v52, v38, v39
    s_waitcnt vmcnt(1)
    v_max3_u32 v52, v52, v40, v41
    v_max3_u32 v52, v52, v42, v43
    s_waitcnt vmcnt(0)
    v_max3_u32 v52, v52, v44, v45
    v_max3_u32 v52, v52, v46, v47
    v_cmp_eq_u32 vcc, -1, v52
    s_cbranch_vccz re_55038
    s_add_u32 s78, s78, 1
    s_cmp_lt_u32 s78, 131072
    s_cbranch_scc1 rd_55037
re_55038:
    v_mfma_f32_16x16x32_bf16 v[64:67], v[168:171], v[32:35], v[64:67]
    v_mfma_f32_16x16x32_bf16 v[68:71], v[172:175], v[32:35], v[68:71]
    v_mfma_f32_16x16x32_bf16 v[72:75], v[168:171], v[36:39], v[72:75]
    v_mfma_f32_16x16x32_bf16 v[76:79], v[172:175], v[36:39], v[76:79]
    v_mfma_f32_16x16x32_bf16 v[80:83], v[168:171], v[40:43], v[80:83]
    v_mfma_f32_16x16x32_bf16 v[84:87], v[172:175], v[40:43], v[84:87]
    v_mfma_f32_16x16x32_bf16 v[88:91], v[168:171], v[44:47], v[88:91]
    v_mfma_f32_16x16x32_bf16 v[92:95], v[172:175], v[44:47], v[92:95]
    s_add_u32 s69, s69, 1024
    s_cmp_eq_u32 s69, 20480
    s_cselect_b32 s69, 0, s69
    s_add_u32 s70, s68, s69
    s_mov_b32 s78, 0
rd_55039:
    buffer_load_dwordx4 v[32:35], v48, s[36:39], s70 offen sc1
    buffer_load_dwordx4 v[36:39], v49, s[36:39], s70 offen sc1
    buffer_load_dwordx4 v[40:43], v50, s[36:39], s70 offen sc1
    buffer_load_dwordx4 v[44:47], v51, s[36:39], s70 offen sc1
    s_waitcnt vmcnt(3)
    v_max_u32 v52, v32, v33
    v_max3_u32 v52, v52, v34, v35
    s_waitcnt vmcnt(2)
    v_max3_u32 v52, v52, v36, v37
    v_max3_u32 v52, v52, v38, v39
    s_waitcnt vmcnt(1)
    v_max3_u32 v52, v52, v40, v41
    v_max3_u32 v52, v52, v42, v43
    s_waitcnt vmcnt(0)
    v_max3_u32 v52, v52, v44, v45
    v_max3_u32 v52, v52, v46, v47
    v_cmp_eq_u32 vcc, -1, v52
    s_cbranch_vccz re_55040
    s_add_u32 s78, s78, 1
    s_cmp_lt_u32 s78, 131072
    s_cbranch_scc1 rd_55039
re_55040:
    v_mfma_f32_16x16x32_bf16 v[64:67], v[176:179], v[32:35], v[64:67]
    v_mfma_f32_16x16x32_bf16 v[68:71], v[180:183], v[32:35], v[68:71]
    v_mfma_f32_16x16x32_bf16 v[72:75], v[176:179], v[36:39], v[72:75]
    v_mfma_f32_16x16x32_bf16 v[76:79], v[180:183], v[36:39], v[76:79]
    v_mfma_f32_16x16x32_bf16 v[80:83], v[176:179], v[40:43], v[80:83]
    v_mfma_f32_16x16x32_bf16 v[84:87], v[180:183], v[40:43], v[84:87]
    v_mfma_f32_16x16x32_bf16 v[88:91], v[176:179], v[44:47], v[88:91]
    v_mfma_f32_16x16x32_bf16 v[92:95], v[180:183], v[44:47], v[92:95]
    s_add_u32 s69, s69, 1024
    s_cmp_eq_u32 s69, 20480
    s_cselect_b32 s69, 0, s69
    s_add_u32 s70, s68, s69
    s_mov_b32 s78, 0
rd_55041:
    buffer_load_dwordx4 v[32:35], v48, s[36:39], s70 offen sc1
    buffer_load_dwordx4 v[36:39], v49, s[36:39], s70 offen sc1
    buffer_load_dwordx4 v[40:43], v50, s[36:39], s70 offen sc1
    buffer_load_dwordx4 v[44:47], v51, s[36:39], s70 offen sc1
    s_waitcnt vmcnt(3)
    v_max_u32 v52, v32, v33
    v_max3_u32 v52, v52, v34, v35
    s_waitcnt vmcnt(2)
    v_max3_u32 v52, v52, v36, v37
    v_max3_u32 v52, v52, v38, v39
    s_waitcnt vmcnt(1)
    v_max3_u32 v52, v52, v40, v41
    v_max3_u32 v52, v52, v42, v43
    s_waitcnt vmcnt(0)
    v_max3_u32 v52, v52, v44, v45
    v_max3_u32 v52, v52, v46, v47
    v_cmp_eq_u32 vcc, -1, v52
    s_cbranch_vccz re_55042
    s_add_u32 s78, s78, 1
    s_cmp_lt_u32 s78, 131072
    s_cbranch_scc1 rd_55041
re_55042:
    v_mfma_f32_16x16x32_bf16 v[64:67], v[184:187], v[32:35], v[64:67]
    v_mfma_f32_16x16x32_bf16 v[68:71], v[188:191], v[32:35], v[68:71]
    v_mfma_f32_16x16x32_bf16 v[72:75], v[184:187], v[36:39], v[72:75]
    v_mfma_f32_16x16x32_bf16 v[76:79], v[188:191], v[36:39], v[76:79]
    v_mfma_f32_16x16x32_bf16 v[80:83], v[184:187], v[40:43], v[80:83]
    v_mfma_f32_16x16x32_bf16 v[84:87], v[188:191], v[40:43], v[84:87]
    v_mfma_f32_16x16x32_bf16 v[88:91], v[184:187], v[44:47], v[88:91]
    v_mfma_f32_16x16x32_bf16 v[92:95], v[188:191], v[44:47], v[92:95]
    s_add_u32 s69, s69, 1024
    s_cmp_eq_u32 s69, 20480
    s_cselect_b32 s69, 0, s69
    s_add_u32 s70, s68, s69
    s_mov_b32 s78, 0
rd_55043:
    buffer_load_dwordx4 v[32:35], v48, s[36:39], s70 offen sc1
    buffer_load_dwordx4 v[36:39], v49, s[36:39], s70 offen sc1
    buffer_load_dwordx4 v[40:43], v50, s[36:39], s70 offen sc1
    buffer_load_dwordx4 v[44:47], v51, s[36:39], s70 offen sc1
    s_waitcnt vmcnt(3)
    v_max_u32 v52, v32, v33
    v_max3_u32 v52, v52, v34, v35
    s_waitcnt vmcnt(2)
    v_max3_u32 v52, v52, v36, v37
    v_max3_u32 v52, v52, v38, v39
    s_waitcnt vmcnt(1)
    v_max3_u32 v52, v52, v40, v41
    v_max3_u32 v52, v52, v42, v43
    s_waitcnt vmcnt(0)
    v_max3_u32 v52, v52, v44, v45
    v_max3_u32 v52, v52, v46, v47
    v_cmp_eq_u32 vcc, -1, v52
    s_cbranch_vccz re_55044
    s_add_u32 s78, s78, 1
    s_cmp_lt_u32 s78, 131072
    s_cbranch_scc1 rd_55043
re_55044:
    v_mfma_f32_16x16x32_bf16 v[64:67], v[192:195], v[32:35], v[64:67]
    v_mfma_f32_16x16x32_bf16 v[68:71], v[196:199], v[32:35], v[68:71]
    v_mfma_f32_16x16x32_bf16 v[72:75], v[192:195], v[36:39], v[72:75]
    v_mfma_f32_16x16x32_bf16 v[76:79], v[196:199], v[36:39], v[76:79]
    v_mfma_f32_16x16x32_bf16 v[80:83], v[192:195], v[40:43], v[80:83]
    v_mfma_f32_16x16x32_bf16 v[84:87], v[196:199], v[40:43], v[84:87]
    v_mfma_f32_16x16x32_bf16 v[88:91], v[192:195], v[44:47], v[88:91]
    v_mfma_f32_16x16x32_bf16 v[92:95], v[196:199], v[44:47], v[92:95]
    s_add_u32 s69, s69, 1024
    s_cmp_eq_u32 s69, 20480
    s_cselect_b32 s69, 0, s69
    s_add_u32 s70, s68, s69
    s_mov_b32 s78, 0
rd_55045:
    buffer_load_dwordx4 v[32:35], v48, s[36:39], s70 offen sc1
    buffer_load_dwordx4 v[36:39], v49, s[36:39], s70 offen sc1
    buffer_load_dwordx4 v[40:43], v50, s[36:39], s70 offen sc1
    buffer_load_dwordx4 v[44:47], v51, s[36:39], s70 offen sc1
    s_waitcnt vmcnt(3)
    v_max_u32 v52, v32, v33
    v_max3_u32 v52, v52, v34, v35
    s_waitcnt vmcnt(2)
    v_max3_u32 v52, v52, v36, v37
    v_max3_u32 v52, v52, v38, v39
    s_waitcnt vmcnt(1)
    v_max3_u32 v52, v52, v40, v41
    v_max3_u32 v52, v52, v42, v43
    s_waitcnt vmcnt(0)
    v_max3_u32 v52, v52, v44, v45
    v_max3_u32 v52, v52, v46, v47
    v_cmp_eq_u32 vcc, -1, v52
    s_cbranch_vccz re_55046
    s_add_u32 s78, s78, 1
    s_cmp_lt_u32 s78, 131072
    s_cbranch_scc1 rd_55045
re_55046:
    v_mfma_f32_16x16x32_bf16 v[64:67], v[200:203], v[32:35], v[64:67]
    v_mfma_f32_16x16x32_bf16 v[68:71], v[204:207], v[32:35], v[68:71]
    v_mfma_f32_16x16x32_bf16 v[72:75], v[200:203], v[36:39], v[72:75]
    v_mfma_f32_16x16x32_bf16 v[76:79], v[204:207], v[36:39], v[76:79]
    v_mfma_f32_16x16x32_bf16 v[80:83], v[200:203], v[40:43], v[80:83]
    v_mfma_f32_16x16x32_bf16 v[84:87], v[204:207], v[40:43], v[84:87]
    v_mfma_f32_16x16x32_bf16 v[88:91], v[200:203], v[44:47], v[88:91]
    v_mfma_f32_16x16x32_bf16 v[92:95], v[204:207], v[44:47], v[92:95]
    s_add_u32 s69, s69, 1024
    s_cmp_eq_u32 s69, 20480
    s_cselect_b32 s69, 0, s69
    s_add_u32 s70, s68, s69
    s_mov_b32 s78, 0
rd_55047:
    buffer_load_dwordx4 v[32:35], v48, s[36:39], s70 offen sc1
    buffer_load_dwordx4 v[36:39], v49, s[36:39], s70 offen sc1
    buffer_load_dwordx4 v[40:43], v50, s[36:39], s70 offen sc1
    buffer_load_dwordx4 v[44:47], v51, s[36:39], s70 offen sc1
    s_waitcnt vmcnt(3)
    v_max_u32 v52, v32, v33
    v_max3_u32 v52, v52, v34, v35
    s_waitcnt vmcnt(2)
    v_max3_u32 v52, v52, v36, v37
    v_max3_u32 v52, v52, v38, v39
    s_waitcnt vmcnt(1)
    v_max3_u32 v52, v52, v40, v41
    v_max3_u32 v52, v52, v42, v43
    s_waitcnt vmcnt(0)
    v_max3_u32 v52, v52, v44, v45
    v_max3_u32 v52, v52, v46, v47
    v_cmp_eq_u32 vcc, -1, v52
    s_cbranch_vccz re_55048
    s_add_u32 s78, s78, 1
    s_cmp_lt_u32 s78, 131072
    s_cbranch_scc1 rd_55047
re_55048:
    v_mfma_f32_16x16x32_bf16 v[64:67], v[208:211], v[32:35], v[64:67]
    v_mfma_f32_16x16x32_bf16 v[68:71], v[212:215], v[32:35], v[68:71]
    v_mfma_f32_16x16x32_bf16 v[72:75], v[208:211], v[36:39], v[72:75]
    v_mfma_f32_16x16x32_bf16 v[76:79], v[212:215], v[36:39], v[76:79]
    v_mfma_f32_16x16x32_bf16 v[80:83], v[208:211], v[40:43], v[80:83]
    v_mfma_f32_16x16x32_bf16 v[84:87], v[212:215], v[40:43], v[84:87]
    v_mfma_f32_16x16x32_bf16 v[88:91], v[208:211], v[44:47], v[88:91]
    v_mfma_f32_16x16x32_bf16 v[92:95], v[212:215], v[44:47], v[92:95]
    s_add_u32 s69, s69, 1024
    s_cmp_eq_u32 s69, 20480
    s_cselect_b32 s69, 0, s69
    s_add_u32 s70, s68, s69
    s_mov_b32 s78, 0
rd_55049:
    buffer_load_dwordx4 v[32:35], v48, s[36:39], s70 offen sc1
    buffer_load_dwordx4 v[36:39], v49, s[36:39], s70 offen sc1
    buffer_load_dwordx4 v[40:43], v50, s[36:39], s70 offen sc1
    buffer_load_dwordx4 v[44:47], v51, s[36:39], s70 offen sc1
    s_waitcnt vmcnt(3)
    v_max_u32 v52, v32, v33
    v_max3_u32 v52, v52, v34, v35
    s_waitcnt vmcnt(2)
    v_max3_u32 v52, v52, v36, v37
    v_max3_u32 v52, v52, v38, v39
    s_waitcnt vmcnt(1)
    v_max3_u32 v52, v52, v40, v41
    v_max3_u32 v52, v52, v42, v43
    s_waitcnt vmcnt(0)
    v_max3_u32 v52, v52, v44, v45
    v_max3_u32 v52, v52, v46, v47
    v_cmp_eq_u32 vcc, -1, v52
    s_cbranch_vccz re_55050
    s_add_u32 s78, s78, 1
    s_cmp_lt_u32 s78, 131072
    s_cbranch_scc1 rd_55049
re_55050:
    v_mfma_f32_16x16x32_bf16 v[64:67], v[216:219], v[32:35], v[64:67]
    v_mfma_f32_16x16x32_bf16 v[68:71], v[220:223], v[32:35], v[68:71]
    v_mfma_f32_16x16x32_bf16 v[72:75], v[216:219], v[36:39], v[72:75]
    v_mfma_f32_16x16x32_bf16 v[76:79], v[220:223], v[36:39], v[76:79]
    v_mfma_f32_16x16x32_bf16 v[80:83], v[216:219], v[40:43], v[80:83]
    v_mfma_f32_16x16x32_bf16 v[84:87], v[220:223], v[40:43], v[84:87]
    v_mfma_f32_16x16x32_bf16 v[88:91], v[216:219], v[44:47], v[88:91]
    v_mfma_f32_16x16x32_bf16 v[92:95], v[220:223], v[44:47], v[92:95]
    s_add_u32 s69, s69, 1024
    s_cmp_eq_u32 s69, 20480
    s_cselect_b32 s69, 0, s69
    s_add_u32 s70, s68, s69
    s_mov_b32 s78, 0
rd_55051:
    buffer_load_dwordx4 v[32:35], v48, s[36:39], s70 offen sc1
    buffer_load_dwordx4 v[36:39], v49, s[36:39], s70 offen sc1
    buffer_load_dwordx4 v[40:43], v50, s[36:39], s70 offen sc1
    buffer_load_dwordx4 v[44:47], v51, s[36:39], s70 offen sc1
    s_waitcnt vmcnt(3)
    v_max_u32 v52, v32, v33
    v_max3_u32 v52, v52, v34, v35
    s_waitcnt vmcnt(2)
    v_max3_u32 v52, v52, v36, v37
    v_max3_u32 v52, v52, v38, v39
    s_waitcnt vmcnt(1)
    v_max3_u32 v52, v52, v40, v41
    v_max3_u32 v52, v52, v42, v43
    s_waitcnt vmcnt(0)
    v_max3_u32 v52, v52, v44, v45
    v_max3_u32 v52, v52, v46, v47
    v_cmp_eq_u32 vcc, -1, v52
    s_cbranch_vccz re_55052
    s_add_u32 s78, s78, 1
    s_cmp_lt_u32 s78, 131072
    s_cbranch_scc1 rd_55051
re_55052:
    v_mfma_f32_16x16x32_bf16 v[64:67], v[224:227], v[32:35], v[64:67]
    v_mfma_f32_16x16x32_bf16 v[68:71], v[228:231], v[32:35], v[68:71]
    v_mfma_f32_16x16x32_bf16 v[72:75], v[224:227], v[36:39], v[72:75]
    v_mfma_f32_16x16x32_bf16 v[76:79], v[228:231], v[36:39], v[76:79]
    v_mfma_f32_16x16x32_bf16 v[80:83], v[224:227], v[40:43], v[80:83]
    v_mfma_f32_16x16x32_bf16 v[84:87], v[228:231], v[40:43], v[84:87]
    v_mfma_f32_16x16x32_bf16 v[88:91], v[224:227], v[44:47], v[88:91]
    v_mfma_f32_16x16x32_bf16 v[92:95], v[228:231], v[44:47], v[92:95]
    s_add_u32 s69, s69, 1024
    s_cmp_eq_u32 s69, 20480
    s_cselect_b32 s69, 0, s69
    s_add_u32 s70, s68, s69
    s_mov_b32 s78, 0
rd_55053:
    buffer_load_dwordx4 v[32:35], v48, s[36:39], s70 offen sc1
    buffer_load_dwordx4 v[36:39], v49, s[36:39], s70 offen sc1
    buffer_load_dwordx4 v[40:43], v50, s[36:39], s70 offen sc1
    buffer_load_dwordx4 v[44:47], v51, s[36:39], s70 offen sc1
    s_waitcnt vmcnt(3)
    v_max_u32 v52, v32, v33
    v_max3_u32 v52, v52, v34, v35
    s_waitcnt vmcnt(2)
    v_max3_u32 v52, v52, v36, v37
    v_max3_u32 v52, v52, v38, v39
    s_waitcnt vmcnt(1)
    v_max3_u32 v52, v52, v40, v41
    v_max3_u32 v52, v52, v42, v43
    s_waitcnt vmcnt(0)
    v_max3_u32 v52, v52, v44, v45
    v_max3_u32 v52, v52, v46, v47
    v_cmp_eq_u32 vcc, -1, v52
    s_cbranch_vccz re_55054
    s_add_u32 s78, s78, 1
    s_cmp_lt_u32 s78, 131072
    s_cbranch_scc1 rd_55053
re_55054:
    v_mfma_f32_16x16x32_bf16 v[64:67], v[232:235], v[32:35], v[64:67]
    v_mfma_f32_16x16x32_bf16 v[68:71], v[236:239], v[32:35], v[68:71]
    v_mfma_f32_16x16x32_bf16 v[72:75], v[232:235], v[36:39], v[72:75]
    v_mfma_f32_16x16x32_bf16 v[76:79], v[236:239], v[36:39], v[76:79]
    v_mfma_f32_16x16x32_bf16 v[80:83], v[232:235], v[40:43], v[80:83]
    v_mfma_f32_16x16x32_bf16 v[84:87], v[236:239], v[40:43], v[84:87]
    v_mfma_f32_16x16x32_bf16 v[88:91], v[232:235], v[44:47], v[88:91]
    v_mfma_f32_16x16x32_bf16 v[92:95], v[236:239], v[44:47], v[92:95]
    s_add_u32 s69, s69, 1024
    s_cmp_eq_u32 s69, 20480
    s_cselect_b32 s69, 0, s69
    s_add_u32 s70, s68, s69
    s_mov_b32 s78, 0
rd_55055:
    buffer_load_dwordx4 v[32:35], v48, s[36:39], s70 offen sc1
    buffer_load_dwordx4 v[36:39], v49, s[36:39], s70 offen sc1
    buffer_load_dwordx4 v[40:43], v50, s[36:39], s70 offen sc1
    buffer_load_dwordx4 v[44:47], v51, s[36:39], s70 offen sc1
    s_waitcnt vmcnt(3)
    v_max_u32 v52, v32, v33
    v_max3_u32 v52, v52, v34, v35
    s_waitcnt vmcnt(2)
    v_max3_u32 v52, v52, v36, v37
    v_max3_u32 v52, v52, v38, v39
    s_waitcnt vmcnt(1)
    v_max3_u32 v52, v52, v40, v41
    v_max3_u32 v52, v52, v42, v43
    s_waitcnt vmcnt(0)
    v_max3_u32 v52, v52, v44, v45
    v_max3_u32 v52, v52, v46, v47
    v_cmp_eq_u32 vcc, -1, v52
    s_cbranch_vccz re_55056
    s_add_u32 s78, s78, 1
    s_cmp_lt_u32 s78, 131072
    s_cbranch_scc1 rd_55055
re_55056:
    v_mfma_f32_16x16x32_bf16 v[64:67], v[240:243], v[32:35], v[64:67]
    v_mfma_f32_16x16x32_bf16 v[68:71], v[244:247], v[32:35], v[68:71]
    v_mfma_f32_16x16x32_bf16 v[72:75], v[240:243], v[36:39], v[72:75]
    v_mfma_f32_16x16x32_bf16 v[76:79], v[244:247], v[36:39], v[76:79]
    v_mfma_f32_16x16x32_bf16 v[80:83], v[240:243], v[40:43], v[80:83]
    v_mfma_f32_16x16x32_bf16 v[84:87], v[244:247], v[40:43], v[84:87]
    v_mfma_f32_16x16x32_bf16 v[88:91], v[240:243], v[44:47], v[88:91]
    v_mfma_f32_16x16x32_bf16 v[92:95], v[244:247], v[44:47], v[92:95]
    s_add_u32 s69, s69, 1024
    s_cmp_eq_u32 s69, 20480
    s_cselect_b32 s69, 0, s69
    s_add_u32 s70, s68, s69
    s_mov_b32 s78, 0
rd_55057:
    buffer_load_dwordx4 v[32:35], v48, s[36:39], s70 offen sc1
    buffer_load_dwordx4 v[36:39], v49, s[36:39], s70 offen sc1
    buffer_load_dwordx4 v[40:43], v50, s[36:39], s70 offen sc1
    buffer_load_dwordx4 v[44:47], v51, s[36:39], s70 offen sc1
    s_waitcnt vmcnt(3)
    v_max_u32 v52, v32, v33
    v_max3_u32 v52, v52, v34, v35
    s_waitcnt vmcnt(2)
    v_max3_u32 v52, v52, v36, v37
    v_max3_u32 v52, v52, v38, v39
    s_waitcnt vmcnt(1)
    v_max3_u32 v52, v52, v40, v41
    v_max3_u32 v52, v52, v42, v43
    s_waitcnt vmcnt(0)
    v_max3_u32 v52, v52, v44, v45
    v_max3_u32 v52, v52, v46, v47
    v_cmp_eq_u32 vcc, -1, v52
    s_cbranch_vccz re_55058
    s_add_u32 s78, s78, 1
    s_cmp_lt_u32 s78, 131072
    s_cbranch_scc1 rd_55057
re_55058:
    v_mfma_f32_16x16x32_bf16 v[64:67], v[248:251], v[32:35], v[64:67]
    v_mfma_f32_16x16x32_bf16 v[68:71], v[252:255], v[32:35], v[68:71]
    v_mfma_f32_16x16x32_bf16 v[72:75], v[248:251], v[36:39], v[72:75]
    v_mfma_f32_16x16x32_bf16 v[76:79], v[252:255], v[36:39], v[76:79]
    v_mfma_f32_16x16x32_bf16 v[80:83], v[248:251], v[40:43], v[80:83]
    v_mfma_f32_16x16x32_bf16 v[84:87], v[252:255], v[40:43], v[84:87]
    v_mfma_f32_16x16x32_bf16 v[88:91], v[248:251], v[44:47], v[88:91]
    v_mfma_f32_16x16x32_bf16 v[92:95], v[252:255], v[44:47], v[92:95]
    s_add_u32 s69, s69, 1024
    s_cmp_eq_u32 s69, 20480
    s_cselect_b32 s69, 0, s69
    v_cvt_pk_bf16_f32 v64, v64, v65
    v_cvt_pk_bf16_f32 v65, v66, v67
    v_cvt_pk_bf16_f32 v66, v68, v69
    v_cvt_pk_bf16_f32 v67, v70, v71
    ds_write_b128 v15, v[64:67] offset:0
    v_cvt_pk_bf16_f32 v72, v72, v73
    v_cvt_pk_bf16_f32 v73, v74, v75
    v_cvt_pk_bf16_f32 v74, v76, v77
    v_cvt_pk_bf16_f32 v75, v78, v79
    ds_write_b128 v15, v[72:75] offset:4096
    v_cvt_pk_bf16_f32 v80, v80, v81
    v_cvt_pk_bf16_f32 v81, v82, v83
    v_cvt_pk_bf16_f32 v82, v84, v85
    v_cvt_pk_bf16_f32 v83, v86, v87
    ds_write_b128 v15, v[80:83] offset:8192
    v_cvt_pk_bf16_f32 v88, v88, v89
    v_cvt_pk_bf16_f32 v89, v90, v91
    v_cvt_pk_bf16_f32 v90, v92, v93
    v_cvt_pk_bf16_f32 v91, v94, v95
    ds_write_b128 v15, v[88:91] offset:12288
    s_waitcnt vmcnt(0) lgkmcnt(0)
    s_branch L_redone
.section .rodata,"a"
.p2align 6
.amdhsa_kernel sequential_preLN__linear_kernel_hedgehog__moe_arch_mod__prompt_kernel
  .amdhsa_next_free_vgpr 256
  .amdhsa_next_free_sgpr 102
  .amdhsa_accum_offset 256
  .amdhsa_group_segment_fixed_size 0
  .amdhsa_kernarg_size 96
  .amdhsa_user_sgpr_count 2
  .amdhsa_user_sgpr_kernarg_segment_ptr 1
  .amdhsa_system_sgpr_workgroup_id_x 1
  .amdhsa_float_denorm_mode_32 3
.end_amdhsa_kernel
```
